```python
import torch

def _softmax(x, axis=-1):
    return torch.softmax(x, dim=axis)
def _gelu(x):
    return torch.nn.functional.gelu(x, approximate="tanh")
def _silu(x):
    return torch.nn.functional.silu(x)
def _sigmoid(x):
    return torch.sigmoid(x)
def _layernorm(x, axis=-1, eps=1e-5):
    m = x.mean(dim=axis, keepdim=True)
    v = x.var(dim=axis, keepdim=True, unbiased=False)
    return (x - m) / torch.sqrt(v + eps)
def _scatter_add(tgt, idx, src, axis=0):
    return tgt.clone().index_add_(axis, idx, src)
def _segment_sum(src, seg, n):
    out = torch.zeros((n,) + src.shape[1:], dtype=src.dtype)
    return out.index_add_(0, seg, src)
def _pad(x, pw):
    flat = tuple(v for pair in reversed(pw) for v in pair)
    return torch.nn.functional.pad(x, flat)

kernel_name = 'sequential_preLN__mha_block__mixer_token_mlp__prompt'

def setup_inputs():

    _w = (lambda a: (lambda t: t.to(torch.bfloat16) if t.is_floating_point() else t)(torch.as_tensor(a)))
    def _A_setup():
        B, S, D, H = 1, 2048, 640, 32
        return {
            "x": _w((lambda *s: torch.randn(*s, dtype=torch.bfloat16) * 0.05)(B, S, D)),
            "wqkv": _w((lambda *s: torch.randn(*s, dtype=torch.bfloat16) * 0.05)(D, 3 * D)),
            "wo": _w((lambda *s: torch.randn(*s, dtype=torch.bfloat16) * 0.05)(D, D)),
        }
    _A_in = _A_setup()

    def _B_setup():
        B, S, D, F = 1, 2048, 640, 1536
        return {
            "x": _w((lambda *s: torch.randn(*s, dtype=torch.bfloat16) * 0.05)(B, S, D)),
            "w1": _w((lambda *s: torch.randn(*s, dtype=torch.bfloat16) * 1.6)(S, F) * (S ** -0.5)),
            "b1": _w((lambda *s: torch.randn(*s, dtype=torch.bfloat16) * 1.6)(F) * 0.02),
            "w2": _w((lambda *s: torch.randn(*s, dtype=torch.bfloat16) * 0.2)(F, S) * (F ** -0.5)),
            "b2": _w((lambda *s: torch.randn(*s, dtype=torch.bfloat16) * 0.2)(S) * 0.02),
        }
    _B_in = _B_setup()

    return {
        "A_x": _A_in["x"],
        "A_wqkv": _A_in["wqkv"],
        "A_wo": _A_in["wo"],
        "B_x": _B_in["x"],
        "B_w1": _B_in["w1"],
        "B_b1": _B_in["b1"],
        "B_w2": _B_in["w2"],
        "B_b2": _B_in["b2"],
    }

def reference(A_x, A_wqkv, A_wo, B_x, B_w1, B_b1, B_w2, B_b2):
    def _A_ref(x, wqkv, wo):
        B, S, D = x.shape
        H = 32
        Dh = D // H
        qkv = (lambda x, *d: x.permute(*d))((x @ wqkv).reshape(B, S, 3, H, Dh), 2, 0, 3, 1, 4)
        q, k, v = qkv[0], qkv[1], qkv[2]
        scores = torch.einsum("bhqd,bhkd->bhqk", q, k) * (Dh ** -0.5)
        p = _softmax(scores, axis=-1)
        o = torch.einsum("bhqk,bhkd->bhqd", p, v)
        return (lambda x, *d: x.permute(*d))(o, 0, 2, 1, 3).reshape(B, S, D) @ wo

    def _B_ref(x, w1, b1, w2, b2):
        B, S, D = x.shape
        h = _layernorm(x, axis=-1)
        u = torch.einsum("bsd,sf->bdf", h, w1) + b1
        u = _gelu(u)
        y = torch.einsum("bdf,fs->bds", u, w2) + b2
        return (lambda x, *d: x.permute(*d))(y, 0, 2, 1)

    x = A_x
    h = x + _A_ref(_layernorm(x, axis=-1), A_wqkv, A_wo)
    h2 = h + _B_ref(_layernorm(h, axis=-1), B_w1, B_b1, B_w2, B_b2)
    return h2
```

```asm
; @launch grid=(256,1,1) block=(256,1,1) lds=163840
.amdgcn_target "amdgcn-amd-amdhsa--gfx950"
.text
.globl sequential_preLN__mha_block__mixer_token_mlp__prompt_kernel
.p2align 8
.type sequential_preLN__mha_block__mixer_token_mlp__prompt_kernel,@function
sequential_preLN__mha_block__mixer_token_mlp__prompt_kernel:
L_rompt_kernel_code0:
    s_load_dwordx2 s[6:7], s[0:1], 0
    s_load_dwordx2 s[48:49], s[0:1], 8
    s_load_dwordx2 s[4:5], s[0:1], 80
    s_load_dwordx8 s[28:35], s[0:1], 32
    s_load_dwordx2 s[36:37], s[0:1], 64
    s_load_dwordx2 s[52:53], s[0:1], 72
    s_cmp_ge_u32 s2, 256
    s_cbranch_scc1 L_rompt_kernel_end
    s_getpc_b64 s[92:93]
L_rompt_kernel_pc:
    s_lshr_b32 s17, s2, 3
    v_lshlrev_b32 v2, 5, v0
    v_add_lshl_u32 v2, v2, s17, 7
    v_min_u32 v2, L_rompt_kernel_codeend-L_rompt_kernel_pc-4, v2
    v_cmp_gt_u32 vcc, 16, v0
    s_and_saveexec_b64 s[22:23], vcc
    s_cbranch_execz L_rompt_kernel_ncp
    global_load_dword v191, v2, s[92:93]
L_rompt_kernel_ncp:
    s_mov_b64 exec, s[22:23]
    v_lshrrev_b32 v1, 6, v0
    s_nop 0
    v_readfirstlane_b32 s14, v1
    s_and_b32 s16, s2, 7
    s_lshr_b32 s17, s2, 3
    s_and_b32 s21, s17, 3
    s_and_b32 s22, s16, 1
    s_lshl_b32 s79, s22, 3
    s_lshr_b32 s23, s17, 2
    s_add_u32 s79, s79, s23
    s_lshl_b32 s22, s22, 1
    s_and_b32 s24, s17, 1
    s_add_u32 s22, s22, s24
    s_cmp_ge_u32 s17, 28
    s_cselect_b32 s21, s22, s21
    s_cselect_b32 s79, 7, s79
    s_lshr_b32 s78, s16, 1
    s_lshl_b32 s78, s78, 2
    s_add_u32 s78, s78, s21
    v_and_b32 v0, 63, v0
    s_cmp_ge_u32 s17, 30
    s_cselect_b32 s24, 15, s79
    s_lshl_b32 s91, s78, 4
    s_add_u32 s91, s91, s24
    s_lshl_b32 s91, s91, 2
    s_add_u32 s91, s91, s14
    s_mul_i32 s43, s91, 2560
    v_lshrrev_b32 v1, 5, v0
    v_mul_u32_u24 v1, 768, v1
    v_lshl_add_u32 v188, v0, 4, v1
    v_bfe_u32 v1, v0, 4, 1
    v_lshl_add_u32 v189, v1, 30, v188
    s_cmp_ge_u32 s17, 30
    s_cbranch_scc1 L_rompt_kernel_side1
    s_mov_b32 s3, 0
    s_add_u32 s21, s21, s23
    s_and_b32 s21, s21, 3
    s_mov_b32 s81, s21
    s_mov_b32 s82, 0x75431620
    s_mov_b32 s83, 0xfff98
    s_cmp_eq_u32 s21, 1
    s_cselect_b32 s82, 0x65420731, s82
    s_cselect_b32 s83, 0xfff98, s83
    s_cmp_eq_u32 s21, 2
    s_cselect_b32 s82, 0x65321840, s82
    s_cselect_b32 s83, 0xfff97, s83
    s_cmp_eq_u32 s21, 3
    s_cselect_b32 s82, 0x64320951, s82
    s_cselect_b32 s83, 0xfff87, s83
    v_lshrrev_b32 v1, 3, v0
    v_lshrrev_b32 v2, 4, v0
    v_and_b32 v3, 7, v0
    s_lshl_b32 s21, s78, 7
    s_lshl_b32 s22, s14, 5
    s_add_u32 s21, s21, s22
    v_add_u32 v1, s21, v1
    v_mul_u32_u24 v1, 1280, v1
    v_xor_b32 v4, v3, v2
    v_lshl_add_u32 v160, v4, 4, v1
    v_xor_b32 v4, 4, v4
    v_lshl_add_u32 v161, v4, 4, v1
    v_add_u32 v162, 18432, v160
    v_add_u32 v163, 27648, v161
    v_add_u32 v161, 9216, v161
    s_lshl_b32 s21, s14, 4
    v_add_u32 v1, s21, v2
    v_mul_u32_u24 v1, 3840, v1
    v_bfe_u32 v3, v0, 2, 2
    v_xor_b32 v3, v3, v2
    v_lshl_add_u32 v1, v3, 6, v1
    v_and_b32 v3, 3, v0
    v_lshl_add_u32 v1, v3, 4, v1
    s_lshl_b32 s21, s79, 8
    v_add_u32 v164, s21, v1
    v_add_u32 v165, 14336, v164
    v_add_u32 v166, 28672, v164
    v_add_u32 v167, 43008, v164
    s_lshl_b32 s86, s14, 12
    s_waitcnt lgkmcnt(0)
    s_mov_b32 s44, s6
    s_mov_b32 s45, s7
    s_mov_b32 s46, 0x280000
    s_mov_b32 s47, 0x00020000
    s_mov_b32 s50, 2457600
    s_mov_b32 s51, 0x00020000
    s_bfe_u32 s21, s82, 0x40000
    s_add_u32 m0, s86, 0
    s_lshl_b32 s84, s21, 7
    s_mul_i32 s85, s21, 245760
    s_nop 0
    buffer_load_dwordx4 v160, s[44:47], s84 offen offset:0 lds
    buffer_load_dwordx4 v161, s[44:47], s84 offen offset:1024 lds
    buffer_load_dwordx4 v162, s[44:47], s84 offen offset:2048 lds
    buffer_load_dwordx4 v163, s[44:47], s84 offen offset:3072 lds
    s_add_u32 m0, s86, 65536
    s_nop 0
    buffer_load_dwordx4 v164, s[48:51], s85 offen offset:0 lds
    buffer_load_dwordx4 v165, s[48:51], s85 offen offset:1024 lds
    buffer_load_dwordx4 v166, s[48:51], s85 offen offset:2048 lds
    buffer_load_dwordx4 v167, s[48:51], s85 offen offset:3072 lds
    buffer_load_dwordx4 v[176:179], v188, s[44:47], s43 offen offset:0
    buffer_load_dwordx4 v[180:183], v188, s[44:47], s43 offen offset:512
    buffer_load_dwordx4 v[184:187], v189, s[44:47], s43 offen offset:1024
L_rompt_kernel_par:
    s_mov_b32 s8, s4
    s_mov_b32 s9, s5
    s_mov_b32 s10, 0x101db00
    s_mov_b32 s11, 0x00020000
    s_mov_b32 s54, 256
    s_mov_b32 s55, 0x00020000
    v_and_b32 v250, 15, v0
    v_lshrrev_b32 v251, 4, v0
    v_lshlrev_b32 v233, 4, v0
    s_lshr_b32 s12, s17, 2
    s_lshl_b32 s13, s16, 2
    s_and_b32 s18, s17, 3
    s_add_u32 s13, s13, s18
    s_add_u32 s18, s18, s12
    s_lshl_b32 s18, s18, 2
    s_add_u32 s18, s18, s14
    s_mul_i32 s19, s12, 80
    s_lshl_b32 s20, s13, 6
    s_lshl_b32 s63, s14, 4
    s_add_u32 s63, s63, s20
    s_mul_i32 s57, s63, 1280
    s_lshl_b32 s74, s19, 1
    s_add_u32 s57, s57, s74
    s_mul_hi_u32 s74, s17, 858993460
    s_mul_i32 s75, s74, 5
    s_sub_u32 s75, s17, s75
    s_and_b32 s70, s16, 1
    s_mul_i32 s70, s70, 5
    s_add_u32 s70, s70, s75
    s_lshl_b32 s65, s70, 6
    s_lshr_b32 s64, s16, 1
    s_mul_i32 s64, s64, 6
    s_add_u32 s64, s64, s74
    s_lshl_b32 s64, s64, 6
    s_add_u32 s66, s74, s75
    s_lshl_b32 s66, s66, 2
    s_add_u32 s66, s66, s14
    s_lshl_b32 s15, s14, 12
    s_add_u32 s15, s15, 86016
    s_mul_i32 s42, s14, 3072
    s_add_u32 s42, s42, 151552
    s_and_b32 s61, s14, 1
    s_lshr_b32 s62, s14, 1
    v_and_b32 v1, 31, v0
    v_lshrrev_b32 v2, 5, v0
    s_lshl_b32 s68, s16, 2
    s_and_b32 s69, s17, 3
    s_add_u32 s68, s68, s69
    s_lshr_b32 s69, s2, 5
    s_and_b32 s21, s68, 1
    s_lshr_b32 s71, s68, 1
    s_mul_i32 s71, s71, 5
    s_mul_i32 s72, s21, 3
    s_add_u32 s72, s72, s71
    v_and_b32 v1, 31, v0
    v_lshrrev_b32 v2, 5, v0
    v_cmp_gt_u32 vcc, 32, v0
    s_lshl_b32 s73, s69, 8
    s_lshl_b32 s74, s61, 7
    s_add_u32 s73, s73, s74
    v_add_u32 v3, s72, v2
    v_mul_u32_u24 v3, 2096, v3
    v_add_u32 v3, v3, v1
    v_add_lshl_u32 v194, v3, s73, 4
    s_mov_b32 s74, 167680
    v_add_lshl_u32 v192, v3, s74, 4
    s_add_u32 s74, s71, 2
    s_mul_i32 s74, s74, 33536
    s_lshl_b32 s75, s21, 3
    s_add_u32 s74, s74, s75
    v_lshlrev_b32 v4, 4, v1
    s_lshl_b32 s75, s73, 4
    s_add_u32 s75, s75, s74
    v_add_u32 v5, s75, v4
    v_mov_b32 v6, 1073741824
    v_cndmask_b32 v195, v6, v5, vcc
    s_add_u32 s74, s74, 2682880
    v_mov_b32 v5, s74
    v_mov_b32 v7, 5365760
    v_cndmask_b32 v5, v7, v5, vcc
    v_add_u32 v193, v5, v4
    s_lshl_b32 s59, s62, 10
    v_bfe_u32 v3, v0, 2, 1
    v_lshlrev_b32 v3, 3, v3
    v_bfe_u32 v4, v0, 3, 1
    v_lshl_add_u32 v3, v4, 2, v3
    v_and_b32 v4, 3, v0
    v_add_u32 v3, v3, v4
    v_cmp_gt_u32 vcc, 16, v1
    v_cmp_eq_u32 s[92:93], 20, v1
    v_cmp_lt_u32 s[22:23], 20, v1
    s_mul_i32 s74, s68, 20
    v_cndmask_b32 v3, v1, v3, vcc
    v_add_u32 v3, s74, v3
    v_mov_b32 v4, 640
    v_cndmask_b32 v3, v3, v4, s[92:93]
    v_mul_u32_u24 v5, 648, v2
    v_add_lshl_u32 v3, v3, v5, 4
    v_cndmask_b32 v3, v3, v6, s[22:23]
    v_add_u32 v198, 5399296, v3
    v_add_u32 v199, 5420032, v3
    v_add_u32 v200, 5440768, v3
    v_add_u32 v201, 5461504, v3
    v_add_u32 v202, 5482240, v3
    v_add_u32 v203, 5502976, v3
    v_add_u32 v204, 5523712, v3
    v_add_u32 v205, 5544448, v3
    s_mul_i32 s74, s12, 102400
    s_add_u32 s74, s74, 15489792
    v_add_u32 v197, s74, v233
    s_mul_i32 s67, s14, 25600
    s_lshl_b32 s74, s68, 1
    v_add_u32 v3, s74, v2
    v_mul_u32_u24 v3, 2096, v3
    v_add_u32 v3, v3, v1
    v_add_lshl_u32 v252, v3, s73, 4
    v_add_u32 v252, 8219392, v252
    s_lshr_b32 s74, s73, 6
    s_add_u32 s74, s74, s62
    s_lshl_b32 s60, s68, 5
    s_add_u32 s60, s60, s74
    s_lshl_b32 s60, s60, 9
    s_add_u32 s60, s60, 10365696
    s_lshl_b32 s74, s2, 2
    s_add_u32 s74, s74, s14
    s_mul_i32 s74, s74, 1536
    v_lshlrev_b32 v4, 7, v0
    v_add_u32 v4, s74, v4
    v_cmp_gt_u32 vcc, 12, v0
    s_mov_b32 s56, 0xffff0000
    s_mov_b32 s58, 0x07060302
    v_cndmask_b32 v196, v6, v4, vcc
    s_add_u32 s38, s14, 0
    s_and_b32 s38, s38, 3
    s_add_u32 s39, s14, 1
    s_and_b32 s39, s39, 3
    s_add_u32 s40, s14, 2
    s_and_b32 s40, s40, 3
    s_add_u32 s41, s14, 3
    s_and_b32 s41, s41, 3
    s_mul_hi_u32 s72, s65, 53687092
    s_add_u32 s73, s65, 63
    s_mul_hi_u32 s73, s73, 53687092
    s_lshr_b32 s74, s19, 6
    s_add_u32 s75, s74, 1
    v_lshrrev_b32 v3, 3, v0
    v_mul_u32_u24 v3, 3072, v3
    s_lshl_b32 s22, s64, 1
    v_add_u32 v3, s22, v3
    v_and_b32 v4, 7, v0
    v_bfe_u32 v5, v0, 4, 1
    v_lshlrev_b32 v5, 1, v5
    v_xor_b32 v4, v4, v5
    v_lshl_add_u32 v220, v4, 4, v3
    v_xor_b32 v221, 64, v220
    v_add_u32 v222, 47104, v220
    v_add_u32 v223, 70656, v221
    v_add_u32 v221, 23552, v221
    v_bfe_u32 v3, v0, 2, 2
    v_lshl_add_u32 v4, v251, 3, v3
    v_lshlrev_b32 v4, 7, v4
    v_bfe_u32 v3, v0, 3, 2
    v_lshl_add_u32 v4, v3, 5, v4
    v_and_b32 v3, 3, v0
    v_lshl_add_u32 v4, v3, 3, v4
    v_xor_b32 v224, 0, v4
    v_add_u32 v224, s15, v224
    v_xor_b32 v225, 32, v4
    v_add_u32 v225, s15, v225
    v_xor_b32 v226, 64, v4
    v_add_u32 v226, s15, v226
    v_xor_b32 v227, 96, v4
    v_add_u32 v227, s15, v227
    s_mul_i32 s23, s39, 15360
    s_add_u32 s23, s23, 0
    v_add_u32 v228, s23, v233
    s_mul_i32 s23, s40, 15360
    s_add_u32 s23, s23, 5120
    v_add_u32 v229, s23, v233
    s_mul_i32 s23, s41, 15360
    s_add_u32 s23, s23, 10240
    v_add_u32 v230, s23, v233
    s_mul_i32 s23, s14, 15360
    v_add_u32 v231, s23, v233
    v_add_u32 v234, 51200, v233
    v_mul_u32_u24 v3, 160, v250
    v_lshl_add_u32 v3, v251, 3, v3
    v_add_u32 v232, s42, v3
    s_cmp_eq_u32 s3, 1
    s_cbranch_scc1 L_rompt_kernel_side2
    v_bfe_u32 v3, v0, 1, 3
    v_xor_b32 v3, v3, v2
    s_lshl_b32 s21, s62, 6
    v_add_u32 v4, s21, v1
    v_lshlrev_b32 v4, 7, v4
    v_lshl_add_u32 v154, v3, 4, v4
    v_xor_b32 v155, 32, v154
    v_xor_b32 v156, 64, v154
    v_xor_b32 v157, 96, v154
    v_bfe_u32 v3, v0, 2, 2
    v_lshl_add_u32 v6, v2, 3, v3
    v_lshlrev_b32 v6, 8, v6
    s_lshl_b32 s21, s61, 1
    s_add_u32 s21, s21, s62
    v_xor_b32 v3, s21, v3
    v_lshl_add_u32 v6, v3, 6, v6
    v_bfe_u32 v3, v0, 4, 1
    v_lshl_add_u32 v6, v3, 5, v6
    v_add_u32 v6, 65536, v6
    v_and_b32 v3, 3, v0
    v_and_b32 v4, 1, v0
    v_lshlrev_b32 v4, 1, v4
    v_bfe_u32 v5, v0, 1, 1
    v_or_b32 v4, v4, v5
    s_cmp_ge_u32 s79, 10
    s_cselect_b64 vcc, -1, 0
    v_cndmask_b32 v3, v4, v3, vcc
    v_lshl_add_u32 v158, v3, 3, v6
    v_xor_b32 v159, 64, v158
    v_mov_b32 v112, 0
    v_mov_b32 v113, 0
    v_mov_b32 v114, 0
    v_mov_b32 v115, 0
    s_cmp_lt_u32 s81, 2
    s_cselect_b32 s21, 0x3f803f80, 0
    v_mov_b32 v152, s21
    v_mov_b32 v153, s21
    s_lshr_b32 s21, s78, 2
    s_lshl_b32 s21, s21, 4
    s_add_u32 s21, s21, s79
    s_lshl_b32 s21, s21, 11
    s_add_u32 s87, s21, 16702208
    s_and_b32 s21, s78, 3
    s_lshl_b32 s21, s21, 9
    s_add_u32 s90, s87, s21
    s_lshl_b32 s21, s61, 6
    s_lshl_b32 s22, s62, 5
    s_add_u32 s21, s21, s22
    v_add_lshl_u32 v171, v1, s21, 2
    v_lshl_add_u32 v171, v2, 9, v171
    v_mfma_f32_32x32x16_bf16 v[8:23], v[112:115], v[112:115], 0
    v_mfma_f32_32x32x16_bf16 v[24:39], v[112:115], v[112:115], 0
    v_mfma_f32_32x32x16_bf16 v[40:55], v[112:115], v[112:115], 0
    v_mfma_f32_32x32x16_bf16 v[56:71], v[112:115], v[112:115], 0
    v_mfma_f32_32x32x16_bf16 v[72:87], v[112:115], v[112:115], 0
    s_lshl_b32 s21, s14, 5
    v_add_u32 v3, s21, v1
    v_lshlrev_b32 v172, 6, v3
    v_lshlrev_b32 v173, 2, v3
    v_add_u32 v173, 151552, v173
    s_lshl_b32 s80, s78, 13
    s_add_u32 s80, s80, 16571144
    s_bfe_u32 s21, s82, 0x40004
    s_add_u32 m0, s86, 16384
    s_lshl_b32 s84, s21, 7
    s_mul_i32 s85, s21, 245760
    s_nop 0
    buffer_load_dwordx4 v160, s[44:47], s84 offen offset:0 lds
    buffer_load_dwordx4 v161, s[44:47], s84 offen offset:1024 lds
    buffer_load_dwordx4 v162, s[44:47], s84 offen offset:2048 lds
    buffer_load_dwordx4 v163, s[44:47], s84 offen offset:3072 lds
    s_add_u32 m0, s86, 81920
    s_nop 0
    buffer_load_dwordx4 v164, s[48:51], s85 offen offset:0 lds
    buffer_load_dwordx4 v165, s[48:51], s85 offen offset:1024 lds
    buffer_load_dwordx4 v166, s[48:51], s85 offen offset:2048 lds
    buffer_load_dwordx4 v167, s[48:51], s85 offen offset:3072 lds
    s_cmp_ge_u32 s79, 10
    s_cbranch_scc1 L_rompt_kernel_loopv
L_rompt_kernel_loopq:
    s_waitcnt vmcnt(11)
    s_barrier
    ds_read_b128 v[88:91], v154 offset:0
    ds_read_b64_tr_b16 v[120:121], v158 offset:0
    ds_read_b64_tr_b16 v[122:123], v158 offset:1024
    ds_read_b64_tr_b16 v[136:137], v159 offset:0
    ds_read_b64_tr_b16 v[138:139], v159 offset:1024
    ds_read_b128 v[92:95], v154 offset:4096
    ds_read_b128 v[96:99], v155 offset:0
    ds_read_b64_tr_b16 v[124:125], v158 offset:4096
    ds_read_b64_tr_b16 v[126:127], v158 offset:5120
    ds_read_b64_tr_b16 v[140:141], v159 offset:4096
    ds_read_b64_tr_b16 v[142:143], v159 offset:5120
    ds_read_b128 v[100:103], v155 offset:4096
    s_bfe_u32 s21, s82, 0x40008
    s_add_u32 m0, s86, 32768
    s_lshl_b32 s84, s21, 7
    s_mul_i32 s85, s21, 245760
    s_nop 0
    buffer_load_dwordx4 v160, s[44:47], s84 offen offset:0 lds
    buffer_load_dwordx4 v161, s[44:47], s84 offen offset:1024 lds
    buffer_load_dwordx4 v162, s[44:47], s84 offen offset:2048 lds
    buffer_load_dwordx4 v163, s[44:47], s84 offen offset:3072 lds
    s_waitcnt lgkmcnt(6)
    v_mfma_f32_32x32x16_bf16 v[8:23], v[120:123], v[88:91], v[8:23]
    ds_read_b128 v[104:107], v156 offset:0
    ds_read_b64_tr_b16 v[128:129], v158 offset:8192
    s_add_u32 m0, s86, 98304
    v_mfma_f32_32x32x16_bf16 v[24:39], v[136:139], v[88:91], v[24:39]
    ds_read_b64_tr_b16 v[130:131], v158 offset:9216
    ds_read_b64_tr_b16 v[144:145], v159 offset:8192
    buffer_load_dwordx4 v164, s[48:51], s85 offen offset:0 lds
    v_mfma_f32_32x32x16_bf16 v[40:55], v[120:123], v[92:95], v[40:55]
    ds_read_b64_tr_b16 v[146:147], v159 offset:9216
    ds_read_b128 v[108:111], v156 offset:4096
    v_mfma_f32_32x32x16_bf16 v[56:71], v[136:139], v[92:95], v[56:71]
    buffer_load_dwordx4 v165, s[48:51], s85 offen offset:1024 lds
    s_waitcnt lgkmcnt(6)
    v_mfma_f32_32x32x16_bf16 v[8:23], v[124:127], v[96:99], v[8:23]
    ds_read_b128 v[112:115], v157 offset:0
    ds_read_b64_tr_b16 v[132:133], v158 offset:12288
    v_mfma_f32_32x32x16_bf16 v[24:39], v[140:143], v[96:99], v[24:39]
    ds_read_b64_tr_b16 v[134:135], v158 offset:13312
    ds_read_b64_tr_b16 v[148:149], v159 offset:12288
    buffer_load_dwordx4 v166, s[48:51], s85 offen offset:2048 lds
    v_mfma_f32_32x32x16_bf16 v[40:55], v[124:127], v[100:103], v[40:55]
    ds_read_b64_tr_b16 v[150:151], v159 offset:13312
    ds_read_b128 v[116:119], v157 offset:4096
    v_mfma_f32_4x4x4_16b_bf16 v[72:75], v[152:153], v[120:121], v[72:75]
    v_mfma_f32_4x4x4_16b_bf16 v[76:79], v[152:153], v[122:123], v[76:79]
    v_mfma_f32_4x4x4_16b_bf16 v[80:83], v[152:153], v[124:125], v[80:83]
    v_mfma_f32_4x4x4_16b_bf16 v[84:87], v[152:153], v[126:127], v[84:87]
    v_mfma_f32_32x32x16_bf16 v[56:71], v[140:143], v[100:103], v[56:71]
    buffer_load_dwordx4 v167, s[48:51], s85 offen offset:3072 lds
    s_waitcnt vmcnt(16)
    s_call_b64 s[92:93], L_rompt_kernel_sub
    s_waitcnt vmcnt(8)
    s_barrier
    s_waitcnt lgkmcnt(6)
    v_mfma_f32_32x32x16_bf16 v[8:23], v[128:131], v[104:107], v[8:23]
    ds_read_b128 v[88:91], v154 offset:16384
    ds_read_b64_tr_b16 v[120:121], v158 offset:16384
    s_bfe_u32 s21, s82, 0x4000c
    s_add_u32 m0, s86, 49152
    v_mfma_f32_32x32x16_bf16 v[24:39], v[144:147], v[104:107], v[24:39]
    ds_read_b64_tr_b16 v[122:123], v158 offset:17408
    ds_read_b64_tr_b16 v[136:137], v159 offset:16384
    s_lshl_b32 s84, s21, 7
    s_mul_i32 s85, s21, 245760
    buffer_load_dwordx4 v160, s[44:47], s84 offen offset:0 lds
    v_mfma_f32_32x32x16_bf16 v[40:55], v[128:131], v[108:111], v[40:55]
    ds_read_b64_tr_b16 v[138:139], v159 offset:17408
    ds_read_b128 v[92:95], v154 offset:20480
    v_mfma_f32_32x32x16_bf16 v[56:71], v[144:147], v[108:111], v[56:71]
    buffer_load_dwordx4 v161, s[44:47], s84 offen offset:1024 lds
    s_waitcnt lgkmcnt(6)
    v_mfma_f32_32x32x16_bf16 v[8:23], v[132:135], v[112:115], v[8:23]
    ds_read_b128 v[96:99], v155 offset:16384
    ds_read_b64_tr_b16 v[124:125], v158 offset:20480
    v_mfma_f32_32x32x16_bf16 v[24:39], v[148:151], v[112:115], v[24:39]
    ds_read_b64_tr_b16 v[126:127], v158 offset:21504
    ds_read_b64_tr_b16 v[140:141], v159 offset:20480
    buffer_load_dwordx4 v162, s[44:47], s84 offen offset:2048 lds
    v_mfma_f32_32x32x16_bf16 v[40:55], v[132:135], v[116:119], v[40:55]
    ds_read_b64_tr_b16 v[142:143], v159 offset:21504
    ds_read_b128 v[100:103], v155 offset:20480
    v_mfma_f32_4x4x4_16b_bf16 v[72:75], v[152:153], v[128:129], v[72:75]
    v_mfma_f32_4x4x4_16b_bf16 v[76:79], v[152:153], v[130:131], v[76:79]
    v_mfma_f32_4x4x4_16b_bf16 v[80:83], v[152:153], v[132:133], v[80:83]
    v_mfma_f32_4x4x4_16b_bf16 v[84:87], v[152:153], v[134:135], v[84:87]
    v_mfma_f32_32x32x16_bf16 v[56:71], v[148:151], v[116:119], v[56:71]
    buffer_load_dwordx4 v163, s[44:47], s84 offen offset:3072 lds
    s_waitcnt lgkmcnt(6)
    v_mfma_f32_32x32x16_bf16 v[8:23], v[120:123], v[88:91], v[8:23]
    ds_read_b128 v[104:107], v156 offset:16384
    ds_read_b64_tr_b16 v[128:129], v158 offset:24576
    s_add_u32 m0, s86, 114688
    v_mfma_f32_32x32x16_bf16 v[24:39], v[136:139], v[88:91], v[24:39]
    ds_read_b64_tr_b16 v[130:131], v158 offset:25600
    ds_read_b64_tr_b16 v[144:145], v159 offset:24576
    buffer_load_dwordx4 v164, s[48:51], s85 offen offset:0 lds
    v_mfma_f32_32x32x16_bf16 v[40:55], v[120:123], v[92:95], v[40:55]
    ds_read_b64_tr_b16 v[146:147], v159 offset:25600
    ds_read_b128 v[108:111], v156 offset:20480
    v_mov_b32 v152, 0x3f803f80
    v_mov_b32 v153, 0x3f803f80
    v_mfma_f32_32x32x16_bf16 v[56:71], v[136:139], v[92:95], v[56:71]
    buffer_load_dwordx4 v165, s[48:51], s85 offen offset:1024 lds
    s_waitcnt lgkmcnt(6)
    v_mfma_f32_32x32x16_bf16 v[8:23], v[124:127], v[96:99], v[8:23]
    ds_read_b128 v[112:115], v157 offset:16384
    ds_read_b64_tr_b16 v[132:133], v158 offset:28672
    v_mfma_f32_32x32x16_bf16 v[24:39], v[140:143], v[96:99], v[24:39]
    ds_read_b64_tr_b16 v[134:135], v158 offset:29696
    ds_read_b64_tr_b16 v[148:149], v159 offset:28672
    buffer_load_dwordx4 v166, s[48:51], s85 offen offset:2048 lds
    v_mfma_f32_32x32x16_bf16 v[40:55], v[124:127], v[100:103], v[40:55]
    ds_read_b64_tr_b16 v[150:151], v159 offset:29696
    ds_read_b128 v[116:119], v157 offset:20480
    v_mfma_f32_4x4x4_16b_bf16 v[72:75], v[152:153], v[120:121], v[72:75]
    v_mfma_f32_4x4x4_16b_bf16 v[76:79], v[152:153], v[122:123], v[76:79]
    v_mfma_f32_4x4x4_16b_bf16 v[80:83], v[152:153], v[124:125], v[80:83]
    v_mfma_f32_4x4x4_16b_bf16 v[84:87], v[152:153], v[126:127], v[84:87]
    v_mfma_f32_32x32x16_bf16 v[56:71], v[140:143], v[100:103], v[56:71]
    buffer_load_dwordx4 v167, s[48:51], s85 offen offset:3072 lds
    s_waitcnt vmcnt(8)
    s_barrier
    s_waitcnt lgkmcnt(6)
    v_mfma_f32_32x32x16_bf16 v[8:23], v[128:131], v[104:107], v[8:23]
    ds_read_b128 v[88:91], v154 offset:32768
    ds_read_b64_tr_b16 v[120:121], v158 offset:32768
    s_bfe_u32 s21, s82, 0x40010
    s_add_u32 m0, s86, 0
    v_mfma_f32_32x32x16_bf16 v[24:39], v[144:147], v[104:107], v[24:39]
    ds_read_b64_tr_b16 v[122:123], v158 offset:33792
    ds_read_b64_tr_b16 v[136:137], v159 offset:32768
    s_lshl_b32 s84, s21, 7
    s_mul_i32 s85, s21, 245760
    buffer_load_dwordx4 v160, s[44:47], s84 offen offset:0 lds
    v_mfma_f32_32x32x16_bf16 v[40:55], v[128:131], v[108:111], v[40:55]
    ds_read_b64_tr_b16 v[138:139], v159 offset:33792
    ds_read_b128 v[92:95], v154 offset:36864
    buffer_load_dword v170, off, s[52:55], 0 sc1
    v_mfma_f32_32x32x16_bf16 v[56:71], v[144:147], v[108:111], v[56:71]
    buffer_load_dwordx4 v161, s[44:47], s84 offen offset:1024 lds
    s_waitcnt lgkmcnt(6)
    v_mfma_f32_32x32x16_bf16 v[8:23], v[132:135], v[112:115], v[8:23]
    ds_read_b128 v[96:99], v155 offset:32768
    ds_read_b64_tr_b16 v[124:125], v158 offset:36864
    v_mfma_f32_32x32x16_bf16 v[24:39], v[148:151], v[112:115], v[24:39]
    ds_read_b64_tr_b16 v[126:127], v158 offset:37888
    ds_read_b64_tr_b16 v[140:141], v159 offset:36864
    buffer_load_dwordx4 v162, s[44:47], s84 offen offset:2048 lds
    v_mfma_f32_32x32x16_bf16 v[40:55], v[132:135], v[116:119], v[40:55]
    ds_read_b64_tr_b16 v[142:143], v159 offset:37888
    ds_read_b128 v[100:103], v155 offset:36864
    v_mfma_f32_4x4x4_16b_bf16 v[72:75], v[152:153], v[128:129], v[72:75]
    v_mfma_f32_4x4x4_16b_bf16 v[76:79], v[152:153], v[130:131], v[76:79]
    v_mfma_f32_4x4x4_16b_bf16 v[80:83], v[152:153], v[132:133], v[80:83]
    v_mfma_f32_4x4x4_16b_bf16 v[84:87], v[152:153], v[134:135], v[84:87]
    v_mfma_f32_32x32x16_bf16 v[56:71], v[148:151], v[116:119], v[56:71]
    buffer_load_dwordx4 v163, s[44:47], s84 offen offset:3072 lds
    s_waitcnt lgkmcnt(6)
    v_mfma_f32_32x32x16_bf16 v[8:23], v[120:123], v[88:91], v[8:23]
    ds_read_b128 v[104:107], v156 offset:32768
    ds_read_b64_tr_b16 v[128:129], v158 offset:40960
    s_add_u32 m0, s86, 65536
    v_mfma_f32_32x32x16_bf16 v[24:39], v[136:139], v[88:91], v[24:39]
    ds_read_b64_tr_b16 v[130:131], v158 offset:41984
    ds_read_b64_tr_b16 v[144:145], v159 offset:40960
    buffer_load_dwordx4 v164, s[48:51], s85 offen offset:0 lds
    v_mfma_f32_32x32x16_bf16 v[40:55], v[120:123], v[92:95], v[40:55]
    ds_read_b64_tr_b16 v[146:147], v159 offset:41984
    ds_read_b128 v[108:111], v156 offset:36864
    v_mfma_f32_32x32x16_bf16 v[56:71], v[136:139], v[92:95], v[56:71]
    buffer_load_dwordx4 v165, s[48:51], s85 offen offset:1024 lds
    s_waitcnt lgkmcnt(6)
    v_mfma_f32_32x32x16_bf16 v[8:23], v[124:127], v[96:99], v[8:23]
    ds_read_b128 v[112:115], v157 offset:32768
    ds_read_b64_tr_b16 v[132:133], v158 offset:45056
    v_mfma_f32_32x32x16_bf16 v[24:39], v[140:143], v[96:99], v[24:39]
    ds_read_b64_tr_b16 v[134:135], v158 offset:46080
    ds_read_b64_tr_b16 v[148:149], v159 offset:45056
    buffer_load_dwordx4 v166, s[48:51], s85 offen offset:2048 lds
    v_mfma_f32_32x32x16_bf16 v[40:55], v[124:127], v[100:103], v[40:55]
    ds_read_b64_tr_b16 v[150:151], v159 offset:46080
    ds_read_b128 v[116:119], v157 offset:36864
    v_mfma_f32_4x4x4_16b_bf16 v[72:75], v[152:153], v[120:121], v[72:75]
    v_mfma_f32_4x4x4_16b_bf16 v[76:79], v[152:153], v[122:123], v[76:79]
    v_mfma_f32_4x4x4_16b_bf16 v[80:83], v[152:153], v[124:125], v[80:83]
    v_mfma_f32_4x4x4_16b_bf16 v[84:87], v[152:153], v[126:127], v[84:87]
    v_mfma_f32_32x32x16_bf16 v[56:71], v[140:143], v[100:103], v[56:71]
    buffer_load_dwordx4 v167, s[48:51], s85 offen offset:3072 lds
    s_waitcnt vmcnt(7)
    s_barrier
    s_waitcnt lgkmcnt(6)
    v_mfma_f32_32x32x16_bf16 v[8:23], v[128:131], v[104:107], v[8:23]
    ds_read_b128 v[88:91], v154 offset:49152
    ds_read_b64_tr_b16 v[120:121], v158 offset:49152
    s_bfe_u32 s21, s82, 0x40014
    s_add_u32 m0, s86, 16384
    v_mfma_f32_32x32x16_bf16 v[24:39], v[144:147], v[104:107], v[24:39]
    ds_read_b64_tr_b16 v[122:123], v158 offset:50176
    ds_read_b64_tr_b16 v[136:137], v159 offset:49152
    s_lshl_b32 s84, s21, 7
    s_mul_i32 s85, s21, 245760
    buffer_load_dwordx4 v160, s[44:47], s84 offen offset:0 lds
    v_mfma_f32_32x32x16_bf16 v[40:55], v[128:131], v[108:111], v[40:55]
    ds_read_b64_tr_b16 v[138:139], v159 offset:50176
    ds_read_b128 v[92:95], v154 offset:53248
    v_mfma_f32_32x32x16_bf16 v[56:71], v[144:147], v[108:111], v[56:71]
    buffer_load_dwordx4 v161, s[44:47], s84 offen offset:1024 lds
    v_cmp_gt_u32 vcc, 16, v170
    s_cbranch_vccz L_rompt_kernel_loopqi
    s_call_b64 s[92:93], L_rompt_kernel_spin
L_rompt_kernel_loopqi:
    s_mov_b32 exec_lo, 15
    s_mov_b32 exec_hi, 15
    buffer_store_dwordx4 v[176:179], v180, s[8:11], s91 offen sc1
    s_mov_b64 exec, -1
    s_waitcnt lgkmcnt(6)
    v_mfma_f32_32x32x16_bf16 v[8:23], v[132:135], v[112:115], v[8:23]
    ds_read_b128 v[96:99], v155 offset:49152
    ds_read_b64_tr_b16 v[124:125], v158 offset:53248
    v_mfma_f32_32x32x16_bf16 v[24:39], v[148:151], v[112:115], v[24:39]
    ds_read_b64_tr_b16 v[126:127], v158 offset:54272
    ds_read_b64_tr_b16 v[140:141], v159 offset:53248
    buffer_load_dwordx4 v162, s[44:47], s84 offen offset:2048 lds
    v_mfma_f32_32x32x16_bf16 v[40:55], v[132:135], v[116:119], v[40:55]
    ds_read_b64_tr_b16 v[142:143], v159 offset:54272
    ds_read_b128 v[100:103], v155 offset:53248
    v_mfma_f32_4x4x4_16b_bf16 v[72:75], v[152:153], v[128:129], v[72:75]
    v_mfma_f32_4x4x4_16b_bf16 v[76:79], v[152:153], v[130:131], v[76:79]
    v_mfma_f32_4x4x4_16b_bf16 v[80:83], v[152:153], v[132:133], v[80:83]
    v_mfma_f32_4x4x4_16b_bf16 v[84:87], v[152:153], v[134:135], v[84:87]
    v_mfma_f32_32x32x16_bf16 v[56:71], v[148:151], v[116:119], v[56:71]
    buffer_load_dwordx4 v163, s[44:47], s84 offen offset:3072 lds
    s_waitcnt lgkmcnt(6)
    v_mfma_f32_32x32x16_bf16 v[8:23], v[120:123], v[88:91], v[8:23]
    ds_read_b128 v[104:107], v156 offset:49152
    ds_read_b64_tr_b16 v[128:129], v158 offset:57344
    s_add_u32 m0, s86, 81920
    v_mfma_f32_32x32x16_bf16 v[24:39], v[136:139], v[88:91], v[24:39]
    ds_read_b64_tr_b16 v[130:131], v158 offset:58368
    ds_read_b64_tr_b16 v[144:145], v159 offset:57344
    buffer_load_dwordx4 v164, s[48:51], s85 offen offset:0 lds
    v_mfma_f32_32x32x16_bf16 v[40:55], v[120:123], v[92:95], v[40:55]
    ds_read_b64_tr_b16 v[146:147], v159 offset:58368
    ds_read_b128 v[108:111], v156 offset:53248
    v_add_f32 v72, v72, v76
    v_add_f32 v80, v80, v84
    v_add_f32 v72, v72, v80
    v_mov_b32 v73, v72
    v_mfma_f32_32x32x16_bf16 v[56:71], v[136:139], v[92:95], v[56:71]
    buffer_load_dwordx4 v165, s[48:51], s85 offen offset:1024 lds
    s_waitcnt lgkmcnt(6)
    v_mfma_f32_32x32x16_bf16 v[8:23], v[124:127], v[96:99], v[8:23]
    ds_read_b128 v[112:115], v157 offset:49152
    ds_read_b64_tr_b16 v[132:133], v158 offset:61440
    v_permlane32_swap_b32 v72, v73
    s_nop 0
    v_mfma_f32_32x32x16_bf16 v[24:39], v[140:143], v[96:99], v[24:39]
    ds_read_b64_tr_b16 v[134:135], v158 offset:62464
    ds_read_b64_tr_b16 v[148:149], v159 offset:61440
    v_add_f32 v72, v72, v73
    v_min_u32 v72, -2, v72
    buffer_load_dwordx4 v166, s[48:51], s85 offen offset:2048 lds
    v_mfma_f32_32x32x16_bf16 v[40:55], v[124:127], v[100:103], v[40:55]
    ds_read_b64_tr_b16 v[150:151], v159 offset:62464
    ds_read_b128 v[116:119], v157 offset:53248
    v_mfma_f32_32x32x16_bf16 v[56:71], v[140:143], v[100:103], v[56:71]
    buffer_load_dwordx4 v167, s[48:51], s85 offen offset:3072 lds
    s_mov_b32 exec_hi, 0
    buffer_store_dword v72, v171, s[8:11], s90 offen sc1
    s_mov_b64 exec, -1
    s_waitcnt vmcnt(10)
    s_barrier
    s_waitcnt lgkmcnt(6)
    v_mfma_f32_32x32x16_bf16 v[8:23], v[128:131], v[104:107], v[8:23]
    ds_read_b128 v[88:91], v154 offset:0
    ds_read_b64_tr_b16 v[120:121], v158 offset:0
    s_bfe_u32 s21, s82, 0x40018
    s_add_u32 m0, s86, 32768
    v_mfma_f32_32x32x16_bf16 v[24:39], v[144:147], v[104:107], v[24:39]
    ds_read_b64_tr_b16 v[122:123], v158 offset:1024
    ds_read_b64_tr_b16 v[136:137], v159 offset:0
    s_lshl_b32 s84, s21, 7
    s_mul_i32 s85, s21, 245760
    buffer_load_dwordx4 v160, s[44:47], s84 offen offset:0 lds
    v_mfma_f32_32x32x16_bf16 v[40:55], v[128:131], v[108:111], v[40:55]
    ds_read_b64_tr_b16 v[138:139], v159 offset:1024
    ds_read_b128 v[92:95], v154 offset:4096
    v_mfma_f32_32x32x16_bf16 v[56:71], v[144:147], v[108:111], v[56:71]
    buffer_load_dwordx4 v161, s[44:47], s84 offen offset:1024 lds
    s_waitcnt lgkmcnt(6)
    v_mfma_f32_32x32x16_bf16 v[8:23], v[132:135], v[112:115], v[8:23]
    ds_read_b128 v[96:99], v155 offset:0
    ds_read_b64_tr_b16 v[124:125], v158 offset:4096
    v_mfma_f32_32x32x16_bf16 v[24:39], v[148:151], v[112:115], v[24:39]
    ds_read_b64_tr_b16 v[126:127], v158 offset:5120
    ds_read_b64_tr_b16 v[140:141], v159 offset:4096
    buffer_load_dwordx4 v162, s[44:47], s84 offen offset:2048 lds
    v_mfma_f32_32x32x16_bf16 v[40:55], v[132:135], v[116:119], v[40:55]
    ds_read_b64_tr_b16 v[142:143], v159 offset:5120
    ds_read_b128 v[100:103], v155 offset:4096
    v_mfma_f32_32x32x16_bf16 v[56:71], v[148:151], v[116:119], v[56:71]
    buffer_load_dwordx4 v163, s[44:47], s84 offen offset:3072 lds
    s_waitcnt lgkmcnt(6)
    v_mfma_f32_32x32x16_bf16 v[8:23], v[120:123], v[88:91], v[8:23]
    ds_read_b128 v[104:107], v156 offset:0
    ds_read_b64_tr_b16 v[128:129], v158 offset:8192
    s_add_u32 m0, s86, 98304
    v_mfma_f32_32x32x16_bf16 v[24:39], v[136:139], v[88:91], v[24:39]
    ds_read_b64_tr_b16 v[130:131], v158 offset:9216
    ds_read_b64_tr_b16 v[144:145], v159 offset:8192
    buffer_load_dwordx4 v164, s[48:51], s85 offen offset:0 lds
    v_mfma_f32_32x32x16_bf16 v[40:55], v[120:123], v[92:95], v[40:55]
    ds_read_b64_tr_b16 v[146:147], v159 offset:9216
    ds_read_b128 v[108:111], v156 offset:4096
    v_mfma_f32_32x32x16_bf16 v[56:71], v[136:139], v[92:95], v[56:71]
    buffer_load_dwordx4 v165, s[48:51], s85 offen offset:1024 lds
    s_waitcnt lgkmcnt(6)
    v_mfma_f32_32x32x16_bf16 v[8:23], v[124:127], v[96:99], v[8:23]
    ds_read_b128 v[112:115], v157 offset:0
    ds_read_b64_tr_b16 v[132:133], v158 offset:12288
    v_mfma_f32_32x32x16_bf16 v[24:39], v[140:143], v[96:99], v[24:39]
    ds_read_b64_tr_b16 v[134:135], v158 offset:13312
    ds_read_b64_tr_b16 v[148:149], v159 offset:12288
    buffer_load_dwordx4 v166, s[48:51], s85 offen offset:2048 lds
    v_mfma_f32_32x32x16_bf16 v[40:55], v[124:127], v[100:103], v[40:55]
    ds_read_b64_tr_b16 v[150:151], v159 offset:13312
    ds_read_b128 v[116:119], v157 offset:4096
    v_mfma_f32_32x32x16_bf16 v[56:71], v[140:143], v[100:103], v[56:71]
    buffer_load_dwordx4 v167, s[48:51], s85 offen offset:3072 lds
    s_waitcnt vmcnt(9)
    s_barrier
    s_waitcnt lgkmcnt(6)
    v_mfma_f32_32x32x16_bf16 v[8:23], v[128:131], v[104:107], v[8:23]
    ds_read_b128 v[88:91], v154 offset:16384
    ds_read_b64_tr_b16 v[120:121], v158 offset:16384
    s_bfe_u32 s21, s82, 0x4001c
    s_add_u32 m0, s86, 49152
    v_mfma_f32_32x32x16_bf16 v[24:39], v[144:147], v[104:107], v[24:39]
    ds_read_b64_tr_b16 v[122:123], v158 offset:17408
    ds_read_b64_tr_b16 v[136:137], v159 offset:16384
    s_lshl_b32 s84, s21, 7
    s_mul_i32 s85, s21, 245760
    buffer_load_dwordx4 v160, s[44:47], s84 offen offset:0 lds
    v_mfma_f32_32x32x16_bf16 v[40:55], v[128:131], v[108:111], v[40:55]
    ds_read_b64_tr_b16 v[138:139], v159 offset:17408
    ds_read_b128 v[92:95], v154 offset:20480
    v_mfma_f32_32x32x16_bf16 v[56:71], v[144:147], v[108:111], v[56:71]
    buffer_load_dwordx4 v161, s[44:47], s84 offen offset:1024 lds
    s_waitcnt lgkmcnt(6)
    v_mfma_f32_32x32x16_bf16 v[8:23], v[132:135], v[112:115], v[8:23]
    ds_read_b128 v[96:99], v155 offset:16384
    ds_read_b64_tr_b16 v[124:125], v158 offset:20480
    v_mfma_f32_32x32x16_bf16 v[24:39], v[148:151], v[112:115], v[24:39]
    ds_read_b64_tr_b16 v[126:127], v158 offset:21504
    ds_read_b64_tr_b16 v[140:141], v159 offset:20480
    buffer_load_dwordx4 v162, s[44:47], s84 offen offset:2048 lds
    v_mfma_f32_32x32x16_bf16 v[40:55], v[132:135], v[116:119], v[40:55]
    ds_read_b64_tr_b16 v[142:143], v159 offset:21504
    ds_read_b128 v[100:103], v155 offset:20480
    v_mfma_f32_32x32x16_bf16 v[56:71], v[148:151], v[116:119], v[56:71]
    buffer_load_dwordx4 v163, s[44:47], s84 offen offset:3072 lds
    s_waitcnt lgkmcnt(6)
    v_mfma_f32_32x32x16_bf16 v[8:23], v[120:123], v[88:91], v[8:23]
    ds_read_b128 v[104:107], v156 offset:16384
    ds_read_b64_tr_b16 v[128:129], v158 offset:24576
    s_add_u32 m0, s86, 114688
    v_mfma_f32_32x32x16_bf16 v[24:39], v[136:139], v[88:91], v[24:39]
    ds_read_b64_tr_b16 v[130:131], v158 offset:25600
    ds_read_b64_tr_b16 v[144:145], v159 offset:24576
    buffer_load_dwordx4 v164, s[48:51], s85 offen offset:0 lds
    v_mfma_f32_32x32x16_bf16 v[40:55], v[120:123], v[92:95], v[40:55]
    ds_read_b64_tr_b16 v[146:147], v159 offset:25600
    ds_read_b128 v[108:111], v156 offset:20480
    v_mfma_f32_32x32x16_bf16 v[56:71], v[136:139], v[92:95], v[56:71]
    buffer_load_dwordx4 v165, s[48:51], s85 offen offset:1024 lds
    s_waitcnt lgkmcnt(6)
    v_mfma_f32_32x32x16_bf16 v[8:23], v[124:127], v[96:99], v[8:23]
    ds_read_b128 v[112:115], v157 offset:16384
    ds_read_b64_tr_b16 v[132:133], v158 offset:28672
    v_mfma_f32_32x32x16_bf16 v[24:39], v[140:143], v[96:99], v[24:39]
    ds_read_b64_tr_b16 v[134:135], v158 offset:29696
    ds_read_b64_tr_b16 v[148:149], v159 offset:28672
    buffer_load_dwordx4 v166, s[48:51], s85 offen offset:2048 lds
    v_mfma_f32_32x32x16_bf16 v[40:55], v[124:127], v[100:103], v[40:55]
    ds_read_b64_tr_b16 v[150:151], v159 offset:29696
    ds_read_b128 v[116:119], v157 offset:20480
    v_mfma_f32_32x32x16_bf16 v[56:71], v[140:143], v[100:103], v[56:71]
    buffer_load_dwordx4 v167, s[48:51], s85 offen offset:3072 lds
    s_waitcnt vmcnt(8)
    s_barrier
    s_waitcnt lgkmcnt(6)
    v_mfma_f32_32x32x16_bf16 v[8:23], v[128:131], v[104:107], v[8:23]
    ds_read_b128 v[88:91], v154 offset:32768
    ds_read_b64_tr_b16 v[120:121], v158 offset:32768
    s_bfe_u32 s21, s83, 0x40000
    s_add_u32 m0, s86, 0
    v_mfma_f32_32x32x16_bf16 v[24:39], v[144:147], v[104:107], v[24:39]
    ds_read_b64_tr_b16 v[122:123], v158 offset:33792
    ds_read_b64_tr_b16 v[136:137], v159 offset:32768
    s_lshl_b32 s84, s21, 7
    s_mul_i32 s85, s21, 245760
    buffer_load_dwordx4 v160, s[44:47], s84 offen offset:0 lds
    v_mfma_f32_32x32x16_bf16 v[40:55], v[128:131], v[108:111], v[40:55]
    ds_read_b64_tr_b16 v[138:139], v159 offset:33792
    ds_read_b128 v[92:95], v154 offset:36864
    v_mfma_f32_32x32x16_bf16 v[56:71], v[144:147], v[108:111], v[56:71]
    buffer_load_dwordx4 v161, s[44:47], s84 offen offset:1024 lds
    s_waitcnt lgkmcnt(6)
    v_mfma_f32_32x32x16_bf16 v[8:23], v[132:135], v[112:115], v[8:23]
    ds_read_b128 v[96:99], v155 offset:32768
    ds_read_b64_tr_b16 v[124:125], v158 offset:36864
    v_mfma_f32_32x32x16_bf16 v[24:39], v[148:151], v[112:115], v[24:39]
    ds_read_b64_tr_b16 v[126:127], v158 offset:37888
    ds_read_b64_tr_b16 v[140:141], v159 offset:36864
    buffer_load_dwordx4 v162, s[44:47], s84 offen offset:2048 lds
    v_mfma_f32_32x32x16_bf16 v[40:55], v[132:135], v[116:119], v[40:55]
    ds_read_b64_tr_b16 v[142:143], v159 offset:37888
    ds_read_b128 v[100:103], v155 offset:36864
    v_mfma_f32_32x32x16_bf16 v[56:71], v[148:151], v[116:119], v[56:71]
    buffer_load_dwordx4 v163, s[44:47], s84 offen offset:3072 lds
    s_waitcnt lgkmcnt(6)
    v_mfma_f32_32x32x16_bf16 v[8:23], v[120:123], v[88:91], v[8:23]
    ds_read_b128 v[104:107], v156 offset:32768
    ds_read_b64_tr_b16 v[128:129], v158 offset:40960
    s_add_u32 m0, s86, 65536
    v_mfma_f32_32x32x16_bf16 v[24:39], v[136:139], v[88:91], v[24:39]
    ds_read_b64_tr_b16 v[130:131], v158 offset:41984
    ds_read_b64_tr_b16 v[144:145], v159 offset:40960
    buffer_load_dwordx4 v164, s[48:51], s85 offen offset:0 lds
    v_mfma_f32_32x32x16_bf16 v[40:55], v[120:123], v[92:95], v[40:55]
    ds_read_b64_tr_b16 v[146:147], v159 offset:41984
    ds_read_b128 v[108:111], v156 offset:36864
    v_mfma_f32_32x32x16_bf16 v[56:71], v[136:139], v[92:95], v[56:71]
    buffer_load_dwordx4 v165, s[48:51], s85 offen offset:1024 lds
    s_waitcnt lgkmcnt(6)
    v_mfma_f32_32x32x16_bf16 v[8:23], v[124:127], v[96:99], v[8:23]
    ds_read_b128 v[112:115], v157 offset:32768
    ds_read_b64_tr_b16 v[132:133], v158 offset:45056
    v_mfma_f32_32x32x16_bf16 v[24:39], v[140:143], v[96:99], v[24:39]
    ds_read_b64_tr_b16 v[134:135], v158 offset:46080
    ds_read_b64_tr_b16 v[148:149], v159 offset:45056
    buffer_load_dwordx4 v166, s[48:51], s85 offen offset:2048 lds
    v_mfma_f32_32x32x16_bf16 v[40:55], v[124:127], v[100:103], v[40:55]
    ds_read_b64_tr_b16 v[150:151], v159 offset:46080
    ds_read_b128 v[116:119], v157 offset:36864
    v_mfma_f32_32x32x16_bf16 v[56:71], v[140:143], v[100:103], v[56:71]
    buffer_load_dwordx4 v167, s[48:51], s85 offen offset:3072 lds
    s_waitcnt vmcnt(8)
    s_barrier
    s_waitcnt lgkmcnt(6)
    v_mfma_f32_32x32x16_bf16 v[8:23], v[128:131], v[104:107], v[8:23]
    ds_read_b128 v[88:91], v154 offset:49152
    ds_read_b64_tr_b16 v[120:121], v158 offset:49152
    s_bfe_u32 s21, s83, 0x40004
    s_add_u32 m0, s86, 16384
    v_mfma_f32_32x32x16_bf16 v[24:39], v[144:147], v[104:107], v[24:39]
    ds_read_b64_tr_b16 v[122:123], v158 offset:50176
    ds_read_b64_tr_b16 v[136:137], v159 offset:49152
    s_lshl_b32 s84, s21, 7
    s_mul_i32 s85, s21, 245760
    buffer_load_dwordx4 v160, s[44:47], s84 offen offset:0 lds
    v_mfma_f32_32x32x16_bf16 v[40:55], v[128:131], v[108:111], v[40:55]
    ds_read_b64_tr_b16 v[138:139], v159 offset:50176
    ds_read_b128 v[92:95], v154 offset:53248
    v_mfma_f32_32x32x16_bf16 v[56:71], v[144:147], v[108:111], v[56:71]
    buffer_load_dwordx4 v161, s[44:47], s84 offen offset:1024 lds
    s_waitcnt lgkmcnt(6)
    v_mfma_f32_32x32x16_bf16 v[8:23], v[132:135], v[112:115], v[8:23]
    ds_read_b128 v[96:99], v155 offset:49152
    ds_read_b64_tr_b16 v[124:125], v158 offset:53248
    v_mfma_f32_32x32x16_bf16 v[24:39], v[148:151], v[112:115], v[24:39]
    ds_read_b64_tr_b16 v[126:127], v158 offset:54272
    ds_read_b64_tr_b16 v[140:141], v159 offset:53248
    buffer_load_dwordx4 v162, s[44:47], s84 offen offset:2048 lds
    v_mfma_f32_32x32x16_bf16 v[40:55], v[132:135], v[116:119], v[40:55]
    ds_read_b64_tr_b16 v[142:143], v159 offset:54272
    ds_read_b128 v[100:103], v155 offset:53248
    v_mfma_f32_32x32x16_bf16 v[56:71], v[148:151], v[116:119], v[56:71]
    buffer_load_dwordx4 v163, s[44:47], s84 offen offset:3072 lds
    s_waitcnt lgkmcnt(6)
    v_mfma_f32_32x32x16_bf16 v[8:23], v[120:123], v[88:91], v[8:23]
    ds_read_b128 v[104:107], v156 offset:49152
    ds_read_b64_tr_b16 v[128:129], v158 offset:57344
    s_add_u32 m0, s86, 81920
    v_mfma_f32_32x32x16_bf16 v[24:39], v[136:139], v[88:91], v[24:39]
    ds_read_b64_tr_b16 v[130:131], v158 offset:58368
    ds_read_b64_tr_b16 v[144:145], v159 offset:57344
    buffer_load_dwordx4 v164, s[48:51], s85 offen offset:0 lds
    v_mfma_f32_32x32x16_bf16 v[40:55], v[120:123], v[92:95], v[40:55]
    ds_read_b64_tr_b16 v[146:147], v159 offset:58368
    ds_read_b128 v[108:111], v156 offset:53248
    v_mfma_f32_32x32x16_bf16 v[56:71], v[136:139], v[92:95], v[56:71]
    buffer_load_dwordx4 v165, s[48:51], s85 offen offset:1024 lds
    s_waitcnt lgkmcnt(6)
    v_mfma_f32_32x32x16_bf16 v[8:23], v[124:127], v[96:99], v[8:23]
    ds_read_b128 v[112:115], v157 offset:49152
    ds_read_b64_tr_b16 v[132:133], v158 offset:61440
    v_mfma_f32_32x32x16_bf16 v[24:39], v[140:143], v[96:99], v[24:39]
    ds_read_b64_tr_b16 v[134:135], v158 offset:62464
    ds_read_b64_tr_b16 v[148:149], v159 offset:61440
    buffer_load_dwordx4 v166, s[48:51], s85 offen offset:2048 lds
    v_mfma_f32_32x32x16_bf16 v[40:55], v[124:127], v[100:103], v[40:55]
    ds_read_b64_tr_b16 v[150:151], v159 offset:62464
    ds_read_b128 v[116:119], v157 offset:53248
    v_mfma_f32_32x32x16_bf16 v[56:71], v[140:143], v[100:103], v[56:71]
    buffer_load_dwordx4 v167, s[48:51], s85 offen offset:3072 lds
    s_waitcnt vmcnt(8)
    s_barrier
    s_waitcnt lgkmcnt(6)
    v_mfma_f32_32x32x16_bf16 v[8:23], v[128:131], v[104:107], v[8:23]
    ds_read_b128 v[88:91], v154 offset:0
    ds_read_b64_tr_b16 v[120:121], v158 offset:0
    v_mfma_f32_32x32x16_bf16 v[24:39], v[144:147], v[104:107], v[24:39]
    ds_read_b64_tr_b16 v[122:123], v158 offset:1024
    ds_read_b64_tr_b16 v[136:137], v159 offset:0
    v_mfma_f32_32x32x16_bf16 v[40:55], v[128:131], v[108:111], v[40:55]
    ds_read_b64_tr_b16 v[138:139], v159 offset:1024
    ds_read_b128 v[92:95], v154 offset:4096
    v_mfma_f32_32x32x16_bf16 v[56:71], v[144:147], v[108:111], v[56:71]
    s_waitcnt lgkmcnt(6)
    v_mfma_f32_32x32x16_bf16 v[8:23], v[132:135], v[112:115], v[8:23]
    ds_read_b128 v[96:99], v155 offset:0
    ds_read_b64_tr_b16 v[124:125], v158 offset:4096
    v_mfma_f32_32x32x16_bf16 v[24:39], v[148:151], v[112:115], v[24:39]
    ds_read_b64_tr_b16 v[126:127], v158 offset:5120
    ds_read_b64_tr_b16 v[140:141], v159 offset:4096
    v_mfma_f32_32x32x16_bf16 v[40:55], v[132:135], v[116:119], v[40:55]
    ds_read_b64_tr_b16 v[142:143], v159 offset:5120
    ds_read_b128 v[100:103], v155 offset:4096
    v_mfma_f32_32x32x16_bf16 v[56:71], v[148:151], v[116:119], v[56:71]
    s_waitcnt lgkmcnt(6)
    v_mfma_f32_32x32x16_bf16 v[8:23], v[120:123], v[88:91], v[8:23]
    ds_read_b128 v[104:107], v156 offset:0
    ds_read_b64_tr_b16 v[128:129], v158 offset:8192
    v_mfma_f32_32x32x16_bf16 v[24:39], v[136:139], v[88:91], v[24:39]
    ds_read_b64_tr_b16 v[130:131], v158 offset:9216
    ds_read_b64_tr_b16 v[144:145], v159 offset:8192
    v_mfma_f32_32x32x16_bf16 v[40:55], v[120:123], v[92:95], v[40:55]
    ds_read_b64_tr_b16 v[146:147], v159 offset:9216
    ds_read_b128 v[108:111], v156 offset:4096
    v_mfma_f32_32x32x16_bf16 v[56:71], v[136:139], v[92:95], v[56:71]
    s_waitcnt lgkmcnt(6)
    v_mfma_f32_32x32x16_bf16 v[8:23], v[124:127], v[96:99], v[8:23]
    ds_read_b128 v[112:115], v157 offset:0
    ds_read_b64_tr_b16 v[132:133], v158 offset:12288
    v_mfma_f32_32x32x16_bf16 v[24:39], v[140:143], v[96:99], v[24:39]
    ds_read_b64_tr_b16 v[134:135], v158 offset:13312
    ds_read_b64_tr_b16 v[148:149], v159 offset:12288
    v_mfma_f32_32x32x16_bf16 v[40:55], v[124:127], v[100:103], v[40:55]
    ds_read_b64_tr_b16 v[150:151], v159 offset:13312
    ds_read_b128 v[116:119], v157 offset:4096
    v_mfma_f32_32x32x16_bf16 v[56:71], v[140:143], v[100:103], v[56:71]
    s_waitcnt vmcnt(0)
    s_barrier
    s_waitcnt lgkmcnt(6)
    v_mfma_f32_32x32x16_bf16 v[8:23], v[128:131], v[104:107], v[8:23]
    ds_read_b128 v[88:91], v154 offset:16384
    ds_read_b64_tr_b16 v[120:121], v158 offset:16384
    v_mfma_f32_32x32x16_bf16 v[24:39], v[144:147], v[104:107], v[24:39]
    ds_read_b64_tr_b16 v[122:123], v158 offset:17408
    ds_read_b64_tr_b16 v[136:137], v159 offset:16384
    v_mfma_f32_32x32x16_bf16 v[40:55], v[128:131], v[108:111], v[40:55]
    ds_read_b64_tr_b16 v[138:139], v159 offset:17408
    ds_read_b128 v[92:95], v154 offset:20480
    buffer_load_dwordx2 v[168:169], v172, s[8:11], s80 offen sc1
    buffer_load_dword v76, v171, s[8:11], s87 offen sc1
    buffer_load_dword v77, v171, s[8:11], s87 offen offset:1024 sc1
    v_mfma_f32_32x32x16_bf16 v[56:71], v[144:147], v[108:111], v[56:71]
    s_waitcnt lgkmcnt(6)
    v_mfma_f32_32x32x16_bf16 v[8:23], v[132:135], v[112:115], v[8:23]
    ds_read_b128 v[96:99], v155 offset:16384
    ds_read_b64_tr_b16 v[124:125], v158 offset:20480
    s_mov_b32 s24, s30
    s_mov_b32 s25, s31
    v_mfma_f32_32x32x16_bf16 v[24:39], v[148:151], v[112:115], v[24:39]
    ds_read_b64_tr_b16 v[126:127], v158 offset:21504
    ds_read_b64_tr_b16 v[140:141], v159 offset:20480
    s_mov_b32 s26, 0xc00
    s_mov_b32 s27, 0x00020000
    s_lshl_b32 s23, s64, 1
    v_lshlrev_b32 v3, 3, v251
    v_mfma_f32_32x32x16_bf16 v[40:55], v[132:135], v[116:119], v[40:55]
    ds_read_b64_tr_b16 v[142:143], v159 offset:21504
    ds_read_b128 v[100:103], v155 offset:20480
    v_mfma_f32_32x32x16_bf16 v[56:71], v[148:151], v[116:119], v[56:71]
    s_waitcnt lgkmcnt(6)
    v_mfma_f32_32x32x16_bf16 v[8:23], v[120:123], v[88:91], v[8:23]
    ds_read_b128 v[104:107], v156 offset:16384
    ds_read_b64_tr_b16 v[128:129], v158 offset:24576
    buffer_load_dwordx2 v[210:211], v3, s[24:27], s23 offen offset:0
    buffer_load_dwordx2 v[212:213], v3, s[24:27], s23 offen offset:32
    v_mfma_f32_32x32x16_bf16 v[24:39], v[136:139], v[88:91], v[24:39]
    ds_read_b64_tr_b16 v[130:131], v158 offset:25600
    ds_read_b64_tr_b16 v[144:145], v159 offset:24576
    buffer_load_dwordx2 v[214:215], v3, s[24:27], s23 offen offset:64
    buffer_load_dwordx2 v[216:217], v3, s[24:27], s23 offen offset:96
    v_mfma_f32_32x32x16_bf16 v[40:55], v[120:123], v[92:95], v[40:55]
    ds_read_b64_tr_b16 v[146:147], v159 offset:25600
    ds_read_b128 v[108:111], v156 offset:20480
    v_mfma_f32_32x32x16_bf16 v[56:71], v[136:139], v[92:95], v[56:71]
    s_waitcnt lgkmcnt(6)
    v_mfma_f32_32x32x16_bf16 v[8:23], v[124:127], v[96:99], v[8:23]
    ds_read_b128 v[112:115], v157 offset:16384
    ds_read_b64_tr_b16 v[132:133], v158 offset:28672
    s_mov_b32 s24, s34
    s_mov_b32 s25, s35
    v_mfma_f32_32x32x16_bf16 v[24:39], v[140:143], v[96:99], v[24:39]
    ds_read_b64_tr_b16 v[134:135], v158 offset:29696
    ds_read_b64_tr_b16 v[148:149], v159 offset:28672
    s_mov_b32 s26, 0x1000
    s_mov_b32 s27, 0x00020000
    v_lshlrev_b32 v3, 1, v250
    s_lshl_b32 s23, s63, 1
    buffer_load_ushort v218, v3, s[24:27], s23 offen
    v_mfma_f32_32x32x16_bf16 v[40:55], v[124:127], v[100:103], v[40:55]
    ds_read_b64_tr_b16 v[150:151], v159 offset:29696
    ds_read_b128 v[116:119], v157 offset:20480
    v_mfma_f32_32x32x16_bf16 v[56:71], v[140:143], v[100:103], v[56:71]
    s_waitcnt lgkmcnt(6)
    v_mfma_f32_32x32x16_bf16 v[8:23], v[128:131], v[104:107], v[8:23]
    s_nop 0
    v_mfma_f32_32x32x16_bf16 v[24:39], v[144:147], v[104:107], v[24:39]
    v_mfma_f32_32x32x16_bf16 v[40:55], v[128:131], v[108:111], v[40:55]
    v_mfma_f32_32x32x16_bf16 v[56:71], v[144:147], v[108:111], v[56:71]
    s_waitcnt lgkmcnt(0)
    v_mfma_f32_32x32x16_bf16 v[8:23], v[132:135], v[112:115], v[8:23]
    s_cmp_lt_u32 s79, 5
    s_cselect_b32 s21, 0x3ea52b5c, 1.0
    s_waitcnt vmcnt(5)
    v_max3_u32 v78, v168, v76, v77
    v_cmp_eq_u32 vcc, -1, v78
    s_cbranch_vccz L_rompt_kernel_loopqj
    s_call_b64 s[92:93], L_rompt_kernel_spin2
L_rompt_kernel_loopqj:
    v_mul_f32 v168, s21, v168
    v_mul_f32 v169, s21, v169
    v_mfma_f32_32x32x16_bf16 v[24:39], v[148:151], v[112:115], v[24:39]
    ds_write_b32 v173, v168
    ds_write_b32 v173, v169 offset:512
    s_lshl_b32 s21, s61, 6
    s_lshl_b32 s22, s62, 5
    s_add_u32 s24, s21, s22
    s_lshl_b32 s23, s62, 6
    v_add_f32 v72, v76, v77
    v_mov_b32 v4, v72
    v_mfma_f32_32x32x16_bf16 v[40:55], v[132:135], v[116:119], v[40:55]
    v_add_lshl_u32 v3, v1, s24, 2
    v_add_u32 v3, 151552, v3
    v_permlane32_swap_b32 v72, v4
    s_nop 0
    v_add_f32 v72, v72, v4
    ds_write_b32 v3, v72 offset:1024
    v_mfma_f32_32x32x16_bf16 v[56:71], v[148:151], v[116:119], v[56:71]
    v_add_lshl_u32 v4, v1, s23, 2
    v_add_u32 v4, 151552, v4
    v_add_u32 v5, 128, v4
    v_lshlrev_b32 v6, 4, v2
    s_lshl_b32 s21, s24, 2
    s_add_u32 s21, s21, 151552
    v_add_u32 v6, s21, v6
    v_xor_b32 v7, 128, v6
    s_lshl_b32 s21, s79, 4
    s_lshl_b32 s22, s61, 3
    s_add_u32 s21, s21, s22
    v_add_u32 v3, s21, v2
    v_mul_u32_u24 v3, 2096, v3
    s_lshl_b32 s21, s78, 7
    s_add_u32 s21, s21, s23
    v_add3_u32 v3, v3, s21, v1
    v_lshlrev_b32 v3, 4, v3
    s_mul_i32 s43, s62, 134144
    s_sub_u32 s22, 134144, s43
    s_waitcnt lgkmcnt(0)
    s_barrier
    ds_read2st64_b32 v[88:89], v4 offset0:0 offset1:2
    ds_read2st64_b32 v[90:91], v5 offset0:0 offset1:2
    ds_read_b128 v[92:95], v6 offset:1024
    ds_read_b128 v[96:99], v6 offset:1056
    ds_read_b128 v[100:103], v6 offset:1088
    ds_read_b128 v[104:107], v6 offset:1120
    ds_read_b128 v[108:111], v7 offset:1024
    ds_read_b128 v[112:115], v7 offset:1056
    ds_read_b128 v[116:119], v7 offset:1088
    ds_read_b128 v[120:123], v7 offset:1120
    s_waitcnt lgkmcnt(4)
    v_pk_mul_f32 v[8:9], v[8:9], v[88:89] op_sel_hi:[1,0]
    v_pk_fma_f32 v[8:9], v[92:93], v[88:89], v[8:9] op_sel:[0,1,0] op_sel_hi:[1,1,1]
    v_pk_mul_f32 v[10:11], v[10:11], v[88:89] op_sel_hi:[1,0]
    v_pk_fma_f32 v[10:11], v[94:95], v[88:89], v[10:11] op_sel:[0,1,0] op_sel_hi:[1,1,1]
    v_pk_mul_f32 v[12:13], v[12:13], v[88:89] op_sel_hi:[1,0]
    v_pk_fma_f32 v[12:13], v[96:97], v[88:89], v[12:13] op_sel:[0,1,0] op_sel_hi:[1,1,1]
    v_pk_mul_f32 v[14:15], v[14:15], v[88:89] op_sel_hi:[1,0]
    v_pk_fma_f32 v[14:15], v[98:99], v[88:89], v[14:15] op_sel:[0,1,0] op_sel_hi:[1,1,1]
    v_cvt_pk_bf16_f32 v124, v8, v9
    v_cvt_pk_bf16_f32 v125, v10, v11
    v_cvt_pk_bf16_f32 v126, v12, v13
    v_cvt_pk_bf16_f32 v127, v14, v15
    s_add_u32 s21, s43, 0
    buffer_store_dwordx4 v[124:127], v3, s[8:11], s21 offen offset:0 sc1
    v_pk_mul_f32 v[16:17], v[16:17], v[88:89] op_sel_hi:[1,0]
    v_pk_fma_f32 v[16:17], v[100:101], v[88:89], v[16:17] op_sel:[0,1,0] op_sel_hi:[1,1,1]
    v_pk_mul_f32 v[18:19], v[18:19], v[88:89] op_sel_hi:[1,0]
    v_pk_fma_f32 v[18:19], v[102:103], v[88:89], v[18:19] op_sel:[0,1,0] op_sel_hi:[1,1,1]
    v_pk_mul_f32 v[20:21], v[20:21], v[88:89] op_sel_hi:[1,0]
    v_pk_fma_f32 v[20:21], v[104:105], v[88:89], v[20:21] op_sel:[0,1,0] op_sel_hi:[1,1,1]
    v_pk_mul_f32 v[22:23], v[22:23], v[88:89] op_sel_hi:[1,0]
    v_pk_fma_f32 v[22:23], v[106:107], v[88:89], v[22:23] op_sel:[0,1,0] op_sel_hi:[1,1,1]
    v_cvt_pk_bf16_f32 v128, v16, v17
    v_cvt_pk_bf16_f32 v129, v18, v19
    v_cvt_pk_bf16_f32 v130, v20, v21
    v_cvt_pk_bf16_f32 v131, v22, v23
    s_add_u32 s21, s43, 67072
    buffer_store_dwordx4 v[128:131], v3, s[8:11], s21 offen offset:0 sc1
    v_pk_mul_f32 v[40:41], v[40:41], v[90:91] op_sel_hi:[1,0]
    v_pk_fma_f32 v[40:41], v[92:93], v[90:91], v[40:41] op_sel:[0,1,0] op_sel_hi:[1,1,1]
    v_pk_mul_f32 v[42:43], v[42:43], v[90:91] op_sel_hi:[1,0]
    v_pk_fma_f32 v[42:43], v[94:95], v[90:91], v[42:43] op_sel:[0,1,0] op_sel_hi:[1,1,1]
    v_pk_mul_f32 v[44:45], v[44:45], v[90:91] op_sel_hi:[1,0]
    v_pk_fma_f32 v[44:45], v[96:97], v[90:91], v[44:45] op_sel:[0,1,0] op_sel_hi:[1,1,1]
    v_pk_mul_f32 v[46:47], v[46:47], v[90:91] op_sel_hi:[1,0]
    v_pk_fma_f32 v[46:47], v[98:99], v[90:91], v[46:47] op_sel:[0,1,0] op_sel_hi:[1,1,1]
    v_cvt_pk_bf16_f32 v132, v40, v41
    v_cvt_pk_bf16_f32 v133, v42, v43
    v_cvt_pk_bf16_f32 v134, v44, v45
    v_cvt_pk_bf16_f32 v135, v46, v47
    s_add_u32 s21, s43, 0
    buffer_store_dwordx4 v[132:135], v3, s[8:11], s21 offen offset:512 sc1
    v_pk_mul_f32 v[48:49], v[48:49], v[90:91] op_sel_hi:[1,0]
    v_pk_fma_f32 v[48:49], v[100:101], v[90:91], v[48:49] op_sel:[0,1,0] op_sel_hi:[1,1,1]
    v_pk_mul_f32 v[50:51], v[50:51], v[90:91] op_sel_hi:[1,0]
    v_pk_fma_f32 v[50:51], v[102:103], v[90:91], v[50:51] op_sel:[0,1,0] op_sel_hi:[1,1,1]
    v_pk_mul_f32 v[52:53], v[52:53], v[90:91] op_sel_hi:[1,0]
    v_pk_fma_f32 v[52:53], v[104:105], v[90:91], v[52:53] op_sel:[0,1,0] op_sel_hi:[1,1,1]
    v_pk_mul_f32 v[54:55], v[54:55], v[90:91] op_sel_hi:[1,0]
    v_pk_fma_f32 v[54:55], v[106:107], v[90:91], v[54:55] op_sel:[0,1,0] op_sel_hi:[1,1,1]
    v_cvt_pk_bf16_f32 v136, v48, v49
    v_cvt_pk_bf16_f32 v137, v50, v51
    v_cvt_pk_bf16_f32 v138, v52, v53
    v_cvt_pk_bf16_f32 v139, v54, v55
    s_add_u32 s21, s43, 67072
    buffer_store_dwordx4 v[136:139], v3, s[8:11], s21 offen offset:512 sc1
    s_waitcnt lgkmcnt(0)
    v_pk_mul_f32 v[24:25], v[24:25], v[88:89] op_sel_hi:[1,0]
    v_pk_fma_f32 v[24:25], v[108:109], v[88:89], v[24:25] op_sel:[0,1,0] op_sel_hi:[1,1,1]
    v_pk_mul_f32 v[26:27], v[26:27], v[88:89] op_sel_hi:[1,0]
    v_pk_fma_f32 v[26:27], v[110:111], v[88:89], v[26:27] op_sel:[0,1,0] op_sel_hi:[1,1,1]
    v_pk_mul_f32 v[28:29], v[28:29], v[88:89] op_sel_hi:[1,0]
    v_pk_fma_f32 v[28:29], v[112:113], v[88:89], v[28:29] op_sel:[0,1,0] op_sel_hi:[1,1,1]
    v_pk_mul_f32 v[30:31], v[30:31], v[88:89] op_sel_hi:[1,0]
    v_pk_fma_f32 v[30:31], v[114:115], v[88:89], v[30:31] op_sel:[0,1,0] op_sel_hi:[1,1,1]
    v_cvt_pk_bf16_f32 v124, v24, v25
    v_cvt_pk_bf16_f32 v125, v26, v27
    v_cvt_pk_bf16_f32 v126, v28, v29
    v_cvt_pk_bf16_f32 v127, v30, v31
    s_add_u32 s21, s22, 0
    buffer_store_dwordx4 v[124:127], v3, s[8:11], s21 offen offset:0 sc1
    v_pk_mul_f32 v[32:33], v[32:33], v[88:89] op_sel_hi:[1,0]
    v_pk_fma_f32 v[32:33], v[116:117], v[88:89], v[32:33] op_sel:[0,1,0] op_sel_hi:[1,1,1]
    v_pk_mul_f32 v[34:35], v[34:35], v[88:89] op_sel_hi:[1,0]
    v_pk_fma_f32 v[34:35], v[118:119], v[88:89], v[34:35] op_sel:[0,1,0] op_sel_hi:[1,1,1]
    v_pk_mul_f32 v[36:37], v[36:37], v[88:89] op_sel_hi:[1,0]
    v_pk_fma_f32 v[36:37], v[120:121], v[88:89], v[36:37] op_sel:[0,1,0] op_sel_hi:[1,1,1]
    v_pk_mul_f32 v[38:39], v[38:39], v[88:89] op_sel_hi:[1,0]
    v_pk_fma_f32 v[38:39], v[122:123], v[88:89], v[38:39] op_sel:[0,1,0] op_sel_hi:[1,1,1]
    v_cvt_pk_bf16_f32 v128, v32, v33
    v_cvt_pk_bf16_f32 v129, v34, v35
    v_cvt_pk_bf16_f32 v130, v36, v37
    v_cvt_pk_bf16_f32 v131, v38, v39
    s_add_u32 s21, s22, 67072
    buffer_store_dwordx4 v[128:131], v3, s[8:11], s21 offen offset:0 sc1
    v_pk_mul_f32 v[56:57], v[56:57], v[90:91] op_sel_hi:[1,0]
    v_pk_fma_f32 v[56:57], v[108:109], v[90:91], v[56:57] op_sel:[0,1,0] op_sel_hi:[1,1,1]
    v_pk_mul_f32 v[58:59], v[58:59], v[90:91] op_sel_hi:[1,0]
    v_pk_fma_f32 v[58:59], v[110:111], v[90:91], v[58:59] op_sel:[0,1,0] op_sel_hi:[1,1,1]
    v_pk_mul_f32 v[60:61], v[60:61], v[90:91] op_sel_hi:[1,0]
    v_pk_fma_f32 v[60:61], v[112:113], v[90:91], v[60:61] op_sel:[0,1,0] op_sel_hi:[1,1,1]
    v_pk_mul_f32 v[62:63], v[62:63], v[90:91] op_sel_hi:[1,0]
    v_pk_fma_f32 v[62:63], v[114:115], v[90:91], v[62:63] op_sel:[0,1,0] op_sel_hi:[1,1,1]
    v_cvt_pk_bf16_f32 v132, v56, v57
    v_cvt_pk_bf16_f32 v133, v58, v59
    v_cvt_pk_bf16_f32 v134, v60, v61
    v_cvt_pk_bf16_f32 v135, v62, v63
    s_add_u32 s21, s22, 0
    buffer_store_dwordx4 v[132:135], v3, s[8:11], s21 offen offset:512 sc1
    v_pk_mul_f32 v[64:65], v[64:65], v[90:91] op_sel_hi:[1,0]
    v_pk_fma_f32 v[64:65], v[116:117], v[90:91], v[64:65] op_sel:[0,1,0] op_sel_hi:[1,1,1]
    v_pk_mul_f32 v[66:67], v[66:67], v[90:91] op_sel_hi:[1,0]
    v_pk_fma_f32 v[66:67], v[118:119], v[90:91], v[66:67] op_sel:[0,1,0] op_sel_hi:[1,1,1]
    v_pk_mul_f32 v[68:69], v[68:69], v[90:91] op_sel_hi:[1,0]
    v_pk_fma_f32 v[68:69], v[120:121], v[90:91], v[68:69] op_sel:[0,1,0] op_sel_hi:[1,1,1]
    v_pk_mul_f32 v[70:71], v[70:71], v[90:91] op_sel_hi:[1,0]
    v_pk_fma_f32 v[70:71], v[122:123], v[90:91], v[70:71] op_sel:[0,1,0] op_sel_hi:[1,1,1]
    v_cvt_pk_bf16_f32 v136, v64, v65
    v_cvt_pk_bf16_f32 v137, v66, v67
    v_cvt_pk_bf16_f32 v138, v68, v69
    v_cvt_pk_bf16_f32 v139, v70, v71
    s_add_u32 s21, s22, 67072
    buffer_store_dwordx4 v[136:139], v3, s[8:11], s21 offen offset:512 sc1
    s_branch L_rompt_kernel_adone
L_rompt_kernel_sub:
    s_mov_b32 s24, 0x3f803f80
    v_mov_b32 v3, 0
    v_mov_b32 v4, 0
    v_mov_b32 v5, 0
    v_mov_b32 v6, 0
    v_dot2c_f32_bf16 v3, s24, v176
    v_dot2c_f32_bf16 v4, v176, v176
    v_dot2c_f32_bf16 v5, s24, v177
    v_dot2c_f32_bf16 v6, v177, v177
    v_dot2c_f32_bf16 v3, s24, v178
    v_dot2c_f32_bf16 v4, v178, v178
    v_dot2c_f32_bf16 v5, s24, v179
    v_dot2c_f32_bf16 v6, v179, v179
    v_dot2c_f32_bf16 v3, s24, v180
    v_dot2c_f32_bf16 v4, v180, v180
    v_dot2c_f32_bf16 v5, s24, v181
    v_dot2c_f32_bf16 v6, v181, v181
    v_dot2c_f32_bf16 v3, s24, v182
    v_dot2c_f32_bf16 v4, v182, v182
    v_dot2c_f32_bf16 v5, s24, v183
    v_dot2c_f32_bf16 v6, v183, v183
    v_dot2c_f32_bf16 v3, s24, v184
    v_dot2c_f32_bf16 v4, v184, v184
    v_dot2c_f32_bf16 v5, s24, v185
    v_dot2c_f32_bf16 v6, v185, v185
    v_dot2c_f32_bf16 v3, s24, v186
    v_dot2c_f32_bf16 v4, v186, v186
    v_dot2c_f32_bf16 v5, s24, v187
    v_dot2c_f32_bf16 v6, v187, v187
    s_nop 2
    v_add_f32 v176, v3, v5
    v_add_f32 v177, v4, v6
    s_nop 0
    v_add_f32_dpp v176, v176, v176 quad_perm:[1,0,3,2] row_mask:0xf bank_mask:0xf
    v_add_f32_dpp v177, v177, v177 quad_perm:[1,0,3,2] row_mask:0xf bank_mask:0xf
    s_nop 0
    v_add_f32_dpp v176, v176, v176 quad_perm:[2,3,0,1] row_mask:0xf bank_mask:0xf
    v_add_f32_dpp v177, v177, v177 quad_perm:[2,3,0,1] row_mask:0xf bank_mask:0xf
    s_nop 0
    v_add_f32_dpp v176, v176, v176 row_half_mirror row_mask:0xf bank_mask:0xf
    v_add_f32_dpp v177, v177, v177 row_half_mirror row_mask:0xf bank_mask:0xf
    s_nop 0
    v_add_f32_dpp v176, v176, v176 row_mirror row_mask:0xf bank_mask:0xf
    v_add_f32_dpp v177, v177, v177 row_mirror row_mask:0xf bank_mask:0xf
    s_nop 0
    v_mov_b32 v178, v176
    v_mov_b32 v179, v177
    s_nop 0
    v_permlane16_swap_b32 v176, v178
    v_permlane16_swap_b32 v177, v179
    s_nop 0
    v_add_f32 v176, v176, v178
    v_add_f32 v177, v177, v179
    v_mul_f32 v176, 0x3acccccd, v176
    v_mul_f32 v177, 0x3acccccd, v177
    v_fma_f32 v177, -v176, v176, v177
    v_max_f32 v177, 0, v177
    v_add_f32 v177, 0x3727c5ac, v177
    v_rsq_f32 v178, v177
    v_and_b32 v3, 3, v0
    v_mul_f32 v179, v176, v178
    v_sub_f32 v179, 0, v179
    v_lshlrev_b32 v3, 4, v3
    v_lshl_add_u32 v180, v2, 6, v3
    v_min_u32 v178, -2, v178
    s_lshl_b32 s91, s91, 7
    s_add_u32 s91, s91, 16571136
    s_setpc_b64 s[92:93]
L_rompt_kernel_spin:
    s_mov_b32 s23, 0x200000
L_rompt_kernel_spinh:
    s_sleep 8
    buffer_load_dword v170, off, s[52:55], 0 sc1
    s_sub_u32 s23, s23, 1
    s_waitcnt vmcnt(0)
    s_cbranch_scc1 L_rompt_kernel_spini
    v_cmp_gt_u32 vcc, 16, v170
    s_cbranch_vccnz L_rompt_kernel_spinh
L_rompt_kernel_spini:
    s_setpc_b64 s[92:93]
L_rompt_kernel_spin2:
    s_mov_b32 s23, 0x200000
L_rompt_kernel_spin2h:
    buffer_load_dwordx2 v[168:169], v172, s[8:11], s80 offen sc1
    buffer_load_dword v76, v171, s[8:11], s87 offen sc1
    buffer_load_dword v77, v171, s[8:11], s87 offen offset:1024 sc1
    s_sub_u32 s23, s23, 1
    s_waitcnt vmcnt(0)
    s_cbranch_scc1 L_rompt_kernel_spin2i
    v_max3_u32 v78, v168, v76, v77
    v_cmp_eq_u32 vcc, -1, v78
    s_cbranch_vccnz L_rompt_kernel_spin2h
L_rompt_kernel_spin2i:
    s_setpc_b64 s[92:93]
L_rompt_kernel_loopv:
    s_waitcnt vmcnt(11)
    s_barrier
    ds_read_b128 v[88:91], v154 offset:0
    ds_read_b64_tr_b16 v[120:121], v158 offset:0
    ds_read_b64_tr_b16 v[122:123], v158 offset:1024
    ds_read_b64_tr_b16 v[136:137], v159 offset:0
    ds_read_b64_tr_b16 v[138:139], v159 offset:1024
    ds_read_b128 v[92:95], v154 offset:4096
    ds_read_b128 v[96:99], v155 offset:0
    ds_read_b64_tr_b16 v[124:125], v158 offset:4096
    ds_read_b64_tr_b16 v[126:127], v158 offset:5120
    ds_read_b64_tr_b16 v[140:141], v159 offset:4096
    ds_read_b64_tr_b16 v[142:143], v159 offset:5120
    ds_read_b128 v[100:103], v155 offset:4096
    s_bfe_u32 s21, s82, 0x40008
    s_add_u32 m0, s86, 32768
    s_lshl_b32 s84, s21, 7
    s_mul_i32 s85, s21, 245760
    s_nop 0
    buffer_load_dwordx4 v160, s[44:47], s84 offen offset:0 lds
    buffer_load_dwordx4 v161, s[44:47], s84 offen offset:1024 lds
    buffer_load_dwordx4 v162, s[44:47], s84 offen offset:2048 lds
    buffer_load_dwordx4 v163, s[44:47], s84 offen offset:3072 lds
    s_waitcnt lgkmcnt(6)
    v_mfma_f32_32x32x16_bf16 v[8:23], v[88:91], v[120:123], v[8:23]
    ds_read_b128 v[104:107], v156 offset:0
    ds_read_b64_tr_b16 v[128:129], v158 offset:8192
    s_add_u32 m0, s86, 98304
    v_mfma_f32_32x32x16_bf16 v[24:39], v[88:91], v[136:139], v[24:39]
    ds_read_b64_tr_b16 v[130:131], v158 offset:9216
    ds_read_b64_tr_b16 v[144:145], v159 offset:8192
    buffer_load_dwordx4 v164, s[48:51], s85 offen offset:0 lds
    v_mfma_f32_32x32x16_bf16 v[40:55], v[92:95], v[120:123], v[40:55]
    ds_read_b64_tr_b16 v[146:147], v159 offset:9216
    ds_read_b128 v[108:111], v156 offset:4096
    v_mfma_f32_32x32x16_bf16 v[56:71], v[92:95], v[136:139], v[56:71]
    buffer_load_dwordx4 v165, s[48:51], s85 offen offset:1024 lds
    s_waitcnt lgkmcnt(6)
    v_mfma_f32_32x32x16_bf16 v[8:23], v[96:99], v[124:127], v[8:23]
    ds_read_b128 v[112:115], v157 offset:0
    ds_read_b64_tr_b16 v[132:133], v158 offset:12288
    v_mfma_f32_32x32x16_bf16 v[24:39], v[96:99], v[140:143], v[24:39]
    ds_read_b64_tr_b16 v[134:135], v158 offset:13312
    ds_read_b64_tr_b16 v[148:149], v159 offset:12288
    buffer_load_dwordx4 v166, s[48:51], s85 offen offset:2048 lds
    v_mfma_f32_32x32x16_bf16 v[40:55], v[100:103], v[124:127], v[40:55]
    ds_read_b64_tr_b16 v[150:151], v159 offset:13312
    ds_read_b128 v[116:119], v157 offset:4096
    v_mfma_f32_4x4x4_16b_bf16 v[72:75], v[152:153], v[120:121], v[72:75]
    v_mfma_f32_4x4x4_16b_bf16 v[76:79], v[152:153], v[122:123], v[76:79]
    v_mfma_f32_4x4x4_16b_bf16 v[80:83], v[152:153], v[124:125], v[80:83]
    v_mfma_f32_4x4x4_16b_bf16 v[84:87], v[152:153], v[126:127], v[84:87]
    v_mfma_f32_32x32x16_bf16 v[56:71], v[100:103], v[140:143], v[56:71]
    buffer_load_dwordx4 v167, s[48:51], s85 offen offset:3072 lds
    s_waitcnt vmcnt(16)
    s_call_b64 s[92:93], L_rompt_kernel_sub
    s_waitcnt vmcnt(8)
    s_barrier
    s_waitcnt lgkmcnt(6)
    v_mfma_f32_32x32x16_bf16 v[8:23], v[104:107], v[128:131], v[8:23]
    ds_read_b128 v[88:91], v154 offset:16384
    ds_read_b64_tr_b16 v[120:121], v158 offset:16384
    s_bfe_u32 s21, s82, 0x4000c
    s_add_u32 m0, s86, 49152
    v_mfma_f32_32x32x16_bf16 v[24:39], v[104:107], v[144:147], v[24:39]
    ds_read_b64_tr_b16 v[122:123], v158 offset:17408
    ds_read_b64_tr_b16 v[136:137], v159 offset:16384
    s_lshl_b32 s84, s21, 7
    s_mul_i32 s85, s21, 245760
    buffer_load_dwordx4 v160, s[44:47], s84 offen offset:0 lds
    v_mfma_f32_32x32x16_bf16 v[40:55], v[108:111], v[128:131], v[40:55]
    ds_read_b64_tr_b16 v[138:139], v159 offset:17408
    ds_read_b128 v[92:95], v154 offset:20480
    v_mfma_f32_32x32x16_bf16 v[56:71], v[108:111], v[144:147], v[56:71]
    buffer_load_dwordx4 v161, s[44:47], s84 offen offset:1024 lds
    s_waitcnt lgkmcnt(6)
    v_mfma_f32_32x32x16_bf16 v[8:23], v[112:115], v[132:135], v[8:23]
    ds_read_b128 v[96:99], v155 offset:16384
    ds_read_b64_tr_b16 v[124:125], v158 offset:20480
    v_mfma_f32_32x32x16_bf16 v[24:39], v[112:115], v[148:151], v[24:39]
    ds_read_b64_tr_b16 v[126:127], v158 offset:21504
    ds_read_b64_tr_b16 v[140:141], v159 offset:20480
    buffer_load_dwordx4 v162, s[44:47], s84 offen offset:2048 lds
    v_mfma_f32_32x32x16_bf16 v[40:55], v[116:119], v[132:135], v[40:55]
    ds_read_b64_tr_b16 v[142:143], v159 offset:21504
    ds_read_b128 v[100:103], v155 offset:20480
    v_mfma_f32_4x4x4_16b_bf16 v[72:75], v[152:153], v[128:129], v[72:75]
    v_mfma_f32_4x4x4_16b_bf16 v[76:79], v[152:153], v[130:131], v[76:79]
    v_mfma_f32_4x4x4_16b_bf16 v[80:83], v[152:153], v[132:133], v[80:83]
    v_mfma_f32_4x4x4_16b_bf16 v[84:87], v[152:153], v[134:135], v[84:87]
    v_mfma_f32_32x32x16_bf16 v[56:71], v[116:119], v[148:151], v[56:71]
    buffer_load_dwordx4 v163, s[44:47], s84 offen offset:3072 lds
    s_waitcnt lgkmcnt(6)
    v_mfma_f32_32x32x16_bf16 v[8:23], v[88:91], v[120:123], v[8:23]
    ds_read_b128 v[104:107], v156 offset:16384
    ds_read_b64_tr_b16 v[128:129], v158 offset:24576
    s_add_u32 m0, s86, 114688
    v_mfma_f32_32x32x16_bf16 v[24:39], v[88:91], v[136:139], v[24:39]
    ds_read_b64_tr_b16 v[130:131], v158 offset:25600
    ds_read_b64_tr_b16 v[144:145], v159 offset:24576
    buffer_load_dwordx4 v164, s[48:51], s85 offen offset:0 lds
    v_mfma_f32_32x32x16_bf16 v[40:55], v[92:95], v[120:123], v[40:55]
    ds_read_b64_tr_b16 v[146:147], v159 offset:25600
    ds_read_b128 v[108:111], v156 offset:20480
    v_mov_b32 v152, 0x3f803f80
    v_mov_b32 v153, 0x3f803f80
    v_mfma_f32_32x32x16_bf16 v[56:71], v[92:95], v[136:139], v[56:71]
    buffer_load_dwordx4 v165, s[48:51], s85 offen offset:1024 lds
    s_waitcnt lgkmcnt(6)
    v_mfma_f32_32x32x16_bf16 v[8:23], v[96:99], v[124:127], v[8:23]
    ds_read_b128 v[112:115], v157 offset:16384
    ds_read_b64_tr_b16 v[132:133], v158 offset:28672
    v_mfma_f32_32x32x16_bf16 v[24:39], v[96:99], v[140:143], v[24:39]
    ds_read_b64_tr_b16 v[134:135], v158 offset:29696
    ds_read_b64_tr_b16 v[148:149], v159 offset:28672
    buffer_load_dwordx4 v166, s[48:51], s85 offen offset:2048 lds
    v_mfma_f32_32x32x16_bf16 v[40:55], v[100:103], v[124:127], v[40:55]
    ds_read_b64_tr_b16 v[150:151], v159 offset:29696
    ds_read_b128 v[116:119], v157 offset:20480
    v_mfma_f32_4x4x4_16b_bf16 v[72:75], v[152:153], v[120:121], v[72:75]
    v_mfma_f32_4x4x4_16b_bf16 v[76:79], v[152:153], v[122:123], v[76:79]
    v_mfma_f32_4x4x4_16b_bf16 v[80:83], v[152:153], v[124:125], v[80:83]
    v_mfma_f32_4x4x4_16b_bf16 v[84:87], v[152:153], v[126:127], v[84:87]
    v_mfma_f32_32x32x16_bf16 v[56:71], v[100:103], v[140:143], v[56:71]
    buffer_load_dwordx4 v167, s[48:51], s85 offen offset:3072 lds
    s_waitcnt vmcnt(8)
    s_barrier
    s_waitcnt lgkmcnt(6)
    v_mfma_f32_32x32x16_bf16 v[8:23], v[104:107], v[128:131], v[8:23]
    ds_read_b128 v[88:91], v154 offset:32768
    ds_read_b64_tr_b16 v[120:121], v158 offset:32768
    s_bfe_u32 s21, s82, 0x40010
    s_add_u32 m0, s86, 0
    v_mfma_f32_32x32x16_bf16 v[24:39], v[104:107], v[144:147], v[24:39]
    ds_read_b64_tr_b16 v[122:123], v158 offset:33792
    ds_read_b64_tr_b16 v[136:137], v159 offset:32768
    s_lshl_b32 s84, s21, 7
    s_mul_i32 s85, s21, 245760
    buffer_load_dwordx4 v160, s[44:47], s84 offen offset:0 lds
    v_mfma_f32_32x32x16_bf16 v[40:55], v[108:111], v[128:131], v[40:55]
    ds_read_b64_tr_b16 v[138:139], v159 offset:33792
    ds_read_b128 v[92:95], v154 offset:36864
    buffer_load_dword v170, off, s[52:55], 0 sc1
    v_mfma_f32_32x32x16_bf16 v[56:71], v[108:111], v[144:147], v[56:71]
    buffer_load_dwordx4 v161, s[44:47], s84 offen offset:1024 lds
    s_waitcnt lgkmcnt(6)
    v_mfma_f32_32x32x16_bf16 v[8:23], v[112:115], v[132:135], v[8:23]
    ds_read_b128 v[96:99], v155 offset:32768
    ds_read_b64_tr_b16 v[124:125], v158 offset:36864
    v_mfma_f32_32x32x16_bf16 v[24:39], v[112:115], v[148:151], v[24:39]
    ds_read_b64_tr_b16 v[126:127], v158 offset:37888
    ds_read_b64_tr_b16 v[140:141], v159 offset:36864
    buffer_load_dwordx4 v162, s[44:47], s84 offen offset:2048 lds
    v_mfma_f32_32x32x16_bf16 v[40:55], v[116:119], v[132:135], v[40:55]
    ds_read_b64_tr_b16 v[142:143], v159 offset:37888
    ds_read_b128 v[100:103], v155 offset:36864
    v_mfma_f32_4x4x4_16b_bf16 v[72:75], v[152:153], v[128:129], v[72:75]
    v_mfma_f32_4x4x4_16b_bf16 v[76:79], v[152:153], v[130:131], v[76:79]
    v_mfma_f32_4x4x4_16b_bf16 v[80:83], v[152:153], v[132:133], v[80:83]
    v_mfma_f32_4x4x4_16b_bf16 v[84:87], v[152:153], v[134:135], v[84:87]
    v_mfma_f32_32x32x16_bf16 v[56:71], v[116:119], v[148:151], v[56:71]
    buffer_load_dwordx4 v163, s[44:47], s84 offen offset:3072 lds
    s_waitcnt lgkmcnt(6)
    v_mfma_f32_32x32x16_bf16 v[8:23], v[88:91], v[120:123], v[8:23]
    ds_read_b128 v[104:107], v156 offset:32768
    ds_read_b64_tr_b16 v[128:129], v158 offset:40960
    s_add_u32 m0, s86, 65536
    v_mfma_f32_32x32x16_bf16 v[24:39], v[88:91], v[136:139], v[24:39]
    ds_read_b64_tr_b16 v[130:131], v158 offset:41984
    ds_read_b64_tr_b16 v[144:145], v159 offset:40960
    buffer_load_dwordx4 v164, s[48:51], s85 offen offset:0 lds
    v_mfma_f32_32x32x16_bf16 v[40:55], v[92:95], v[120:123], v[40:55]
    ds_read_b64_tr_b16 v[146:147], v159 offset:41984
    ds_read_b128 v[108:111], v156 offset:36864
    v_mfma_f32_32x32x16_bf16 v[56:71], v[92:95], v[136:139], v[56:71]
    buffer_load_dwordx4 v165, s[48:51], s85 offen offset:1024 lds
    s_waitcnt lgkmcnt(6)
    v_mfma_f32_32x32x16_bf16 v[8:23], v[96:99], v[124:127], v[8:23]
    ds_read_b128 v[112:115], v157 offset:32768
    ds_read_b64_tr_b16 v[132:133], v158 offset:45056
    v_mfma_f32_32x32x16_bf16 v[24:39], v[96:99], v[140:143], v[24:39]
    ds_read_b64_tr_b16 v[134:135], v158 offset:46080
    ds_read_b64_tr_b16 v[148:149], v159 offset:45056
    buffer_load_dwordx4 v166, s[48:51], s85 offen offset:2048 lds
    v_mfma_f32_32x32x16_bf16 v[40:55], v[100:103], v[124:127], v[40:55]
    ds_read_b64_tr_b16 v[150:151], v159 offset:46080
    ds_read_b128 v[116:119], v157 offset:36864
    v_mfma_f32_4x4x4_16b_bf16 v[72:75], v[152:153], v[120:121], v[72:75]
    v_mfma_f32_4x4x4_16b_bf16 v[76:79], v[152:153], v[122:123], v[76:79]
    v_mfma_f32_4x4x4_16b_bf16 v[80:83], v[152:153], v[124:125], v[80:83]
    v_mfma_f32_4x4x4_16b_bf16 v[84:87], v[152:153], v[126:127], v[84:87]
    v_mfma_f32_32x32x16_bf16 v[56:71], v[100:103], v[140:143], v[56:71]
    buffer_load_dwordx4 v167, s[48:51], s85 offen offset:3072 lds
    s_waitcnt vmcnt(7)
    s_barrier
    s_waitcnt lgkmcnt(6)
    v_mfma_f32_32x32x16_bf16 v[8:23], v[104:107], v[128:131], v[8:23]
    ds_read_b128 v[88:91], v154 offset:49152
    ds_read_b64_tr_b16 v[120:121], v158 offset:49152
    s_bfe_u32 s21, s82, 0x40014
    s_add_u32 m0, s86, 16384
    v_mfma_f32_32x32x16_bf16 v[24:39], v[104:107], v[144:147], v[24:39]
    ds_read_b64_tr_b16 v[122:123], v158 offset:50176
    ds_read_b64_tr_b16 v[136:137], v159 offset:49152
    s_lshl_b32 s84, s21, 7
    s_mul_i32 s85, s21, 245760
    buffer_load_dwordx4 v160, s[44:47], s84 offen offset:0 lds
    v_mfma_f32_32x32x16_bf16 v[40:55], v[108:111], v[128:131], v[40:55]
    ds_read_b64_tr_b16 v[138:139], v159 offset:50176
    ds_read_b128 v[92:95], v154 offset:53248
    v_mfma_f32_32x32x16_bf16 v[56:71], v[108:111], v[144:147], v[56:71]
    buffer_load_dwordx4 v161, s[44:47], s84 offen offset:1024 lds
    v_cmp_gt_u32 vcc, 16, v170
    s_cbranch_vccz L_rompt_kernel_loopvi
    s_call_b64 s[92:93], L_rompt_kernel_spin
L_rompt_kernel_loopvi:
    s_mov_b32 exec_lo, 15
    s_mov_b32 exec_hi, 15
    buffer_store_dwordx4 v[176:179], v180, s[8:11], s91 offen sc1
    s_mov_b64 exec, -1
    s_waitcnt lgkmcnt(6)
    v_mfma_f32_32x32x16_bf16 v[8:23], v[112:115], v[132:135], v[8:23]
    ds_read_b128 v[96:99], v155 offset:49152
    ds_read_b64_tr_b16 v[124:125], v158 offset:53248
    v_mfma_f32_32x32x16_bf16 v[24:39], v[112:115], v[148:151], v[24:39]
    ds_read_b64_tr_b16 v[126:127], v158 offset:54272
    ds_read_b64_tr_b16 v[140:141], v159 offset:53248
    buffer_load_dwordx4 v162, s[44:47], s84 offen offset:2048 lds
    v_mfma_f32_32x32x16_bf16 v[40:55], v[116:119], v[132:135], v[40:55]
    ds_read_b64_tr_b16 v[142:143], v159 offset:54272
    ds_read_b128 v[100:103], v155 offset:53248
    v_mfma_f32_4x4x4_16b_bf16 v[72:75], v[152:153], v[128:129], v[72:75]
    v_mfma_f32_4x4x4_16b_bf16 v[76:79], v[152:153], v[130:131], v[76:79]
    v_mfma_f32_4x4x4_16b_bf16 v[80:83], v[152:153], v[132:133], v[80:83]
    v_mfma_f32_4x4x4_16b_bf16 v[84:87], v[152:153], v[134:135], v[84:87]
    v_mfma_f32_32x32x16_bf16 v[56:71], v[116:119], v[148:151], v[56:71]
    buffer_load_dwordx4 v163, s[44:47], s84 offen offset:3072 lds
    s_waitcnt lgkmcnt(6)
    v_mfma_f32_32x32x16_bf16 v[8:23], v[88:91], v[120:123], v[8:23]
    ds_read_b128 v[104:107], v156 offset:49152
    ds_read_b64_tr_b16 v[128:129], v158 offset:57344
    s_add_u32 m0, s86, 81920
    v_mfma_f32_32x32x16_bf16 v[24:39], v[88:91], v[136:139], v[24:39]
    ds_read_b64_tr_b16 v[130:131], v158 offset:58368
    ds_read_b64_tr_b16 v[144:145], v159 offset:57344
    buffer_load_dwordx4 v164, s[48:51], s85 offen offset:0 lds
    v_mfma_f32_32x32x16_bf16 v[40:55], v[92:95], v[120:123], v[40:55]
    ds_read_b64_tr_b16 v[146:147], v159 offset:58368
    ds_read_b128 v[108:111], v156 offset:53248
    v_add_f32 v72, v72, v76
    v_add_f32 v80, v80, v84
    v_add_f32 v72, v72, v80
    v_mov_b32 v73, v72
    v_mfma_f32_32x32x16_bf16 v[56:71], v[92:95], v[136:139], v[56:71]
    buffer_load_dwordx4 v165, s[48:51], s85 offen offset:1024 lds
    s_waitcnt lgkmcnt(6)
    v_mfma_f32_32x32x16_bf16 v[8:23], v[96:99], v[124:127], v[8:23]
    ds_read_b128 v[112:115], v157 offset:49152
    ds_read_b64_tr_b16 v[132:133], v158 offset:61440
    v_permlane32_swap_b32 v72, v73
    s_nop 0
    v_mfma_f32_32x32x16_bf16 v[24:39], v[96:99], v[140:143], v[24:39]
    ds_read_b64_tr_b16 v[134:135], v158 offset:62464
    ds_read_b64_tr_b16 v[148:149], v159 offset:61440
    v_add_f32 v72, v72, v73
    v_min_u32 v72, -2, v72
    buffer_load_dwordx4 v166, s[48:51], s85 offen offset:2048 lds
    v_mfma_f32_32x32x16_bf16 v[40:55], v[100:103], v[124:127], v[40:55]
    ds_read_b64_tr_b16 v[150:151], v159 offset:62464
    ds_read_b128 v[116:119], v157 offset:53248
    v_mfma_f32_32x32x16_bf16 v[56:71], v[100:103], v[140:143], v[56:71]
    buffer_load_dwordx4 v167, s[48:51], s85 offen offset:3072 lds
    s_mov_b32 exec_hi, 0
    buffer_store_dword v72, v171, s[8:11], s90 offen sc1
    s_mov_b64 exec, -1
    s_waitcnt vmcnt(10)
    s_barrier
    s_waitcnt lgkmcnt(6)
    v_mfma_f32_32x32x16_bf16 v[8:23], v[104:107], v[128:131], v[8:23]
    ds_read_b128 v[88:91], v154 offset:0
    ds_read_b64_tr_b16 v[120:121], v158 offset:0
    s_bfe_u32 s21, s82, 0x40018
    s_add_u32 m0, s86, 32768
    v_mfma_f32_32x32x16_bf16 v[24:39], v[104:107], v[144:147], v[24:39]
    ds_read_b64_tr_b16 v[122:123], v158 offset:1024
    ds_read_b64_tr_b16 v[136:137], v159 offset:0
    s_lshl_b32 s84, s21, 7
    s_mul_i32 s85, s21, 245760
    buffer_load_dwordx4 v160, s[44:47], s84 offen offset:0 lds
    v_mfma_f32_32x32x16_bf16 v[40:55], v[108:111], v[128:131], v[40:55]
    ds_read_b64_tr_b16 v[138:139], v159 offset:1024
    ds_read_b128 v[92:95], v154 offset:4096
    v_mfma_f32_32x32x16_bf16 v[56:71], v[108:111], v[144:147], v[56:71]
    buffer_load_dwordx4 v161, s[44:47], s84 offen offset:1024 lds
    s_waitcnt lgkmcnt(6)
    v_mfma_f32_32x32x16_bf16 v[8:23], v[112:115], v[132:135], v[8:23]
    ds_read_b128 v[96:99], v155 offset:0
    ds_read_b64_tr_b16 v[124:125], v158 offset:4096
    v_mfma_f32_32x32x16_bf16 v[24:39], v[112:115], v[148:151], v[24:39]
    ds_read_b64_tr_b16 v[126:127], v158 offset:5120
    ds_read_b64_tr_b16 v[140:141], v159 offset:4096
    buffer_load_dwordx4 v162, s[44:47], s84 offen offset:2048 lds
    v_mfma_f32_32x32x16_bf16 v[40:55], v[116:119], v[132:135], v[40:55]
    ds_read_b64_tr_b16 v[142:143], v159 offset:5120
    ds_read_b128 v[100:103], v155 offset:4096
    v_mfma_f32_32x32x16_bf16 v[56:71], v[116:119], v[148:151], v[56:71]
    buffer_load_dwordx4 v163, s[44:47], s84 offen offset:3072 lds
    s_waitcnt lgkmcnt(6)
    v_mfma_f32_32x32x16_bf16 v[8:23], v[88:91], v[120:123], v[8:23]
    ds_read_b128 v[104:107], v156 offset:0
    ds_read_b64_tr_b16 v[128:129], v158 offset:8192
    s_add_u32 m0, s86, 98304
    v_mfma_f32_32x32x16_bf16 v[24:39], v[88:91], v[136:139], v[24:39]
    ds_read_b64_tr_b16 v[130:131], v158 offset:9216
    ds_read_b64_tr_b16 v[144:145], v159 offset:8192
    buffer_load_dwordx4 v164, s[48:51], s85 offen offset:0 lds
    v_mfma_f32_32x32x16_bf16 v[40:55], v[92:95], v[120:123], v[40:55]
    ds_read_b64_tr_b16 v[146:147], v159 offset:9216
    ds_read_b128 v[108:111], v156 offset:4096
    v_mfma_f32_32x32x16_bf16 v[56:71], v[92:95], v[136:139], v[56:71]
    buffer_load_dwordx4 v165, s[48:51], s85 offen offset:1024 lds
    s_waitcnt lgkmcnt(6)
    v_mfma_f32_32x32x16_bf16 v[8:23], v[96:99], v[124:127], v[8:23]
    ds_read_b128 v[112:115], v157 offset:0
    ds_read_b64_tr_b16 v[132:133], v158 offset:12288
    v_mfma_f32_32x32x16_bf16 v[24:39], v[96:99], v[140:143], v[24:39]
    ds_read_b64_tr_b16 v[134:135], v158 offset:13312
    ds_read_b64_tr_b16 v[148:149], v159 offset:12288
    buffer_load_dwordx4 v166, s[48:51], s85 offen offset:2048 lds
    v_mfma_f32_32x32x16_bf16 v[40:55], v[100:103], v[124:127], v[40:55]
    ds_read_b64_tr_b16 v[150:151], v159 offset:13312
    ds_read_b128 v[116:119], v157 offset:4096
    v_mfma_f32_32x32x16_bf16 v[56:71], v[100:103], v[140:143], v[56:71]
    buffer_load_dwordx4 v167, s[48:51], s85 offen offset:3072 lds
    s_waitcnt vmcnt(9)
    s_barrier
    s_waitcnt lgkmcnt(6)
    v_mfma_f32_32x32x16_bf16 v[8:23], v[104:107], v[128:131], v[8:23]
    ds_read_b128 v[88:91], v154 offset:16384
    ds_read_b64_tr_b16 v[120:121], v158 offset:16384
    s_bfe_u32 s21, s82, 0x4001c
    s_add_u32 m0, s86, 49152
    v_mfma_f32_32x32x16_bf16 v[24:39], v[104:107], v[144:147], v[24:39]
    ds_read_b64_tr_b16 v[122:123], v158 offset:17408
    ds_read_b64_tr_b16 v[136:137], v159 offset:16384
    s_lshl_b32 s84, s21, 7
    s_mul_i32 s85, s21, 245760
    buffer_load_dwordx4 v160, s[44:47], s84 offen offset:0 lds
    v_mfma_f32_32x32x16_bf16 v[40:55], v[108:111], v[128:131], v[40:55]
    ds_read_b64_tr_b16 v[138:139], v159 offset:17408
    ds_read_b128 v[92:95], v154 offset:20480
    v_mfma_f32_32x32x16_bf16 v[56:71], v[108:111], v[144:147], v[56:71]
    buffer_load_dwordx4 v161, s[44:47], s84 offen offset:1024 lds
    s_waitcnt lgkmcnt(6)
    v_mfma_f32_32x32x16_bf16 v[8:23], v[112:115], v[132:135], v[8:23]
    ds_read_b128 v[96:99], v155 offset:16384
    ds_read_b64_tr_b16 v[124:125], v158 offset:20480
    v_mfma_f32_32x32x16_bf16 v[24:39], v[112:115], v[148:151], v[24:39]
    ds_read_b64_tr_b16 v[126:127], v158 offset:21504
    ds_read_b64_tr_b16 v[140:141], v159 offset:20480
    buffer_load_dwordx4 v162, s[44:47], s84 offen offset:2048 lds
    v_mfma_f32_32x32x16_bf16 v[40:55], v[116:119], v[132:135], v[40:55]
    ds_read_b64_tr_b16 v[142:143], v159 offset:21504
    ds_read_b128 v[100:103], v155 offset:20480
    v_mfma_f32_32x32x16_bf16 v[56:71], v[116:119], v[148:151], v[56:71]
    buffer_load_dwordx4 v163, s[44:47], s84 offen offset:3072 lds
    s_waitcnt lgkmcnt(6)
    v_mfma_f32_32x32x16_bf16 v[8:23], v[88:91], v[120:123], v[8:23]
    ds_read_b128 v[104:107], v156 offset:16384
    ds_read_b64_tr_b16 v[128:129], v158 offset:24576
    s_add_u32 m0, s86, 114688
    v_mfma_f32_32x32x16_bf16 v[24:39], v[88:91], v[136:139], v[24:39]
    ds_read_b64_tr_b16 v[130:131], v158 offset:25600
    ds_read_b64_tr_b16 v[144:145], v159 offset:24576
    buffer_load_dwordx4 v164, s[48:51], s85 offen offset:0 lds
    v_mfma_f32_32x32x16_bf16 v[40:55], v[92:95], v[120:123], v[40:55]
    ds_read_b64_tr_b16 v[146:147], v159 offset:25600
    ds_read_b128 v[108:111], v156 offset:20480
    v_mfma_f32_32x32x16_bf16 v[56:71], v[92:95], v[136:139], v[56:71]
    buffer_load_dwordx4 v165, s[48:51], s85 offen offset:1024 lds
    s_waitcnt lgkmcnt(6)
    v_mfma_f32_32x32x16_bf16 v[8:23], v[96:99], v[124:127], v[8:23]
    ds_read_b128 v[112:115], v157 offset:16384
    ds_read_b64_tr_b16 v[132:133], v158 offset:28672
    v_mfma_f32_32x32x16_bf16 v[24:39], v[96:99], v[140:143], v[24:39]
    ds_read_b64_tr_b16 v[134:135], v158 offset:29696
    ds_read_b64_tr_b16 v[148:149], v159 offset:28672
    buffer_load_dwordx4 v166, s[48:51], s85 offen offset:2048 lds
    v_mfma_f32_32x32x16_bf16 v[40:55], v[100:103], v[124:127], v[40:55]
    ds_read_b64_tr_b16 v[150:151], v159 offset:29696
    ds_read_b128 v[116:119], v157 offset:20480
    v_mfma_f32_32x32x16_bf16 v[56:71], v[100:103], v[140:143], v[56:71]
    buffer_load_dwordx4 v167, s[48:51], s85 offen offset:3072 lds
    s_waitcnt vmcnt(8)
    s_barrier
    s_waitcnt lgkmcnt(6)
    v_mfma_f32_32x32x16_bf16 v[8:23], v[104:107], v[128:131], v[8:23]
    ds_read_b128 v[88:91], v154 offset:32768
    ds_read_b64_tr_b16 v[120:121], v158 offset:32768
    s_bfe_u32 s21, s83, 0x40000
    s_add_u32 m0, s86, 0
    v_mfma_f32_32x32x16_bf16 v[24:39], v[104:107], v[144:147], v[24:39]
    ds_read_b64_tr_b16 v[122:123], v158 offset:33792
    ds_read_b64_tr_b16 v[136:137], v159 offset:32768
    s_lshl_b32 s84, s21, 7
    s_mul_i32 s85, s21, 245760
    buffer_load_dwordx4 v160, s[44:47], s84 offen offset:0 lds
    v_mfma_f32_32x32x16_bf16 v[40:55], v[108:111], v[128:131], v[40:55]
    ds_read_b64_tr_b16 v[138:139], v159 offset:33792
    ds_read_b128 v[92:95], v154 offset:36864
    v_mfma_f32_32x32x16_bf16 v[56:71], v[108:111], v[144:147], v[56:71]
    buffer_load_dwordx4 v161, s[44:47], s84 offen offset:1024 lds
    s_waitcnt lgkmcnt(6)
    v_mfma_f32_32x32x16_bf16 v[8:23], v[112:115], v[132:135], v[8:23]
    ds_read_b128 v[96:99], v155 offset:32768
    ds_read_b64_tr_b16 v[124:125], v158 offset:36864
    v_mfma_f32_32x32x16_bf16 v[24:39], v[112:115], v[148:151], v[24:39]
    ds_read_b64_tr_b16 v[126:127], v158 offset:37888
    ds_read_b64_tr_b16 v[140:141], v159 offset:36864
    buffer_load_dwordx4 v162, s[44:47], s84 offen offset:2048 lds
    v_mfma_f32_32x32x16_bf16 v[40:55], v[116:119], v[132:135], v[40:55]
    ds_read_b64_tr_b16 v[142:143], v159 offset:37888
    ds_read_b128 v[100:103], v155 offset:36864
    v_mfma_f32_32x32x16_bf16 v[56:71], v[116:119], v[148:151], v[56:71]
    buffer_load_dwordx4 v163, s[44:47], s84 offen offset:3072 lds
    s_waitcnt lgkmcnt(6)
    v_mfma_f32_32x32x16_bf16 v[8:23], v[88:91], v[120:123], v[8:23]
    ds_read_b128 v[104:107], v156 offset:32768
    ds_read_b64_tr_b16 v[128:129], v158 offset:40960
    s_add_u32 m0, s86, 65536
    v_mfma_f32_32x32x16_bf16 v[24:39], v[88:91], v[136:139], v[24:39]
    ds_read_b64_tr_b16 v[130:131], v158 offset:41984
    ds_read_b64_tr_b16 v[144:145], v159 offset:40960
    buffer_load_dwordx4 v164, s[48:51], s85 offen offset:0 lds
    v_mfma_f32_32x32x16_bf16 v[40:55], v[92:95], v[120:123], v[40:55]
    ds_read_b64_tr_b16 v[146:147], v159 offset:41984
    ds_read_b128 v[108:111], v156 offset:36864
    v_mfma_f32_32x32x16_bf16 v[56:71], v[92:95], v[136:139], v[56:71]
    buffer_load_dwordx4 v165, s[48:51], s85 offen offset:1024 lds
    s_waitcnt lgkmcnt(6)
    v_mfma_f32_32x32x16_bf16 v[8:23], v[96:99], v[124:127], v[8:23]
    ds_read_b128 v[112:115], v157 offset:32768
    ds_read_b64_tr_b16 v[132:133], v158 offset:45056
    v_mfma_f32_32x32x16_bf16 v[24:39], v[96:99], v[140:143], v[24:39]
    ds_read_b64_tr_b16 v[134:135], v158 offset:46080
    ds_read_b64_tr_b16 v[148:149], v159 offset:45056
    buffer_load_dwordx4 v166, s[48:51], s85 offen offset:2048 lds
    v_mfma_f32_32x32x16_bf16 v[40:55], v[100:103], v[124:127], v[40:55]
    ds_read_b64_tr_b16 v[150:151], v159 offset:46080
    ds_read_b128 v[116:119], v157 offset:36864
    v_mfma_f32_32x32x16_bf16 v[56:71], v[100:103], v[140:143], v[56:71]
    buffer_load_dwordx4 v167, s[48:51], s85 offen offset:3072 lds
    s_waitcnt vmcnt(8)
    s_barrier
    s_waitcnt lgkmcnt(6)
    v_mfma_f32_32x32x16_bf16 v[8:23], v[104:107], v[128:131], v[8:23]
    ds_read_b128 v[88:91], v154 offset:49152
    ds_read_b64_tr_b16 v[120:121], v158 offset:49152
    s_bfe_u32 s21, s83, 0x40004
    s_add_u32 m0, s86, 16384
    v_mfma_f32_32x32x16_bf16 v[24:39], v[104:107], v[144:147], v[24:39]
    ds_read_b64_tr_b16 v[122:123], v158 offset:50176
    ds_read_b64_tr_b16 v[136:137], v159 offset:49152
    s_lshl_b32 s84, s21, 7
    s_mul_i32 s85, s21, 245760
    buffer_load_dwordx4 v160, s[44:47], s84 offen offset:0 lds
    v_mfma_f32_32x32x16_bf16 v[40:55], v[108:111], v[128:131], v[40:55]
    ds_read_b64_tr_b16 v[138:139], v159 offset:50176
    ds_read_b128 v[92:95], v154 offset:53248
    v_mfma_f32_32x32x16_bf16 v[56:71], v[108:111], v[144:147], v[56:71]
    buffer_load_dwordx4 v161, s[44:47], s84 offen offset:1024 lds
    s_waitcnt lgkmcnt(6)
    v_mfma_f32_32x32x16_bf16 v[8:23], v[112:115], v[132:135], v[8:23]
    ds_read_b128 v[96:99], v155 offset:49152
    ds_read_b64_tr_b16 v[124:125], v158 offset:53248
    v_mfma_f32_32x32x16_bf16 v[24:39], v[112:115], v[148:151], v[24:39]
    ds_read_b64_tr_b16 v[126:127], v158 offset:54272
    ds_read_b64_tr_b16 v[140:141], v159 offset:53248
    buffer_load_dwordx4 v162, s[44:47], s84 offen offset:2048 lds
    v_mfma_f32_32x32x16_bf16 v[40:55], v[116:119], v[132:135], v[40:55]
    ds_read_b64_tr_b16 v[142:143], v159 offset:54272
    ds_read_b128 v[100:103], v155 offset:53248
    v_mfma_f32_32x32x16_bf16 v[56:71], v[116:119], v[148:151], v[56:71]
    buffer_load_dwordx4 v163, s[44:47], s84 offen offset:3072 lds
    s_waitcnt lgkmcnt(6)
    v_mfma_f32_32x32x16_bf16 v[8:23], v[88:91], v[120:123], v[8:23]
    ds_read_b128 v[104:107], v156 offset:49152
    ds_read_b64_tr_b16 v[128:129], v158 offset:57344
    s_add_u32 m0, s86, 81920
    v_mfma_f32_32x32x16_bf16 v[24:39], v[88:91], v[136:139], v[24:39]
    ds_read_b64_tr_b16 v[130:131], v158 offset:58368
    ds_read_b64_tr_b16 v[144:145], v159 offset:57344
    buffer_load_dwordx4 v164, s[48:51], s85 offen offset:0 lds
    v_mfma_f32_32x32x16_bf16 v[40:55], v[92:95], v[120:123], v[40:55]
    ds_read_b64_tr_b16 v[146:147], v159 offset:58368
    ds_read_b128 v[108:111], v156 offset:53248
    v_mfma_f32_32x32x16_bf16 v[56:71], v[92:95], v[136:139], v[56:71]
    buffer_load_dwordx4 v165, s[48:51], s85 offen offset:1024 lds
    s_waitcnt lgkmcnt(6)
    v_mfma_f32_32x32x16_bf16 v[8:23], v[96:99], v[124:127], v[8:23]
    ds_read_b128 v[112:115], v157 offset:49152
    ds_read_b64_tr_b16 v[132:133], v158 offset:61440
    v_mfma_f32_32x32x16_bf16 v[24:39], v[96:99], v[140:143], v[24:39]
    ds_read_b64_tr_b16 v[134:135], v158 offset:62464
    ds_read_b64_tr_b16 v[148:149], v159 offset:61440
    buffer_load_dwordx4 v166, s[48:51], s85 offen offset:2048 lds
    v_mfma_f32_32x32x16_bf16 v[40:55], v[100:103], v[124:127], v[40:55]
    ds_read_b64_tr_b16 v[150:151], v159 offset:62464
    ds_read_b128 v[116:119], v157 offset:53248
    v_mfma_f32_32x32x16_bf16 v[56:71], v[100:103], v[140:143], v[56:71]
    buffer_load_dwordx4 v167, s[48:51], s85 offen offset:3072 lds
    s_waitcnt vmcnt(8)
    s_barrier
    s_waitcnt lgkmcnt(6)
    v_mfma_f32_32x32x16_bf16 v[8:23], v[104:107], v[128:131], v[8:23]
    ds_read_b128 v[88:91], v154 offset:0
    ds_read_b64_tr_b16 v[120:121], v158 offset:0
    v_mfma_f32_32x32x16_bf16 v[24:39], v[104:107], v[144:147], v[24:39]
    ds_read_b64_tr_b16 v[122:123], v158 offset:1024
    ds_read_b64_tr_b16 v[136:137], v159 offset:0
    v_mfma_f32_32x32x16_bf16 v[40:55], v[108:111], v[128:131], v[40:55]
    ds_read_b64_tr_b16 v[138:139], v159 offset:1024
    ds_read_b128 v[92:95], v154 offset:4096
    v_mfma_f32_32x32x16_bf16 v[56:71], v[108:111], v[144:147], v[56:71]
    s_waitcnt lgkmcnt(6)
    v_mfma_f32_32x32x16_bf16 v[8:23], v[112:115], v[132:135], v[8:23]
    ds_read_b128 v[96:99], v155 offset:0
    ds_read_b64_tr_b16 v[124:125], v158 offset:4096
    v_mfma_f32_32x32x16_bf16 v[24:39], v[112:115], v[148:151], v[24:39]
    ds_read_b64_tr_b16 v[126:127], v158 offset:5120
    ds_read_b64_tr_b16 v[140:141], v159 offset:4096
    v_mfma_f32_32x32x16_bf16 v[40:55], v[116:119], v[132:135], v[40:55]
    ds_read_b64_tr_b16 v[142:143], v159 offset:5120
    ds_read_b128 v[100:103], v155 offset:4096
    v_mfma_f32_32x32x16_bf16 v[56:71], v[116:119], v[148:151], v[56:71]
    s_waitcnt lgkmcnt(6)
    v_mfma_f32_32x32x16_bf16 v[8:23], v[88:91], v[120:123], v[8:23]
    ds_read_b128 v[104:107], v156 offset:0
    ds_read_b64_tr_b16 v[128:129], v158 offset:8192
    v_mfma_f32_32x32x16_bf16 v[24:39], v[88:91], v[136:139], v[24:39]
    ds_read_b64_tr_b16 v[130:131], v158 offset:9216
    ds_read_b64_tr_b16 v[144:145], v159 offset:8192
    v_mfma_f32_32x32x16_bf16 v[40:55], v[92:95], v[120:123], v[40:55]
    ds_read_b64_tr_b16 v[146:147], v159 offset:9216
    ds_read_b128 v[108:111], v156 offset:4096
    v_mfma_f32_32x32x16_bf16 v[56:71], v[92:95], v[136:139], v[56:71]
    s_waitcnt lgkmcnt(6)
    v_mfma_f32_32x32x16_bf16 v[8:23], v[96:99], v[124:127], v[8:23]
    ds_read_b128 v[112:115], v157 offset:0
    ds_read_b64_tr_b16 v[132:133], v158 offset:12288
    v_mfma_f32_32x32x16_bf16 v[24:39], v[96:99], v[140:143], v[24:39]
    ds_read_b64_tr_b16 v[134:135], v158 offset:13312
    ds_read_b64_tr_b16 v[148:149], v159 offset:12288
    v_mfma_f32_32x32x16_bf16 v[40:55], v[100:103], v[124:127], v[40:55]
    ds_read_b64_tr_b16 v[150:151], v159 offset:13312
    ds_read_b128 v[116:119], v157 offset:4096
    v_mfma_f32_32x32x16_bf16 v[56:71], v[100:103], v[140:143], v[56:71]
    s_waitcnt vmcnt(0)
    s_barrier
    s_waitcnt lgkmcnt(6)
    v_mfma_f32_32x32x16_bf16 v[8:23], v[104:107], v[128:131], v[8:23]
    ds_read_b128 v[88:91], v154 offset:16384
    ds_read_b64_tr_b16 v[120:121], v158 offset:16384
    v_mfma_f32_32x32x16_bf16 v[24:39], v[104:107], v[144:147], v[24:39]
    ds_read_b64_tr_b16 v[122:123], v158 offset:17408
    ds_read_b64_tr_b16 v[136:137], v159 offset:16384
    v_mfma_f32_32x32x16_bf16 v[40:55], v[108:111], v[128:131], v[40:55]
    ds_read_b64_tr_b16 v[138:139], v159 offset:17408
    ds_read_b128 v[92:95], v154 offset:20480
    buffer_load_dwordx2 v[168:169], v172, s[8:11], s80 offen sc1
    buffer_load_dword v76, v171, s[8:11], s87 offen sc1
    buffer_load_dword v77, v171, s[8:11], s87 offen offset:1024 sc1
    v_mfma_f32_32x32x16_bf16 v[56:71], v[108:111], v[144:147], v[56:71]
    s_waitcnt lgkmcnt(6)
    v_mfma_f32_32x32x16_bf16 v[8:23], v[112:115], v[132:135], v[8:23]
    ds_read_b128 v[96:99], v155 offset:16384
    ds_read_b64_tr_b16 v[124:125], v158 offset:20480
    s_mov_b32 s24, s30
    s_mov_b32 s25, s31
    v_mfma_f32_32x32x16_bf16 v[24:39], v[112:115], v[148:151], v[24:39]
    ds_read_b64_tr_b16 v[126:127], v158 offset:21504
    ds_read_b64_tr_b16 v[140:141], v159 offset:20480
    s_mov_b32 s26, 0xc00
    s_mov_b32 s27, 0x00020000
    s_lshl_b32 s23, s64, 1
    v_lshlrev_b32 v3, 3, v251
    v_mfma_f32_32x32x16_bf16 v[40:55], v[116:119], v[132:135], v[40:55]
    ds_read_b64_tr_b16 v[142:143], v159 offset:21504
    ds_read_b128 v[100:103], v155 offset:20480
    v_mfma_f32_32x32x16_bf16 v[56:71], v[116:119], v[148:151], v[56:71]
    s_waitcnt lgkmcnt(6)
    v_mfma_f32_32x32x16_bf16 v[8:23], v[88:91], v[120:123], v[8:23]
    ds_read_b128 v[104:107], v156 offset:16384
    ds_read_b64_tr_b16 v[128:129], v158 offset:24576
    buffer_load_dwordx2 v[210:211], v3, s[24:27], s23 offen offset:0
    buffer_load_dwordx2 v[212:213], v3, s[24:27], s23 offen offset:32
    v_mfma_f32_32x32x16_bf16 v[24:39], v[88:91], v[136:139], v[24:39]
    ds_read_b64_tr_b16 v[130:131], v158 offset:25600
    ds_read_b64_tr_b16 v[144:145], v159 offset:24576
    buffer_load_dwordx2 v[214:215], v3, s[24:27], s23 offen offset:64
    buffer_load_dwordx2 v[216:217], v3, s[24:27], s23 offen offset:96
    v_mfma_f32_32x32x16_bf16 v[40:55], v[92:95], v[120:123], v[40:55]
    ds_read_b64_tr_b16 v[146:147], v159 offset:25600
    ds_read_b128 v[108:111], v156 offset:20480
    v_mfma_f32_32x32x16_bf16 v[56:71], v[92:95], v[136:139], v[56:71]
    s_waitcnt lgkmcnt(6)
    v_mfma_f32_32x32x16_bf16 v[8:23], v[96:99], v[124:127], v[8:23]
    ds_read_b128 v[112:115], v157 offset:16384
    ds_read_b64_tr_b16 v[132:133], v158 offset:28672
    s_mov_b32 s24, s34
    s_mov_b32 s25, s35
    v_mfma_f32_32x32x16_bf16 v[24:39], v[96:99], v[140:143], v[24:39]
    ds_read_b64_tr_b16 v[134:135], v158 offset:29696
    ds_read_b64_tr_b16 v[148:149], v159 offset:28672
    s_mov_b32 s26, 0x1000
    s_mov_b32 s27, 0x00020000
    v_lshlrev_b32 v3, 1, v250
    s_lshl_b32 s23, s63, 1
    buffer_load_ushort v218, v3, s[24:27], s23 offen
    v_mfma_f32_32x32x16_bf16 v[40:55], v[100:103], v[124:127], v[40:55]
    ds_read_b64_tr_b16 v[150:151], v159 offset:29696
    ds_read_b128 v[116:119], v157 offset:20480
    v_mfma_f32_32x32x16_bf16 v[56:71], v[100:103], v[140:143], v[56:71]
    s_waitcnt lgkmcnt(6)
    v_mfma_f32_32x32x16_bf16 v[8:23], v[104:107], v[128:131], v[8:23]
    s_nop 0
    v_mfma_f32_32x32x16_bf16 v[24:39], v[104:107], v[144:147], v[24:39]
    v_mfma_f32_32x32x16_bf16 v[40:55], v[108:111], v[128:131], v[40:55]
    v_mfma_f32_32x32x16_bf16 v[56:71], v[108:111], v[144:147], v[56:71]
    s_waitcnt lgkmcnt(0)
    v_mfma_f32_32x32x16_bf16 v[8:23], v[112:115], v[132:135], v[8:23]
    s_cmp_lt_u32 s79, 5
    s_cselect_b32 s21, 0x3ea52b5c, 1.0
    s_waitcnt vmcnt(5)
    v_max3_u32 v78, v168, v76, v77
    v_cmp_eq_u32 vcc, -1, v78
    s_cbranch_vccz L_rompt_kernel_loopvj
    s_call_b64 s[92:93], L_rompt_kernel_spin2
L_rompt_kernel_loopvj:
    v_mul_f32 v168, s21, v168
    v_mul_f32 v169, s21, v169
    v_mfma_f32_32x32x16_bf16 v[24:39], v[112:115], v[148:151], v[24:39]
    ds_write_b32 v173, v168
    ds_write_b32 v173, v169 offset:512
    s_lshl_b32 s21, s61, 6
    s_lshl_b32 s22, s62, 5
    s_add_u32 s24, s21, s22
    s_lshl_b32 s23, s62, 6
    v_add_f32 v72, v76, v77
    v_mov_b32 v4, v72
    v_mfma_f32_32x32x16_bf16 v[40:55], v[116:119], v[132:135], v[40:55]
    v_add_lshl_u32 v3, v1, s24, 2
    v_add_u32 v3, 151552, v3
    v_permlane32_swap_b32 v72, v4
    s_nop 0
    v_add_f32 v72, v72, v4
    ds_write_b32 v3, v72 offset:1024
    v_mfma_f32_32x32x16_bf16 v[56:71], v[116:119], v[148:151], v[56:71]
    v_xor_b32 v5, 128, v3
    v_lshlrev_b32 v6, 4, v2
    s_lshl_b32 s21, s23, 2
    s_add_u32 s21, s21, 151552
    v_add_u32 v6, s21, v6
    s_lshl_b32 s21, s78, 4
    s_lshl_b32 s22, s62, 3
    s_add_u32 s21, s21, s22
    v_add_u32 v4, s21, v2
    v_mul_u32_u24 v4, 648, v4
    s_sub_u32 s21, s79, 10
    s_lshl_b32 s21, s21, 7
    s_lshl_b32 s22, s61, 6
    s_add_u32 s21, s21, s22
    v_add3_u32 v4, v4, s21, v1
    v_lshlrev_b32 v4, 4, v4
    s_waitcnt lgkmcnt(0)
    s_barrier
    ds_read_b32 v88, v3 offset:1024
    ds_read_b32 v89, v5 offset:1024
    ds_read_b128 v[92:95], v6 offset:0
    ds_read_b128 v[108:111], v6 offset:512
    ds_read_b128 v[96:99], v6 offset:32
    ds_read_b128 v[112:115], v6 offset:544
    ds_read_b128 v[100:103], v6 offset:64
    ds_read_b128 v[116:119], v6 offset:576
    ds_read_b128 v[104:107], v6 offset:96
    ds_read_b128 v[120:123], v6 offset:608
    s_waitcnt lgkmcnt(0)
    s_xor_b32 s22, s62, 0
    s_lshl_b32 s22, s22, 9
    v_pk_mul_f32 v[8:9], v[8:9], v[92:93]
    v_pk_fma_f32 v[8:9], v[108:109], v[88:89], v[8:9] op_sel:[0,0,0] op_sel_hi:[1,0,1]
    v_pk_mul_f32 v[10:11], v[10:11], v[94:95]
    v_pk_fma_f32 v[10:11], v[110:111], v[88:89], v[10:11] op_sel:[0,0,0] op_sel_hi:[1,0,1]
    v_pk_mul_f32 v[12:13], v[12:13], v[96:97]
    v_pk_fma_f32 v[12:13], v[112:113], v[88:89], v[12:13] op_sel:[0,0,0] op_sel_hi:[1,0,1]
    v_pk_mul_f32 v[14:15], v[14:15], v[98:99]
    v_pk_fma_f32 v[14:15], v[114:115], v[88:89], v[14:15] op_sel:[0,0,0] op_sel_hi:[1,0,1]
    v_cvt_pk_bf16_f32 v124, v8, v9
    v_cvt_pk_bf16_f32 v125, v10, v11
    v_cvt_pk_bf16_f32 v126, v12, v13
    v_cvt_pk_bf16_f32 v127, v14, v15
    s_add_u32 s21, s22, 5399296
    buffer_store_dwordx4 v[124:127], v4, s[8:11], s21 offen sc1
    v_pk_mul_f32 v[16:17], v[16:17], v[100:101]
    v_pk_fma_f32 v[16:17], v[116:117], v[88:89], v[16:17] op_sel:[0,0,0] op_sel_hi:[1,0,1]
    v_pk_mul_f32 v[18:19], v[18:19], v[102:103]
    v_pk_fma_f32 v[18:19], v[118:119], v[88:89], v[18:19] op_sel:[0,0,0] op_sel_hi:[1,0,1]
    v_pk_mul_f32 v[20:21], v[20:21], v[104:105]
    v_pk_fma_f32 v[20:21], v[120:121], v[88:89], v[20:21] op_sel:[0,0,0] op_sel_hi:[1,0,1]
    v_pk_mul_f32 v[22:23], v[22:23], v[106:107]
    v_pk_fma_f32 v[22:23], v[122:123], v[88:89], v[22:23] op_sel:[0,0,0] op_sel_hi:[1,0,1]
    v_cvt_pk_bf16_f32 v128, v16, v17
    v_cvt_pk_bf16_f32 v129, v18, v19
    v_cvt_pk_bf16_f32 v130, v20, v21
    v_cvt_pk_bf16_f32 v131, v22, v23
    s_add_u32 s21, s22, 5420032
    buffer_store_dwordx4 v[128:131], v4, s[8:11], s21 offen sc1
    s_xor_b32 s22, s62, 1
    s_lshl_b32 s22, s22, 9
    v_pk_mul_f32 v[24:25], v[24:25], v[92:93]
    v_pk_fma_f32 v[24:25], v[108:109], v[88:89], v[24:25] op_sel:[0,1,0] op_sel_hi:[1,1,1]
    v_pk_mul_f32 v[26:27], v[26:27], v[94:95]
    v_pk_fma_f32 v[26:27], v[110:111], v[88:89], v[26:27] op_sel:[0,1,0] op_sel_hi:[1,1,1]
    v_pk_mul_f32 v[28:29], v[28:29], v[96:97]
    v_pk_fma_f32 v[28:29], v[112:113], v[88:89], v[28:29] op_sel:[0,1,0] op_sel_hi:[1,1,1]
    v_pk_mul_f32 v[30:31], v[30:31], v[98:99]
    v_pk_fma_f32 v[30:31], v[114:115], v[88:89], v[30:31] op_sel:[0,1,0] op_sel_hi:[1,1,1]
    v_cvt_pk_bf16_f32 v132, v24, v25
    v_cvt_pk_bf16_f32 v133, v26, v27
    v_cvt_pk_bf16_f32 v134, v28, v29
    v_cvt_pk_bf16_f32 v135, v30, v31
    s_add_u32 s21, s22, 5399296
    buffer_store_dwordx4 v[132:135], v4, s[8:11], s21 offen sc1
    v_pk_mul_f32 v[32:33], v[32:33], v[100:101]
    v_pk_fma_f32 v[32:33], v[116:117], v[88:89], v[32:33] op_sel:[0,1,0] op_sel_hi:[1,1,1]
    v_pk_mul_f32 v[34:35], v[34:35], v[102:103]
    v_pk_fma_f32 v[34:35], v[118:119], v[88:89], v[34:35] op_sel:[0,1,0] op_sel_hi:[1,1,1]
    v_pk_mul_f32 v[36:37], v[36:37], v[104:105]
    v_pk_fma_f32 v[36:37], v[120:121], v[88:89], v[36:37] op_sel:[0,1,0] op_sel_hi:[1,1,1]
    v_pk_mul_f32 v[38:39], v[38:39], v[106:107]
    v_pk_fma_f32 v[38:39], v[122:123], v[88:89], v[38:39] op_sel:[0,1,0] op_sel_hi:[1,1,1]
    v_cvt_pk_bf16_f32 v136, v32, v33
    v_cvt_pk_bf16_f32 v137, v34, v35
    v_cvt_pk_bf16_f32 v138, v36, v37
    v_cvt_pk_bf16_f32 v139, v38, v39
    s_add_u32 s21, s22, 5420032
    buffer_store_dwordx4 v[136:139], v4, s[8:11], s21 offen sc1
    ds_read_b128 v[92:95], v6 offset:128
    ds_read_b128 v[108:111], v6 offset:640
    ds_read_b128 v[96:99], v6 offset:160
    ds_read_b128 v[112:115], v6 offset:672
    ds_read_b128 v[100:103], v6 offset:192
    ds_read_b128 v[116:119], v6 offset:704
    ds_read_b128 v[104:107], v6 offset:224
    ds_read_b128 v[120:123], v6 offset:736
    s_waitcnt lgkmcnt(0)
    s_xor_b32 s22, s62, 0
    s_lshl_b32 s22, s22, 9
    v_pk_mul_f32 v[40:41], v[40:41], v[92:93]
    v_pk_fma_f32 v[40:41], v[108:109], v[88:89], v[40:41] op_sel:[0,0,0] op_sel_hi:[1,0,1]
    v_pk_mul_f32 v[42:43], v[42:43], v[94:95]
    v_pk_fma_f32 v[42:43], v[110:111], v[88:89], v[42:43] op_sel:[0,0,0] op_sel_hi:[1,0,1]
    v_pk_mul_f32 v[44:45], v[44:45], v[96:97]
    v_pk_fma_f32 v[44:45], v[112:113], v[88:89], v[44:45] op_sel:[0,0,0] op_sel_hi:[1,0,1]
    v_pk_mul_f32 v[46:47], v[46:47], v[98:99]
    v_pk_fma_f32 v[46:47], v[114:115], v[88:89], v[46:47] op_sel:[0,0,0] op_sel_hi:[1,0,1]
    v_cvt_pk_bf16_f32 v124, v40, v41
    v_cvt_pk_bf16_f32 v125, v42, v43
    v_cvt_pk_bf16_f32 v126, v44, v45
    v_cvt_pk_bf16_f32 v127, v46, v47
    s_add_u32 s21, s22, 5440768
    buffer_store_dwordx4 v[124:127], v4, s[8:11], s21 offen sc1
    v_pk_mul_f32 v[48:49], v[48:49], v[100:101]
    v_pk_fma_f32 v[48:49], v[116:117], v[88:89], v[48:49] op_sel:[0,0,0] op_sel_hi:[1,0,1]
    v_pk_mul_f32 v[50:51], v[50:51], v[102:103]
    v_pk_fma_f32 v[50:51], v[118:119], v[88:89], v[50:51] op_sel:[0,0,0] op_sel_hi:[1,0,1]
    v_pk_mul_f32 v[52:53], v[52:53], v[104:105]
    v_pk_fma_f32 v[52:53], v[120:121], v[88:89], v[52:53] op_sel:[0,0,0] op_sel_hi:[1,0,1]
    v_pk_mul_f32 v[54:55], v[54:55], v[106:107]
    v_pk_fma_f32 v[54:55], v[122:123], v[88:89], v[54:55] op_sel:[0,0,0] op_sel_hi:[1,0,1]
    v_cvt_pk_bf16_f32 v128, v48, v49
    v_cvt_pk_bf16_f32 v129, v50, v51
    v_cvt_pk_bf16_f32 v130, v52, v53
    v_cvt_pk_bf16_f32 v131, v54, v55
    s_add_u32 s21, s22, 5461504
    buffer_store_dwordx4 v[128:131], v4, s[8:11], s21 offen sc1
    s_xor_b32 s22, s62, 1
    s_lshl_b32 s22, s22, 9
    v_pk_mul_f32 v[56:57], v[56:57], v[92:93]
    v_pk_fma_f32 v[56:57], v[108:109], v[88:89], v[56:57] op_sel:[0,1,0] op_sel_hi:[1,1,1]
    v_pk_mul_f32 v[58:59], v[58:59], v[94:95]
    v_pk_fma_f32 v[58:59], v[110:111], v[88:89], v[58:59] op_sel:[0,1,0] op_sel_hi:[1,1,1]
    v_pk_mul_f32 v[60:61], v[60:61], v[96:97]
    v_pk_fma_f32 v[60:61], v[112:113], v[88:89], v[60:61] op_sel:[0,1,0] op_sel_hi:[1,1,1]
    v_pk_mul_f32 v[62:63], v[62:63], v[98:99]
    v_pk_fma_f32 v[62:63], v[114:115], v[88:89], v[62:63] op_sel:[0,1,0] op_sel_hi:[1,1,1]
    v_cvt_pk_bf16_f32 v132, v56, v57
    v_cvt_pk_bf16_f32 v133, v58, v59
    v_cvt_pk_bf16_f32 v134, v60, v61
    v_cvt_pk_bf16_f32 v135, v62, v63
    s_add_u32 s21, s22, 5440768
    buffer_store_dwordx4 v[132:135], v4, s[8:11], s21 offen sc1
    v_pk_mul_f32 v[64:65], v[64:65], v[100:101]
    v_pk_fma_f32 v[64:65], v[116:117], v[88:89], v[64:65] op_sel:[0,1,0] op_sel_hi:[1,1,1]
    v_pk_mul_f32 v[66:67], v[66:67], v[102:103]
    v_pk_fma_f32 v[66:67], v[118:119], v[88:89], v[66:67] op_sel:[0,1,0] op_sel_hi:[1,1,1]
    v_pk_mul_f32 v[68:69], v[68:69], v[104:105]
    v_pk_fma_f32 v[68:69], v[120:121], v[88:89], v[68:69] op_sel:[0,1,0] op_sel_hi:[1,1,1]
    v_pk_mul_f32 v[70:71], v[70:71], v[106:107]
    v_pk_fma_f32 v[70:71], v[122:123], v[88:89], v[70:71] op_sel:[0,1,0] op_sel_hi:[1,1,1]
    v_cvt_pk_bf16_f32 v136, v64, v65
    v_cvt_pk_bf16_f32 v137, v66, v67
    v_cvt_pk_bf16_f32 v138, v68, v69
    v_cvt_pk_bf16_f32 v139, v70, v71
    s_add_u32 s21, s22, 5461504
    buffer_store_dwordx4 v[136:139], v4, s[8:11], s21 offen sc1
L_rompt_kernel_adone:
    s_nop 0
    s_mul_hi_u32 s23, s79, 858993460
    s_mul_i32 s21, s23, 5
    s_sub_u32 s21, s79, s21
    s_lshl_b32 s21, s21, 7
    s_add_u32 s22, s21, 127
    s_mul_hi_u32 s21, s21, 214748365
    s_mul_hi_u32 s22, s22, 214748365
    s_sub_u32 s22, s22, s21
    s_add_u32 s22, s22, 1
L_rompt_kernel_asig:
    s_mov_b32 s3, 0
    s_lshl_b32 s21, s21, 9
    s_lshl_b32 s23, s23, 7
    s_add_u32 s21, s21, s23
    s_add_u32 s80, s21, 16866048
    s_bfm_b64 s[82:83], s22, 0
    v_mul_u32_u24 v3, 2096, v251
    v_add3_u32 v3, v3, v250, s63
    v_lshlrev_b32 v236, 4, v3
    v_add_u32 v236, 8219392, v236
    v_mul_u32_u24 v3, 640, v251
    v_add3_u32 v3, v3, v250, s19
    v_lshlrev_b32 v235, 4, v3
    v_add_u32 v235, 13523712, v235
    v_mul_u32_u24 v3, 640, v251
    v_add3_u32 v3, v3, v250, s65
    v_lshlrev_b32 v4, 4, v3
    v_add_u32 v4, 10902272, v4
    s_lshl_b32 s23, s38, 8
    v_add_u32 v243, s23, v4
    s_lshl_b32 s23, s39, 8
    v_add_u32 v244, s23, v4
    s_lshl_b32 s23, s40, 8
    v_add_u32 v245, s23, v4
    s_lshl_b32 s23, s41, 8
    v_add_u32 v246, s23, v4
    s_lshl_b32 s23, s13, 5
    s_lshl_b32 s24, s61, 4
    s_add_u32 s23, s23, s24
    s_lshl_b32 s23, s23, 4
    s_lshl_b32 s24, s62, 3
    s_add_u32 s23, s23, s24
    s_add_u32 s23, s23, 10365696
    v_lshlrev_b32 v3, 15, v251
    v_lshl_add_u32 v3, v250, 4, v3
    v_add_u32 v237, s23, v3
    s_lshl_b32 s23, s13, 12
    s_lshl_b32 s24, s14, 7
    s_add_u32 s23, s23, s24
    s_add_u32 s23, s23, 16308992
    v_lshl_add_u32 v3, v250, 3, s23
    v_lshl_add_u32 v239, v251, 10, v3
    s_lshl_b32 s24, s12, 9
    v_add_u32 v238, s24, v3
    v_bfe_u32 v3, v0, 4, 1
    v_bfe_u32 v4, v0, 2, 2
    v_lshl_add_u32 v4, v3, 3, v4
    v_mul_u32_u24 v4, 160, v4
    v_lshl_add_u32 v4, v2, 5, v4
    v_and_b32 v5, 3, v0
    v_lshl_add_u32 v4, v5, 3, v4
    v_add_u32 v240, s42, v4
    s_lshr_b32 s23, s63, 3
    s_mul_i32 s23, s23, 640
    s_add_u32 s23, s23, s19
    s_lshl_b32 s23, s23, 4
    s_add_u32 s23, s23, 10902272
    v_mul_u32_u24 v3, 640, v3
    v_lshl_add_u32 v3, v2, 4, v3
    v_add_lshl_u32 v3, v3, v250, 4
    v_add_u32 v241, s23, v3
    s_lshr_b32 s23, s64, 3
    s_mul_i32 s23, s23, 640
    s_add_u32 s23, s23, s65
    s_lshl_b32 s24, s14, 4
    s_add_u32 s23, s23, s24
    v_mul_u32_u24 v3, 640, v251
    v_add3_u32 v3, v3, v250, s23
    v_lshlrev_b32 v242, 4, v3
    v_add_u32 v242, 13523712, v242
    v_add_u32 v3, 0, v0
    v_mul_u32_u24 v4, 205, v3
    v_lshrrev_b32 v4, 11, v4
    v_mul_u32_u24 v4, 1120, v4
    v_lshl_add_u32 v247, v3, 4, v4
    v_add_u32 v3, 64, v0
    v_mul_u32_u24 v4, 205, v3
    v_lshrrev_b32 v4, 11, v4
    v_mul_u32_u24 v4, 1120, v4
    v_lshl_add_u32 v248, v3, 4, v4
    v_add_u32 v3, 128, v0
    v_mul_u32_u24 v4, 205, v3
    v_lshrrev_b32 v4, 11, v4
    v_mul_u32_u24 v4, 1120, v4
    v_lshl_add_u32 v249, v3, 4, v4
    s_add_u32 s23, s66, 0
    s_and_b32 s23, s23, 15
    s_mul_i32 s84, s23, 98304
    s_add_u32 s23, s66, 4
    s_and_b32 s23, s23, 15
    s_mul_i32 s85, s23, 98304
    s_add_u32 s23, s66, 8
    s_and_b32 s23, s23, 15
    s_mul_i32 s86, s23, 98304
    s_add_u32 s23, s66, 12
    s_and_b32 s23, s23, 15
    s_mul_i32 s90, s23, 98304
    v_lshlrev_b32 v3, 9, v0
    v_mov_b32 v4, 1
    s_cmp_lg_u32 s14, 0
    s_waitcnt vmcnt(0)
    s_barrier
    s_cbranch_scc1 L_rompt_kernel_asg
    s_mov_b64 exec, s[82:83]
    buffer_atomic_add v4, v3, s[8:11], s80 offen sc1
    s_mov_b64 exec, -1
L_rompt_kernel_asg:
    s_mov_b32 m0, s42
    s_nop 0
    buffer_load_dwordx4 v247, s[44:47], s57 offen lds
    s_add_u32 m0, s42, 1024
    s_nop 0
    buffer_load_dwordx4 v248, s[44:47], s57 offen lds
    s_add_u32 m0, s42, 2048
    s_mov_b32 exec_hi, 0
    buffer_load_dwordx4 v249, s[44:47], s57 offen lds
    s_mov_b64 exec, -1
    s_mov_b32 s44, s28
    s_mov_b32 s45, s29
    s_mov_b32 s46, 0x600000
    s_mov_b32 s47, 0x00020000
    s_mov_b32 s48, s4
    s_mov_b32 s49, s5
    s_mov_b32 s50, 0x101db00
    s_mov_b32 s51, 0x00020000
    s_cmp_ge_u32 s17, 30
    s_cselect_b32 s46, 0, s46
    s_cselect_b32 s50, 0, s50
    s_mov_b32 s52, s28
    s_mov_b32 s53, s29
    s_mov_b32 s54, 0x600000
    s_mov_b32 s55, 0x00020000
    s_mov_b32 s26, 0
    s_mov_b32 s27, -1
    s_mov_b32 s25, 0
    s_mov_b32 m0, s67
    s_xor_b32 s71, s59, 1024
    s_mov_b32 s87, 0x400000
    s_mov_b32 s80, s32
    s_mov_b32 s81, s33
    s_mov_b32 s82, 0x600000
    s_mov_b32 s83, 0x00020000
    s_cmp_lg_u32 s14, 1
    s_cbranch_scc1 L_rompt_kernel_pax
    s_mul_i32 s21, s68, 20
    s_add_u32 s22, s21, 19
    s_lshr_b32 s21, s21, 7
    s_lshr_b32 s22, s22, 7
    s_sub_u32 s22, s22, s21
    s_lshl_b32 s22, s22, 4
    s_add_u32 s22, s22, 16
    v_mov_b32 v5, s22
    v_cmp_eq_u32 vcc, 3, v0
    v_lshlrev_b32 v6, 7, v0
    s_lshl_b32 s43, s68, 9
    v_cndmask_b32 v5, v5, 16, vcc
    s_add_u32 s43, s43, 16866048
    s_mov_b32 s23, 0x200000
    s_mov_b64 exec, 15
L_rompt_kernel_pa:
    v_mov_b32 v7, 0
    buffer_atomic_add v7, v6, s[8:11], s43 offen sc0 sc1
    s_sub_u32 s23, s23, 1
    s_cbranch_scc1 L_rompt_kernel_pay
    s_waitcnt vmcnt(0)
    v_cmp_gt_u32 vcc, v5, v7
    s_cbranch_vccnz L_rompt_kernel_pa
L_rompt_kernel_pay:
    s_waitcnt vmcnt(0)
    s_mov_b64 exec, -1
L_rompt_kernel_pax:
    s_lshl_b32 s21, s62, 14
    s_mul_i32 s22, s62, 1327104
    s_waitcnt lgkmcnt(0)
    s_barrier
    buffer_load_dwordx4 v[148:151], v192, s[8:11], 0 offen
    buffer_load_dwordx2 v[158:159], v193, s[8:11], 0 offen
    buffer_load_dwordx4 v[124:127], v194, s[8:11], s71 offen offset:512
    buffer_load_dwordx2 v[134:135], v195, s[8:11], s71 offen offset:512
    buffer_load_dwordx4 v[120:123], v194, s[8:11], s71 offen offset:0
    buffer_load_dwordx2 v[132:133], v195, s[8:11], s71 offen offset:0
    buffer_load_dwordx4 v[116:119], v194, s[8:11], s59 offen offset:512
    buffer_load_dwordx2 v[130:131], v195, s[8:11], s59 offen offset:512
    buffer_load_dwordx4 v[112:115], v194, s[8:11], s59 offen offset:0
    buffer_load_dwordx2 v[128:129], v195, s[8:11], s59 offen offset:0
    buffer_load_dwordx4 v[136:139], v192, s[8:11], s21 offen offset:0
    buffer_load_dwordx2 v[152:153], v193, s[8:11], s21 offen offset:0
    buffer_load_dwordx4 v[160:163], v198, s[8:11], s22 offen
    buffer_load_dwordx4 v[164:167], v199, s[8:11], s22 offen
    s_waitcnt vmcnt(4)
    v_mfma_f32_32x32x16_bf16 a[208:223], v[148:151], v[124:127], 0
    buffer_load_dwordx4 v[140:143], v192, s[8:11], s21 offen offset:512
    v_mfma_f32_32x32x8_bf16 a[208:223], v[158:159], v[134:135], a[208:223]
    buffer_load_dwordx2 v[154:155], v193, s[8:11], s21 offen offset:512
    v_mfma_f32_32x32x16_bf16 a[224:239], v[148:151], v[120:123], 0
    buffer_load_dwordx4 v[168:171], v200, s[8:11], s22 offen
    v_mfma_f32_32x32x8_bf16 a[224:239], v[158:159], v[132:133], a[224:239]
    buffer_load_dwordx4 v[172:175], v201, s[8:11], s22 offen
    v_mfma_f32_32x32x16_bf16 v[88:103], v[148:151], v[116:119], 0
    buffer_load_dwordx4 v[144:147], v192, s[8:11], s21 offen offset:1024
    v_mfma_f32_32x32x8_bf16 v[88:103], v[158:159], v[130:131], v[88:103]
    buffer_load_dwordx2 v[156:157], v193, s[8:11], s21 offen offset:1024
    v_mfma_f32_32x32x16_bf16 v[72:87], v[148:151], v[112:115], 0
    buffer_load_dwordx4 v[176:179], v202, s[8:11], s22 offen
    v_mfma_f32_32x32x8_bf16 v[72:87], v[158:159], v[128:129], v[72:87]
    buffer_load_dwordx4 v[180:183], v203, s[8:11], s22 offen
    v_accvgpr_read_b32 v3, a208
    v_accvgpr_read_b32 v4, a209
    v_accvgpr_read_b32 v5, a210
    v_max3_f32 v209, v3, v4, v5
    v_accvgpr_read_b32 v3, a224
    v_accvgpr_read_b32 v4, a225
    v_accvgpr_read_b32 v5, a226
    v_max3_f32 v208, v3, v4, v5
    v_max3_f32 v207, v88, v89, v90
    s_nop 1
    v_max3_f32 v206, v72, v73, v74
L_rompt_kernel_setm:
    s_waitcnt vmcnt(8)
    v_mfma_f32_32x32x16_bf16 v[72:87], v[136:139], v[112:115], 0
    s_mov_b64 exec, s[26:27]
    v_and_b32 v4, s56, v206
    v_sub_f32 v5, v4, v206
    v_xor_b32 v4, 0x80000000, v4
    v_perm_b32 v128, v5, v4, s58
    s_mov_b64 exec, -1
    s_nop 0
    v_mfma_f32_32x32x8_bf16 v[72:87], v[152:153], v[128:129], v[72:87]
    s_mov_b64 exec, s[26:27]
    v_and_b32 v4, s56, v207
    v_sub_f32 v5, v4, v207
    v_xor_b32 v4, 0x80000000, v4
    v_perm_b32 v130, v5, v4, s58
    v_and_b32 v4, s56, v208
    v_sub_f32 v5, v4, v208
    v_xor_b32 v4, 0x80000000, v4
    v_perm_b32 v132, v5, v4, s58
    v_and_b32 v4, s56, v209
    v_sub_f32 v5, v4, v209
    v_xor_b32 v4, 0x80000000, v4
    v_perm_b32 v134, v5, v4, s58
    s_mov_b64 exec, -1
    v_mfma_f32_32x32x16_bf16 v[88:103], v[136:139], v[116:119], 0
    v_exp_f32 v72, v72
    v_exp_f32 v73, v73
    v_exp_f32 v74, v74
    v_exp_f32 v75, v75
    buffer_load_dwordx4 v[148:151], v192, s[8:11], s21 offen offset:1536
    v_cvt_pk_bf16_f32 v104, v72, v73
    v_cvt_pk_bf16_f32 v105, v74, v75
    v_exp_f32 v76, v76
    v_exp_f32 v77, v77
    v_exp_f32 v78, v78
    v_exp_f32 v79, v79
    v_mfma_f32_32x32x8_bf16 v[88:103], v[152:153], v[130:131], v[88:103]
    v_cvt_pk_bf16_f32 v106, v76, v77
    v_cvt_pk_bf16_f32 v107, v78, v79
    v_exp_f32 v80, v80
    v_exp_f32 v81, v81
    v_exp_f32 v82, v82
    v_exp_f32 v83, v83
    v_mfma_f32_32x32x16_bf16 v[8:23], v[160:163], v[104:107], 0
    s_add_u32 m0, s67, 0
    s_nop 0
    buffer_load_dwordx4 v197, s[8:11], m0 offen offset:0 sc1 lds
    v_cvt_pk_bf16_f32 v108, v80, v81
    v_cvt_pk_bf16_f32 v109, v82, v83
    v_exp_f32 v84, v84
    v_exp_f32 v85, v85
    v_exp_f32 v86, v86
    v_exp_f32 v87, v87
    v_cvt_pk_bf16_f32 v110, v84, v85
    v_cvt_pk_bf16_f32 v111, v86, v87
    v_mfma_f32_32x32x16_bf16 v[72:87], v[136:139], v[120:123], 0
    v_exp_f32 v88, v88
    v_exp_f32 v89, v89
    v_exp_f32 v90, v90
    v_exp_f32 v91, v91
    v_mfma_f32_32x32x16_bf16 v[8:23], v[164:167], v[108:111], v[8:23]
    buffer_load_dwordx2 v[158:159], v193, s[8:11], s21 offen offset:1536
    v_cvt_pk_bf16_f32 v104, v88, v89
    v_cvt_pk_bf16_f32 v105, v90, v91
    v_exp_f32 v92, v92
    v_exp_f32 v93, v93
    v_exp_f32 v94, v94
    v_exp_f32 v95, v95
    v_mfma_f32_32x32x8_bf16 v[72:87], v[152:153], v[132:133], v[72:87]
    v_cvt_pk_bf16_f32 v106, v92, v93
    v_cvt_pk_bf16_f32 v107, v94, v95
    v_exp_f32 v96, v96
    v_exp_f32 v97, v97
    v_exp_f32 v98, v98
    v_exp_f32 v99, v99
    v_mfma_f32_32x32x16_bf16 v[24:39], v[160:163], v[104:107], 0
    buffer_load_dwordx4 v197, s[8:11], m0 offen offset:1024 sc1 lds
    v_cvt_pk_bf16_f32 v108, v96, v97
    v_cvt_pk_bf16_f32 v109, v98, v99
    v_exp_f32 v100, v100
    v_exp_f32 v101, v101
    v_exp_f32 v102, v102
    v_exp_f32 v103, v103
    v_cvt_pk_bf16_f32 v110, v100, v101
    v_cvt_pk_bf16_f32 v111, v102, v103
    v_mfma_f32_32x32x16_bf16 v[88:103], v[136:139], v[124:127], 0
    v_exp_f32 v72, v72
    v_exp_f32 v73, v73
    v_exp_f32 v74, v74
    v_exp_f32 v75, v75
    v_mfma_f32_32x32x16_bf16 v[24:39], v[164:167], v[108:111], v[24:39]
    buffer_load_dwordx4 v[184:187], v204, s[8:11], s22 offen
    v_cvt_pk_bf16_f32 v104, v72, v73
    v_cvt_pk_bf16_f32 v105, v74, v75
    v_exp_f32 v76, v76
    v_exp_f32 v77, v77
    v_exp_f32 v78, v78
    v_exp_f32 v79, v79
    v_mfma_f32_32x32x8_bf16 v[88:103], v[152:153], v[134:135], v[88:103]
    v_cvt_pk_bf16_f32 v106, v76, v77
    v_cvt_pk_bf16_f32 v107, v78, v79
    v_exp_f32 v80, v80
    v_exp_f32 v81, v81
    v_exp_f32 v82, v82
    v_exp_f32 v83, v83
    v_mfma_f32_32x32x16_bf16 v[40:55], v[160:163], v[104:107], 0
    buffer_load_dwordx4 v197, s[8:11], m0 offen offset:2048 sc1 lds
    v_cvt_pk_bf16_f32 v108, v80, v81
    v_cvt_pk_bf16_f32 v109, v82, v83
    v_exp_f32 v84, v84
    v_exp_f32 v85, v85
    v_exp_f32 v86, v86
    v_exp_f32 v87, v87
    v_cvt_pk_bf16_f32 v110, v84, v85
    v_cvt_pk_bf16_f32 v111, v86, v87
    s_waitcnt vmcnt(10)
    v_mfma_f32_32x32x16_bf16 v[72:87], v[140:143], v[112:115], 0
    v_exp_f32 v88, v88
    v_exp_f32 v89, v89
    v_exp_f32 v90, v90
    v_exp_f32 v91, v91
    v_mfma_f32_32x32x16_bf16 v[40:55], v[164:167], v[108:111], v[40:55]
    buffer_load_dwordx4 v[188:191], v205, s[8:11], s22 offen
    v_cvt_pk_bf16_f32 v104, v88, v89
    v_cvt_pk_bf16_f32 v105, v90, v91
    v_exp_f32 v92, v92
    v_exp_f32 v93, v93
    v_exp_f32 v94, v94
    v_exp_f32 v95, v95
    v_mfma_f32_32x32x8_bf16 v[72:87], v[154:155], v[128:129], v[72:87]
    v_cvt_pk_bf16_f32 v106, v92, v93
    v_cvt_pk_bf16_f32 v107, v94, v95
    v_exp_f32 v96, v96
    v_exp_f32 v97, v97
    v_exp_f32 v98, v98
    v_exp_f32 v99, v99
    v_mfma_f32_32x32x16_bf16 v[56:71], v[160:163], v[104:107], 0
    buffer_load_dword v7, v196, s[52:55], 0 offen
    v_cvt_pk_bf16_f32 v108, v96, v97
    v_cvt_pk_bf16_f32 v109, v98, v99
    v_exp_f32 v100, v100
    v_exp_f32 v101, v101
    v_exp_f32 v102, v102
    v_exp_f32 v103, v103
    v_cvt_pk_bf16_f32 v110, v100, v101
    v_cvt_pk_bf16_f32 v111, v102, v103
    v_mfma_f32_32x32x16_bf16 v[88:103], v[140:143], v[116:119], 0
    v_exp_f32 v72, v72
    v_exp_f32 v73, v73
    v_exp_f32 v74, v74
    v_exp_f32 v75, v75
    v_mfma_f32_32x32x16_bf16 v[56:71], v[164:167], v[108:111], v[56:71]
    s_add_u32 s22, s22, 165888
    s_add_u32 s21, s21, 2048
    buffer_load_dwordx4 v[136:139], v192, s[8:11], s21 offen offset:0
    v_cvt_pk_bf16_f32 v104, v72, v73
    v_cvt_pk_bf16_f32 v105, v74, v75
    v_exp_f32 v76, v76
    v_exp_f32 v77, v77
    v_exp_f32 v78, v78
    v_exp_f32 v79, v79
    v_mfma_f32_32x32x8_bf16 v[88:103], v[154:155], v[130:131], v[88:103]
    v_cvt_pk_bf16_f32 v106, v76, v77
    v_cvt_pk_bf16_f32 v107, v78, v79
    v_exp_f32 v80, v80
    v_exp_f32 v81, v81
    v_exp_f32 v82, v82
    v_exp_f32 v83, v83
    v_mfma_f32_32x32x16_bf16 v[8:23], v[168:171], v[104:107], v[8:23]
    v_cvt_pk_bf16_f32 v108, v80, v81
    v_cvt_pk_bf16_f32 v109, v82, v83
    v_exp_f32 v84, v84
    v_exp_f32 v85, v85
    v_exp_f32 v86, v86
    v_exp_f32 v87, v87
    v_cvt_pk_bf16_f32 v110, v84, v85
    v_cvt_pk_bf16_f32 v111, v86, v87
    v_mfma_f32_32x32x16_bf16 v[72:87], v[140:143], v[120:123], 0
    v_exp_f32 v88, v88
    v_exp_f32 v89, v89
    v_exp_f32 v90, v90
    v_exp_f32 v91, v91
    v_mfma_f32_32x32x16_bf16 v[8:23], v[172:175], v[108:111], v[8:23]
    buffer_load_dwordx2 v[152:153], v193, s[8:11], s21 offen offset:0
    v_cvt_pk_bf16_f32 v104, v88, v89
    v_cvt_pk_bf16_f32 v105, v90, v91
    v_exp_f32 v92, v92
    v_exp_f32 v93, v93
    v_exp_f32 v94, v94
    v_exp_f32 v95, v95
    v_mfma_f32_32x32x8_bf16 v[72:87], v[154:155], v[132:133], v[72:87]
    v_cvt_pk_bf16_f32 v106, v92, v93
    v_cvt_pk_bf16_f32 v107, v94, v95
    v_exp_f32 v96, v96
    v_exp_f32 v97, v97
    v_exp_f32 v98, v98
    v_exp_f32 v99, v99
    v_mfma_f32_32x32x16_bf16 v[24:39], v[168:171], v[104:107], v[24:39]
    v_cvt_pk_bf16_f32 v108, v96, v97
    v_cvt_pk_bf16_f32 v109, v98, v99
    v_exp_f32 v100, v100
    v_exp_f32 v101, v101
    v_exp_f32 v102, v102
    v_exp_f32 v103, v103
    v_cvt_pk_bf16_f32 v110, v100, v101
    v_cvt_pk_bf16_f32 v111, v102, v103
    v_mfma_f32_32x32x16_bf16 v[88:103], v[140:143], v[124:127], 0
    v_exp_f32 v72, v72
    v_exp_f32 v73, v73
    v_exp_f32 v74, v74
    v_exp_f32 v75, v75
    v_mfma_f32_32x32x16_bf16 v[24:39], v[172:175], v[108:111], v[24:39]
    buffer_load_dwordx4 v[160:163], v198, s[8:11], s22 offen
    v_cvt_pk_bf16_f32 v104, v72, v73
    v_cvt_pk_bf16_f32 v105, v74, v75
    v_exp_f32 v76, v76
    v_exp_f32 v77, v77
    v_exp_f32 v78, v78
    v_exp_f32 v79, v79
    v_mfma_f32_32x32x8_bf16 v[88:103], v[154:155], v[134:135], v[88:103]
    v_cvt_pk_bf16_f32 v106, v76, v77
    v_cvt_pk_bf16_f32 v107, v78, v79
    v_exp_f32 v80, v80
    v_exp_f32 v81, v81
    v_exp_f32 v82, v82
    v_exp_f32 v83, v83
    v_mfma_f32_32x32x16_bf16 v[40:55], v[168:171], v[104:107], v[40:55]
    v_cvt_pk_bf16_f32 v108, v80, v81
    v_cvt_pk_bf16_f32 v109, v82, v83
    v_exp_f32 v84, v84
    v_exp_f32 v85, v85
    v_exp_f32 v86, v86
    v_exp_f32 v87, v87
    v_cvt_pk_bf16_f32 v110, v84, v85
    v_cvt_pk_bf16_f32 v111, v86, v87
    s_waitcnt vmcnt(11)
    v_mfma_f32_32x32x16_bf16 v[72:87], v[144:147], v[112:115], 0
    v_exp_f32 v88, v88
    v_exp_f32 v89, v89
    v_exp_f32 v90, v90
    v_exp_f32 v91, v91
    v_mfma_f32_32x32x16_bf16 v[40:55], v[172:175], v[108:111], v[40:55]
    buffer_load_dwordx4 v[164:167], v199, s[8:11], s22 offen
    v_cvt_pk_bf16_f32 v104, v88, v89
    v_cvt_pk_bf16_f32 v105, v90, v91
    v_exp_f32 v92, v92
    v_exp_f32 v93, v93
    v_exp_f32 v94, v94
    v_exp_f32 v95, v95
    v_mfma_f32_32x32x8_bf16 v[72:87], v[156:157], v[128:129], v[72:87]
    v_cvt_pk_bf16_f32 v106, v92, v93
    v_cvt_pk_bf16_f32 v107, v94, v95
    v_exp_f32 v96, v96
    v_exp_f32 v97, v97
    v_exp_f32 v98, v98
    v_exp_f32 v99, v99
    v_mfma_f32_32x32x16_bf16 v[56:71], v[168:171], v[104:107], v[56:71]
    v_cvt_pk_bf16_f32 v108, v96, v97
    v_cvt_pk_bf16_f32 v109, v98, v99
    v_exp_f32 v100, v100
    v_exp_f32 v101, v101
    v_exp_f32 v102, v102
    v_exp_f32 v103, v103
    v_cvt_pk_bf16_f32 v110, v100, v101
    v_cvt_pk_bf16_f32 v111, v102, v103
    v_mfma_f32_32x32x16_bf16 v[88:103], v[144:147], v[116:119], 0
    v_exp_f32 v72, v72
    v_exp_f32 v73, v73
    v_exp_f32 v74, v74
    v_exp_f32 v75, v75
    v_mfma_f32_32x32x16_bf16 v[56:71], v[172:175], v[108:111], v[56:71]
    buffer_load_dwordx4 v[140:143], v192, s[8:11], s21 offen offset:512
    v_cvt_pk_bf16_f32 v104, v72, v73
    v_cvt_pk_bf16_f32 v105, v74, v75
    v_exp_f32 v76, v76
    v_exp_f32 v77, v77
    v_exp_f32 v78, v78
    v_exp_f32 v79, v79
    v_mfma_f32_32x32x8_bf16 v[88:103], v[156:157], v[130:131], v[88:103]
    v_cvt_pk_bf16_f32 v106, v76, v77
    v_cvt_pk_bf16_f32 v107, v78, v79
    v_exp_f32 v80, v80
    v_exp_f32 v81, v81
    v_exp_f32 v82, v82
    v_exp_f32 v83, v83
    v_mfma_f32_32x32x16_bf16 v[8:23], v[176:179], v[104:107], v[8:23]
    v_cvt_pk_bf16_f32 v108, v80, v81
    v_cvt_pk_bf16_f32 v109, v82, v83
    v_exp_f32 v84, v84
    v_exp_f32 v85, v85
    v_exp_f32 v86, v86
    v_exp_f32 v87, v87
    v_cvt_pk_bf16_f32 v110, v84, v85
    v_cvt_pk_bf16_f32 v111, v86, v87
    v_mfma_f32_32x32x16_bf16 v[72:87], v[144:147], v[120:123], 0
    v_exp_f32 v88, v88
    v_exp_f32 v89, v89
    v_exp_f32 v90, v90
    v_exp_f32 v91, v91
    v_mfma_f32_32x32x16_bf16 v[8:23], v[180:183], v[108:111], v[8:23]
    buffer_load_dwordx2 v[154:155], v193, s[8:11], s21 offen offset:512
    v_cvt_pk_bf16_f32 v104, v88, v89
    v_cvt_pk_bf16_f32 v105, v90, v91
    v_exp_f32 v92, v92
    v_exp_f32 v93, v93
    v_exp_f32 v94, v94
    v_exp_f32 v95, v95
    v_mfma_f32_32x32x8_bf16 v[72:87], v[156:157], v[132:133], v[72:87]
    v_cvt_pk_bf16_f32 v106, v92, v93
    v_cvt_pk_bf16_f32 v107, v94, v95
    v_exp_f32 v96, v96
    v_exp_f32 v97, v97
    v_exp_f32 v98, v98
    v_exp_f32 v99, v99
    v_mfma_f32_32x32x16_bf16 v[24:39], v[176:179], v[104:107], v[24:39]
    v_cvt_pk_bf16_f32 v108, v96, v97
    v_cvt_pk_bf16_f32 v109, v98, v99
    v_exp_f32 v100, v100
    v_exp_f32 v101, v101
    v_exp_f32 v102, v102
    v_exp_f32 v103, v103
    v_cvt_pk_bf16_f32 v110, v100, v101
    v_cvt_pk_bf16_f32 v111, v102, v103
    v_mfma_f32_32x32x16_bf16 v[88:103], v[144:147], v[124:127], 0
    v_exp_f32 v72, v72
    v_exp_f32 v73, v73
    v_exp_f32 v74, v74
    v_exp_f32 v75, v75
    v_mfma_f32_32x32x16_bf16 v[24:39], v[180:183], v[108:111], v[24:39]
    buffer_load_dwordx4 v[168:171], v200, s[8:11], s22 offen
    v_cvt_pk_bf16_f32 v104, v72, v73
    v_cvt_pk_bf16_f32 v105, v74, v75
    v_exp_f32 v76, v76
    v_exp_f32 v77, v77
    v_exp_f32 v78, v78
    v_exp_f32 v79, v79
    v_mfma_f32_32x32x8_bf16 v[88:103], v[156:157], v[134:135], v[88:103]
    v_cvt_pk_bf16_f32 v106, v76, v77
    v_cvt_pk_bf16_f32 v107, v78, v79
    v_exp_f32 v80, v80
    v_exp_f32 v81, v81
    v_exp_f32 v82, v82
    v_exp_f32 v83, v83
    v_mfma_f32_32x32x16_bf16 v[40:55], v[176:179], v[104:107], v[40:55]
    v_cvt_pk_bf16_f32 v108, v80, v81
    v_cvt_pk_bf16_f32 v109, v82, v83
    v_exp_f32 v84, v84
    v_exp_f32 v85, v85
    v_exp_f32 v86, v86
    v_exp_f32 v87, v87
    v_cvt_pk_bf16_f32 v110, v84, v85
    v_cvt_pk_bf16_f32 v111, v86, v87
    s_waitcnt vmcnt(8)
    v_mfma_f32_32x32x16_bf16 v[72:87], v[148:151], v[112:115], 0
    v_exp_f32 v88, v88
    v_exp_f32 v89, v89
    v_exp_f32 v90, v90
    v_exp_f32 v91, v91
    v_mfma_f32_32x32x16_bf16 v[40:55], v[180:183], v[108:111], v[40:55]
    buffer_load_dwordx4 v[172:175], v201, s[8:11], s22 offen
    v_cvt_pk_bf16_f32 v104, v88, v89
    v_cvt_pk_bf16_f32 v105, v90, v91
    v_exp_f32 v92, v92
    v_exp_f32 v93, v93
    v_exp_f32 v94, v94
    v_exp_f32 v95, v95
    v_mfma_f32_32x32x8_bf16 v[72:87], v[158:159], v[128:129], v[72:87]
    v_cvt_pk_bf16_f32 v106, v92, v93
    v_cvt_pk_bf16_f32 v107, v94, v95
    v_exp_f32 v96, v96
    v_exp_f32 v97, v97
    v_exp_f32 v98, v98
    v_exp_f32 v99, v99
    v_mfma_f32_32x32x16_bf16 v[56:71], v[176:179], v[104:107], v[56:71]
    v_cvt_pk_bf16_f32 v108, v96, v97
    v_cvt_pk_bf16_f32 v109, v98, v99
    v_exp_f32 v100, v100
    v_exp_f32 v101, v101
    v_exp_f32 v102, v102
    v_exp_f32 v103, v103
    v_cvt_pk_bf16_f32 v110, v100, v101
    v_cvt_pk_bf16_f32 v111, v102, v103
    v_mfma_f32_32x32x16_bf16 v[88:103], v[148:151], v[116:119], 0
    v_exp_f32 v72, v72
    v_exp_f32 v73, v73
    v_exp_f32 v74, v74
    v_exp_f32 v75, v75
    v_mfma_f32_32x32x16_bf16 v[56:71], v[180:183], v[108:111], v[56:71]
    buffer_load_dwordx4 v[144:147], v192, s[8:11], s21 offen offset:1024
    v_cvt_pk_bf16_f32 v104, v72, v73
    v_cvt_pk_bf16_f32 v105, v74, v75
    v_exp_f32 v76, v76
    v_exp_f32 v77, v77
    v_exp_f32 v78, v78
    v_exp_f32 v79, v79
    v_mfma_f32_32x32x8_bf16 v[88:103], v[158:159], v[130:131], v[88:103]
    v_cvt_pk_bf16_f32 v106, v76, v77
    v_cvt_pk_bf16_f32 v107, v78, v79
    v_exp_f32 v80, v80
    v_exp_f32 v81, v81
    v_exp_f32 v82, v82
    v_exp_f32 v83, v83
    v_mfma_f32_32x32x16_bf16 v[8:23], v[184:187], v[104:107], v[8:23]
    buffer_load_dwordx4 v197, s[8:11], m0 offen offset:3072 sc1 lds
    v_cvt_pk_bf16_f32 v108, v80, v81
    v_cvt_pk_bf16_f32 v109, v82, v83
    v_exp_f32 v84, v84
    v_exp_f32 v85, v85
    v_exp_f32 v86, v86
    v_exp_f32 v87, v87
    v_cvt_pk_bf16_f32 v110, v84, v85
    v_cvt_pk_bf16_f32 v111, v86, v87
    v_mfma_f32_32x32x16_bf16 v[72:87], v[148:151], v[120:123], 0
    v_exp_f32 v88, v88
    v_exp_f32 v89, v89
    v_exp_f32 v90, v90
    v_exp_f32 v91, v91
    v_mfma_f32_32x32x16_bf16 v[8:23], v[188:191], v[108:111], v[8:23]
    buffer_load_dwordx2 v[156:157], v193, s[8:11], s21 offen offset:1024
    v_cvt_pk_bf16_f32 v104, v88, v89
    v_cvt_pk_bf16_f32 v105, v90, v91
    v_exp_f32 v92, v92
    v_exp_f32 v93, v93
    v_exp_f32 v94, v94
    v_exp_f32 v95, v95
    v_mfma_f32_32x32x8_bf16 v[72:87], v[158:159], v[132:133], v[72:87]
    v_cvt_pk_bf16_f32 v106, v92, v93
    v_cvt_pk_bf16_f32 v107, v94, v95
    v_exp_f32 v96, v96
    v_exp_f32 v97, v97
    v_exp_f32 v98, v98
    v_exp_f32 v99, v99
    v_mfma_f32_32x32x16_bf16 v[24:39], v[184:187], v[104:107], v[24:39]
    s_add_u32 m0, s67, 4096
    s_nop 0
    buffer_load_dwordx4 v197, s[8:11], m0 offen offset:0 sc1 lds
    v_cvt_pk_bf16_f32 v108, v96, v97
    v_cvt_pk_bf16_f32 v109, v98, v99
    v_exp_f32 v100, v100
    v_exp_f32 v101, v101
    v_exp_f32 v102, v102
    v_exp_f32 v103, v103
    v_cvt_pk_bf16_f32 v110, v100, v101
    v_cvt_pk_bf16_f32 v111, v102, v103
    v_mfma_f32_32x32x16_bf16 v[88:103], v[148:151], v[124:127], 0
    v_exp_f32 v72, v72
    v_exp_f32 v73, v73
    v_exp_f32 v74, v74
    v_exp_f32 v75, v75
    v_mfma_f32_32x32x16_bf16 v[24:39], v[188:191], v[108:111], v[24:39]
    buffer_load_dwordx4 v[176:179], v202, s[8:11], s22 offen
    v_cvt_pk_bf16_f32 v104, v72, v73
    v_cvt_pk_bf16_f32 v105, v74, v75
    v_exp_f32 v76, v76
    v_exp_f32 v77, v77
    v_exp_f32 v78, v78
    v_exp_f32 v79, v79
    v_mfma_f32_32x32x8_bf16 v[88:103], v[158:159], v[134:135], v[88:103]
    v_cvt_pk_bf16_f32 v106, v76, v77
    v_cvt_pk_bf16_f32 v107, v78, v79
    v_exp_f32 v80, v80
    v_exp_f32 v81, v81
    v_exp_f32 v82, v82
    v_exp_f32 v83, v83
    v_mfma_f32_32x32x16_bf16 v[40:55], v[184:187], v[104:107], v[40:55]
    buffer_load_dwordx4 v197, s[8:11], m0 offen offset:1024 sc1 lds
    v_cvt_pk_bf16_f32 v108, v80, v81
    v_cvt_pk_bf16_f32 v109, v82, v83
    v_exp_f32 v84, v84
    v_exp_f32 v85, v85
    v_exp_f32 v86, v86
    v_exp_f32 v87, v87
    v_cvt_pk_bf16_f32 v110, v84, v85
    v_cvt_pk_bf16_f32 v111, v86, v87
    s_waitcnt vmcnt(10)
    v_mfma_f32_32x32x16_bf16 v[72:87], v[136:139], v[112:115], 0
    v_exp_f32 v88, v88
    v_exp_f32 v89, v89
    v_exp_f32 v90, v90
    v_exp_f32 v91, v91
    v_mfma_f32_32x32x16_bf16 v[40:55], v[188:191], v[108:111], v[40:55]
    buffer_load_dwordx4 v[180:183], v203, s[8:11], s22 offen
    v_cvt_pk_bf16_f32 v104, v88, v89
    v_cvt_pk_bf16_f32 v105, v90, v91
    v_exp_f32 v92, v92
    v_exp_f32 v93, v93
    v_exp_f32 v94, v94
    v_exp_f32 v95, v95
    v_mfma_f32_32x32x8_bf16 v[72:87], v[152:153], v[128:129], v[72:87]
    v_cvt_pk_bf16_f32 v106, v92, v93
    v_cvt_pk_bf16_f32 v107, v94, v95
    v_exp_f32 v96, v96
    v_exp_f32 v97, v97
    v_exp_f32 v98, v98
    v_exp_f32 v99, v99
    v_mfma_f32_32x32x16_bf16 v[56:71], v[184:187], v[104:107], v[56:71]
    buffer_load_dwordx4 v197, s[8:11], m0 offen offset:2048 sc1 lds
    v_cvt_pk_bf16_f32 v108, v96, v97
    v_cvt_pk_bf16_f32 v109, v98, v99
    v_exp_f32 v100, v100
    v_exp_f32 v101, v101
    v_exp_f32 v102, v102
    v_exp_f32 v103, v103
    v_cvt_pk_bf16_f32 v110, v100, v101
    v_cvt_pk_bf16_f32 v111, v102, v103
    v_mfma_f32_32x32x16_bf16 v[88:103], v[136:139], v[116:119], 0
    v_exp_f32 v72, v72
    v_exp_f32 v73, v73
    v_exp_f32 v74, v74
    v_exp_f32 v75, v75
    v_mfma_f32_32x32x16_bf16 v[56:71], v[188:191], v[108:111], v[56:71]
    buffer_load_dwordx4 v[148:151], v192, s[8:11], s21 offen offset:1536
    v_cvt_pk_bf16_f32 v104, v72, v73
    v_cvt_pk_bf16_f32 v105, v74, v75
    v_exp_f32 v76, v76
    v_exp_f32 v77, v77
    v_exp_f32 v78, v78
    v_exp_f32 v79, v79
    v_mfma_f32_32x32x8_bf16 v[88:103], v[152:153], v[130:131], v[88:103]
    v_cvt_pk_bf16_f32 v106, v76, v77
    v_cvt_pk_bf16_f32 v107, v78, v79
    v_exp_f32 v80, v80
    v_exp_f32 v81, v81
    v_exp_f32 v82, v82
    v_exp_f32 v83, v83
    v_mfma_f32_32x32x16_bf16 v[8:23], v[160:163], v[104:107], v[8:23]
    buffer_load_dwordx4 v197, s[8:11], m0 offen offset:3072 sc1 lds
    v_cvt_pk_bf16_f32 v108, v80, v81
    v_cvt_pk_bf16_f32 v109, v82, v83
    v_exp_f32 v84, v84
    v_exp_f32 v85, v85
    v_exp_f32 v86, v86
    v_exp_f32 v87, v87
    v_cvt_pk_bf16_f32 v110, v84, v85
    v_cvt_pk_bf16_f32 v111, v86, v87
    v_mfma_f32_32x32x16_bf16 v[72:87], v[136:139], v[120:123], 0
    v_exp_f32 v88, v88
    v_exp_f32 v89, v89
    v_exp_f32 v90, v90
    v_exp_f32 v91, v91
    v_mfma_f32_32x32x16_bf16 v[8:23], v[164:167], v[108:111], v[8:23]
    buffer_load_dwordx2 v[158:159], v193, s[8:11], s21 offen offset:1536
    v_cvt_pk_bf16_f32 v104, v88, v89
    v_cvt_pk_bf16_f32 v105, v90, v91
    v_exp_f32 v92, v92
    v_exp_f32 v93, v93
    v_exp_f32 v94, v94
    v_exp_f32 v95, v95
    v_mfma_f32_32x32x8_bf16 v[72:87], v[152:153], v[132:133], v[72:87]
    v_cvt_pk_bf16_f32 v106, v92, v93
    v_cvt_pk_bf16_f32 v107, v94, v95
    v_exp_f32 v96, v96
    v_exp_f32 v97, v97
    v_exp_f32 v98, v98
    v_exp_f32 v99, v99
    v_mfma_f32_32x32x16_bf16 v[24:39], v[160:163], v[104:107], v[24:39]
    s_add_u32 m0, s67, 8192
    s_nop 0
    buffer_load_dwordx4 v197, s[8:11], m0 offen offset:0 sc1 lds
    v_cvt_pk_bf16_f32 v108, v96, v97
    v_cvt_pk_bf16_f32 v109, v98, v99
    v_exp_f32 v100, v100
    v_exp_f32 v101, v101
    v_exp_f32 v102, v102
    v_exp_f32 v103, v103
    v_cvt_pk_bf16_f32 v110, v100, v101
    v_cvt_pk_bf16_f32 v111, v102, v103
    v_mfma_f32_32x32x16_bf16 v[88:103], v[136:139], v[124:127], 0
    v_exp_f32 v72, v72
    v_exp_f32 v73, v73
    v_exp_f32 v74, v74
    v_exp_f32 v75, v75
    v_mfma_f32_32x32x16_bf16 v[24:39], v[164:167], v[108:111], v[24:39]
    buffer_load_dwordx4 v[184:187], v204, s[8:11], s22 offen
    v_cvt_pk_bf16_f32 v104, v72, v73
    v_cvt_pk_bf16_f32 v105, v74, v75
    v_exp_f32 v76, v76
    v_exp_f32 v77, v77
    v_exp_f32 v78, v78
    v_exp_f32 v79, v79
    v_mfma_f32_32x32x8_bf16 v[88:103], v[152:153], v[134:135], v[88:103]
    v_cvt_pk_bf16_f32 v106, v76, v77
    v_cvt_pk_bf16_f32 v107, v78, v79
    v_exp_f32 v80, v80
    v_exp_f32 v81, v81
    v_exp_f32 v82, v82
    v_exp_f32 v83, v83
    v_mfma_f32_32x32x16_bf16 v[40:55], v[160:163], v[104:107], v[40:55]
    buffer_load_dwordx4 v197, s[8:11], m0 offen offset:1024 sc1 lds
    v_cvt_pk_bf16_f32 v108, v80, v81
    v_cvt_pk_bf16_f32 v109, v82, v83
    v_exp_f32 v84, v84
    v_exp_f32 v85, v85
    v_exp_f32 v86, v86
    v_exp_f32 v87, v87
    v_cvt_pk_bf16_f32 v110, v84, v85
    v_cvt_pk_bf16_f32 v111, v86, v87
    s_waitcnt vmcnt(14)
    v_mfma_f32_32x32x16_bf16 v[72:87], v[140:143], v[112:115], 0
    v_exp_f32 v88, v88
    v_exp_f32 v89, v89
    v_exp_f32 v90, v90
    v_exp_f32 v91, v91
    v_mfma_f32_32x32x16_bf16 v[40:55], v[164:167], v[108:111], v[40:55]
    buffer_load_dwordx4 v[188:191], v205, s[8:11], s22 offen
    v_cvt_pk_bf16_f32 v104, v88, v89
    v_cvt_pk_bf16_f32 v105, v90, v91
    v_exp_f32 v92, v92
    v_exp_f32 v93, v93
    v_exp_f32 v94, v94
    v_exp_f32 v95, v95
    v_mfma_f32_32x32x8_bf16 v[72:87], v[154:155], v[128:129], v[72:87]
    v_cvt_pk_bf16_f32 v106, v92, v93
    v_cvt_pk_bf16_f32 v107, v94, v95
    v_exp_f32 v96, v96
    v_exp_f32 v97, v97
    v_exp_f32 v98, v98
    v_exp_f32 v99, v99
    v_mfma_f32_32x32x16_bf16 v[56:71], v[160:163], v[104:107], v[56:71]
    s_mov_b32 s23, 1572864
    buffer_load_dword v7, v196, s[52:55], s23 offen
    v_cvt_pk_bf16_f32 v108, v96, v97
    v_cvt_pk_bf16_f32 v109, v98, v99
    v_exp_f32 v100, v100
    v_exp_f32 v101, v101
    v_exp_f32 v102, v102
    v_exp_f32 v103, v103
    v_cvt_pk_bf16_f32 v110, v100, v101
    v_cvt_pk_bf16_f32 v111, v102, v103
    v_mfma_f32_32x32x16_bf16 v[88:103], v[140:143], v[116:119], 0
    v_exp_f32 v72, v72
    v_exp_f32 v73, v73
    v_exp_f32 v74, v74
    v_exp_f32 v75, v75
    v_mfma_f32_32x32x16_bf16 v[56:71], v[164:167], v[108:111], v[56:71]
    s_add_u32 s22, s22, 165888
    s_add_u32 s21, s21, 2048
    buffer_load_dwordx4 v[136:139], v192, s[8:11], s21 offen offset:0
    v_cvt_pk_bf16_f32 v104, v72, v73
    v_cvt_pk_bf16_f32 v105, v74, v75
    v_exp_f32 v76, v76
    v_exp_f32 v77, v77
    v_exp_f32 v78, v78
    v_exp_f32 v79, v79
    v_mfma_f32_32x32x8_bf16 v[88:103], v[154:155], v[130:131], v[88:103]
    v_cvt_pk_bf16_f32 v106, v76, v77
    v_cvt_pk_bf16_f32 v107, v78, v79
    v_exp_f32 v80, v80
    v_exp_f32 v81, v81
    v_exp_f32 v82, v82
    v_exp_f32 v83, v83
    v_mfma_f32_32x32x16_bf16 v[8:23], v[168:171], v[104:107], v[8:23]
    v_cvt_pk_bf16_f32 v108, v80, v81
    v_cvt_pk_bf16_f32 v109, v82, v83
    v_exp_f32 v84, v84
    v_exp_f32 v85, v85
    v_exp_f32 v86, v86
    v_exp_f32 v87, v87
    v_cvt_pk_bf16_f32 v110, v84, v85
    v_cvt_pk_bf16_f32 v111, v86, v87
    v_mfma_f32_32x32x16_bf16 v[72:87], v[140:143], v[120:123], 0
    v_exp_f32 v88, v88
    v_exp_f32 v89, v89
    v_exp_f32 v90, v90
    v_exp_f32 v91, v91
    v_mfma_f32_32x32x16_bf16 v[8:23], v[172:175], v[108:111], v[8:23]
    buffer_load_dwordx2 v[152:153], v193, s[8:11], s21 offen offset:0
    v_cvt_pk_bf16_f32 v104, v88, v89
    v_cvt_pk_bf16_f32 v105, v90, v91
    v_exp_f32 v92, v92
    v_exp_f32 v93, v93
    v_exp_f32 v94, v94
    v_exp_f32 v95, v95
    v_mfma_f32_32x32x8_bf16 v[72:87], v[154:155], v[132:133], v[72:87]
    v_cvt_pk_bf16_f32 v106, v92, v93
    v_cvt_pk_bf16_f32 v107, v94, v95
    v_exp_f32 v96, v96
    v_exp_f32 v97, v97
    v_exp_f32 v98, v98
    v_exp_f32 v99, v99
    v_mfma_f32_32x32x16_bf16 v[24:39], v[168:171], v[104:107], v[24:39]
    v_cvt_pk_bf16_f32 v108, v96, v97
    v_cvt_pk_bf16_f32 v109, v98, v99
    v_exp_f32 v100, v100
    v_exp_f32 v101, v101
    v_exp_f32 v102, v102
    v_exp_f32 v103, v103
    v_cvt_pk_bf16_f32 v110, v100, v101
    v_cvt_pk_bf16_f32 v111, v102, v103
    v_mfma_f32_32x32x16_bf16 v[88:103], v[140:143], v[124:127], 0
    v_exp_f32 v72, v72
    v_exp_f32 v73, v73
    v_exp_f32 v74, v74
    v_exp_f32 v75, v75
    v_mfma_f32_32x32x16_bf16 v[24:39], v[172:175], v[108:111], v[24:39]
    buffer_load_dwordx4 v[160:163], v198, s[8:11], s22 offen
    v_cvt_pk_bf16_f32 v104, v72, v73
    v_cvt_pk_bf16_f32 v105, v74, v75
    v_exp_f32 v76, v76
    v_exp_f32 v77, v77
    v_exp_f32 v78, v78
    v_exp_f32 v79, v79
    v_mfma_f32_32x32x8_bf16 v[88:103], v[154:155], v[134:135], v[88:103]
    v_cvt_pk_bf16_f32 v106, v76, v77
    v_cvt_pk_bf16_f32 v107, v78, v79
    v_exp_f32 v80, v80
    v_exp_f32 v81, v81
    v_exp_f32 v82, v82
    v_exp_f32 v83, v83
    v_mfma_f32_32x32x16_bf16 v[40:55], v[168:171], v[104:107], v[40:55]
    v_cvt_pk_bf16_f32 v108, v80, v81
    v_cvt_pk_bf16_f32 v109, v82, v83
    v_exp_f32 v84, v84
    v_exp_f32 v85, v85
    v_exp_f32 v86, v86
    v_exp_f32 v87, v87
    v_cvt_pk_bf16_f32 v110, v84, v85
    v_cvt_pk_bf16_f32 v111, v86, v87
    s_waitcnt vmcnt(12)
    v_mfma_f32_32x32x16_bf16 v[72:87], v[144:147], v[112:115], 0
    v_exp_f32 v88, v88
    v_exp_f32 v89, v89
    v_exp_f32 v90, v90
    v_exp_f32 v91, v91
    v_mfma_f32_32x32x16_bf16 v[40:55], v[172:175], v[108:111], v[40:55]
    buffer_load_dwordx4 v[164:167], v199, s[8:11], s22 offen
    v_cvt_pk_bf16_f32 v104, v88, v89
    v_cvt_pk_bf16_f32 v105, v90, v91
    v_exp_f32 v92, v92
    v_exp_f32 v93, v93
    v_exp_f32 v94, v94
    v_exp_f32 v95, v95
    v_mfma_f32_32x32x8_bf16 v[72:87], v[156:157], v[128:129], v[72:87]
    v_cvt_pk_bf16_f32 v106, v92, v93
    v_cvt_pk_bf16_f32 v107, v94, v95
    v_exp_f32 v96, v96
    v_exp_f32 v97, v97
    v_exp_f32 v98, v98
    v_exp_f32 v99, v99
    v_mfma_f32_32x32x16_bf16 v[56:71], v[168:171], v[104:107], v[56:71]
    v_cvt_pk_bf16_f32 v108, v96, v97
    v_cvt_pk_bf16_f32 v109, v98, v99
    v_exp_f32 v100, v100
    v_exp_f32 v101, v101
    v_exp_f32 v102, v102
    v_exp_f32 v103, v103
    v_cvt_pk_bf16_f32 v110, v100, v101
    v_cvt_pk_bf16_f32 v111, v102, v103
    v_mfma_f32_32x32x16_bf16 v[88:103], v[144:147], v[116:119], 0
    v_exp_f32 v72, v72
    v_exp_f32 v73, v73
    v_exp_f32 v74, v74
    v_exp_f32 v75, v75
    v_mfma_f32_32x32x16_bf16 v[56:71], v[172:175], v[108:111], v[56:71]
    buffer_load_dwordx4 v[140:143], v192, s[8:11], s21 offen offset:512
    v_cvt_pk_bf16_f32 v104, v72, v73
    v_cvt_pk_bf16_f32 v105, v74, v75
    v_exp_f32 v76, v76
    v_exp_f32 v77, v77
    v_exp_f32 v78, v78
    v_exp_f32 v79, v79
    v_mfma_f32_32x32x8_bf16 v[88:103], v[156:157], v[130:131], v[88:103]
    v_cvt_pk_bf16_f32 v106, v76, v77
    v_cvt_pk_bf16_f32 v107, v78, v79
    v_exp_f32 v80, v80
    v_exp_f32 v81, v81
    v_exp_f32 v82, v82
    v_exp_f32 v83, v83
    v_mfma_f32_32x32x16_bf16 v[8:23], v[176:179], v[104:107], v[8:23]
    v_cvt_pk_bf16_f32 v108, v80, v81
    v_cvt_pk_bf16_f32 v109, v82, v83
    v_exp_f32 v84, v84
    v_exp_f32 v85, v85
    v_exp_f32 v86, v86
    v_exp_f32 v87, v87
    v_cvt_pk_bf16_f32 v110, v84, v85
    v_cvt_pk_bf16_f32 v111, v86, v87
    v_mfma_f32_32x32x16_bf16 v[72:87], v[144:147], v[120:123], 0
    v_exp_f32 v88, v88
    v_exp_f32 v89, v89
    v_exp_f32 v90, v90
    v_exp_f32 v91, v91
    v_mfma_f32_32x32x16_bf16 v[8:23], v[180:183], v[108:111], v[8:23]
    buffer_load_dwordx2 v[154:155], v193, s[8:11], s21 offen offset:512
    v_cvt_pk_bf16_f32 v104, v88, v89
    v_cvt_pk_bf16_f32 v105, v90, v91
    v_exp_f32 v92, v92
    v_exp_f32 v93, v93
    v_exp_f32 v94, v94
    v_exp_f32 v95, v95
    v_mfma_f32_32x32x8_bf16 v[72:87], v[156:157], v[132:133], v[72:87]
    v_cvt_pk_bf16_f32 v106, v92, v93
    v_cvt_pk_bf16_f32 v107, v94, v95
    v_exp_f32 v96, v96
    v_exp_f32 v97, v97
    v_exp_f32 v98, v98
    v_exp_f32 v99, v99
    v_mfma_f32_32x32x16_bf16 v[24:39], v[176:179], v[104:107], v[24:39]
    v_cvt_pk_bf16_f32 v108, v96, v97
    v_cvt_pk_bf16_f32 v109, v98, v99
    v_exp_f32 v100, v100
    v_exp_f32 v101, v101
    v_exp_f32 v102, v102
    v_exp_f32 v103, v103
    v_cvt_pk_bf16_f32 v110, v100, v101
    v_cvt_pk_bf16_f32 v111, v102, v103
    v_mfma_f32_32x32x16_bf16 v[88:103], v[144:147], v[124:127], 0
    v_exp_f32 v72, v72
    v_exp_f32 v73, v73
    v_exp_f32 v74, v74
    v_exp_f32 v75, v75
    v_mfma_f32_32x32x16_bf16 v[24:39], v[180:183], v[108:111], v[24:39]
    buffer_load_dwordx4 v[168:171], v200, s[8:11], s22 offen
    v_cvt_pk_bf16_f32 v104, v72, v73
    v_cvt_pk_bf16_f32 v105, v74, v75
    v_exp_f32 v76, v76
    v_exp_f32 v77, v77
    v_exp_f32 v78, v78
    v_exp_f32 v79, v79
    v_mfma_f32_32x32x8_bf16 v[88:103], v[156:157], v[134:135], v[88:103]
    v_cvt_pk_bf16_f32 v106, v76, v77
    v_cvt_pk_bf16_f32 v107, v78, v79
    v_exp_f32 v80, v80
    v_exp_f32 v81, v81
    v_exp_f32 v82, v82
    v_exp_f32 v83, v83
    v_mfma_f32_32x32x16_bf16 v[40:55], v[176:179], v[104:107], v[40:55]
    v_cvt_pk_bf16_f32 v108, v80, v81
    v_cvt_pk_bf16_f32 v109, v82, v83
    v_exp_f32 v84, v84
    v_exp_f32 v85, v85
    v_exp_f32 v86, v86
    v_exp_f32 v87, v87
    v_cvt_pk_bf16_f32 v110, v84, v85
    v_cvt_pk_bf16_f32 v111, v86, v87
    s_waitcnt vmcnt(8)
    v_mfma_f32_32x32x16_bf16 v[72:87], v[148:151], v[112:115], 0
    v_exp_f32 v88, v88
    v_exp_f32 v89, v89
    v_exp_f32 v90, v90
    v_exp_f32 v91, v91
    v_mfma_f32_32x32x16_bf16 v[40:55], v[180:183], v[108:111], v[40:55]
    buffer_load_dwordx4 v[172:175], v201, s[8:11], s22 offen
    v_cvt_pk_bf16_f32 v104, v88, v89
    v_cvt_pk_bf16_f32 v105, v90, v91
    v_exp_f32 v92, v92
    v_exp_f32 v93, v93
    v_exp_f32 v94, v94
    v_exp_f32 v95, v95
    v_mfma_f32_32x32x8_bf16 v[72:87], v[158:159], v[128:129], v[72:87]
    v_cvt_pk_bf16_f32 v106, v92, v93
    v_cvt_pk_bf16_f32 v107, v94, v95
    v_exp_f32 v96, v96
    v_exp_f32 v97, v97
    v_exp_f32 v98, v98
    v_exp_f32 v99, v99
    v_mfma_f32_32x32x16_bf16 v[56:71], v[176:179], v[104:107], v[56:71]
    v_cvt_pk_bf16_f32 v108, v96, v97
    v_cvt_pk_bf16_f32 v109, v98, v99
    v_exp_f32 v100, v100
    v_exp_f32 v101, v101
    v_exp_f32 v102, v102
    v_exp_f32 v103, v103
    v_cvt_pk_bf16_f32 v110, v100, v101
    v_cvt_pk_bf16_f32 v111, v102, v103
    v_mfma_f32_32x32x16_bf16 v[88:103], v[148:151], v[116:119], 0
    v_exp_f32 v72, v72
    v_exp_f32 v73, v73
    v_exp_f32 v74, v74
    v_exp_f32 v75, v75
    v_mfma_f32_32x32x16_bf16 v[56:71], v[180:183], v[108:111], v[56:71]
    buffer_load_dwordx4 v[144:147], v192, s[8:11], s21 offen offset:1024
    v_cvt_pk_bf16_f32 v104, v72, v73
    v_cvt_pk_bf16_f32 v105, v74, v75
    v_exp_f32 v76, v76
    v_exp_f32 v77, v77
    v_exp_f32 v78, v78
    v_exp_f32 v79, v79
    v_mfma_f32_32x32x8_bf16 v[88:103], v[158:159], v[130:131], v[88:103]
    v_cvt_pk_bf16_f32 v106, v76, v77
    v_cvt_pk_bf16_f32 v107, v78, v79
    v_exp_f32 v80, v80
    v_exp_f32 v81, v81
    v_exp_f32 v82, v82
    v_exp_f32 v83, v83
    v_mfma_f32_32x32x16_bf16 v[8:23], v[184:187], v[104:107], v[8:23]
    buffer_load_dwordx4 v197, s[8:11], m0 offen offset:2048 sc1 lds
    v_cvt_pk_bf16_f32 v108, v80, v81
    v_cvt_pk_bf16_f32 v109, v82, v83
    v_exp_f32 v84, v84
    v_exp_f32 v85, v85
    v_exp_f32 v86, v86
    v_exp_f32 v87, v87
    v_cvt_pk_bf16_f32 v110, v84, v85
    v_cvt_pk_bf16_f32 v111, v86, v87
    v_mfma_f32_32x32x16_bf16 v[72:87], v[148:151], v[120:123], 0
    v_exp_f32 v88, v88
    v_exp_f32 v89, v89
    v_exp_f32 v90, v90
    v_exp_f32 v91, v91
    v_mfma_f32_32x32x16_bf16 v[8:23], v[188:191], v[108:111], v[8:23]
    buffer_load_dwordx2 v[156:157], v193, s[8:11], s21 offen offset:1024
    v_cvt_pk_bf16_f32 v104, v88, v89
    v_cvt_pk_bf16_f32 v105, v90, v91
    v_exp_f32 v92, v92
    v_exp_f32 v93, v93
    v_exp_f32 v94, v94
    v_exp_f32 v95, v95
    v_mfma_f32_32x32x8_bf16 v[72:87], v[158:159], v[132:133], v[72:87]
    v_cvt_pk_bf16_f32 v106, v92, v93
    v_cvt_pk_bf16_f32 v107, v94, v95
    v_exp_f32 v96, v96
    v_exp_f32 v97, v97
    v_exp_f32 v98, v98
    v_exp_f32 v99, v99
    v_mfma_f32_32x32x16_bf16 v[24:39], v[184:187], v[104:107], v[24:39]
    buffer_load_dwordx4 v197, s[8:11], m0 offen offset:3072 sc1 lds
    v_cvt_pk_bf16_f32 v108, v96, v97
    v_cvt_pk_bf16_f32 v109, v98, v99
    v_exp_f32 v100, v100
    v_exp_f32 v101, v101
    v_exp_f32 v102, v102
    v_exp_f32 v103, v103
    v_cvt_pk_bf16_f32 v110, v100, v101
    v_cvt_pk_bf16_f32 v111, v102, v103
    v_mfma_f32_32x32x16_bf16 v[88:103], v[148:151], v[124:127], 0
    v_exp_f32 v72, v72
    v_exp_f32 v73, v73
    v_exp_f32 v74, v74
    v_exp_f32 v75, v75
    v_mfma_f32_32x32x16_bf16 v[24:39], v[188:191], v[108:111], v[24:39]
    buffer_load_dwordx4 v[176:179], v202, s[8:11], s22 offen
    v_cvt_pk_bf16_f32 v104, v72, v73
    v_cvt_pk_bf16_f32 v105, v74, v75
    v_exp_f32 v76, v76
    v_exp_f32 v77, v77
    v_exp_f32 v78, v78
    v_exp_f32 v79, v79
    v_mfma_f32_32x32x8_bf16 v[88:103], v[158:159], v[134:135], v[88:103]
    v_cvt_pk_bf16_f32 v106, v76, v77
    v_cvt_pk_bf16_f32 v107, v78, v79
    v_exp_f32 v80, v80
    v_exp_f32 v81, v81
    v_exp_f32 v82, v82
    v_exp_f32 v83, v83
    v_mfma_f32_32x32x16_bf16 v[40:55], v[184:187], v[104:107], v[40:55]
    s_add_u32 m0, s67, 12288
    s_nop 0
    buffer_load_dwordx4 v197, s[8:11], m0 offen offset:0 sc1 lds
    v_cvt_pk_bf16_f32 v108, v80, v81
    v_cvt_pk_bf16_f32 v109, v82, v83
    v_exp_f32 v84, v84
    v_exp_f32 v85, v85
    v_exp_f32 v86, v86
    v_exp_f32 v87, v87
    v_cvt_pk_bf16_f32 v110, v84, v85
    v_cvt_pk_bf16_f32 v111, v86, v87
    s_waitcnt vmcnt(10)
    v_mfma_f32_32x32x16_bf16 v[72:87], v[136:139], v[112:115], 0
    v_exp_f32 v88, v88
    v_exp_f32 v89, v89
    v_exp_f32 v90, v90
    v_exp_f32 v91, v91
    v_mfma_f32_32x32x16_bf16 v[40:55], v[188:191], v[108:111], v[40:55]
    buffer_load_dwordx4 v[180:183], v203, s[8:11], s22 offen
    v_cvt_pk_bf16_f32 v104, v88, v89
    v_cvt_pk_bf16_f32 v105, v90, v91
    v_exp_f32 v92, v92
    v_exp_f32 v93, v93
    v_exp_f32 v94, v94
    v_exp_f32 v95, v95
    v_mfma_f32_32x32x8_bf16 v[72:87], v[152:153], v[128:129], v[72:87]
    v_cvt_pk_bf16_f32 v106, v92, v93
    v_cvt_pk_bf16_f32 v107, v94, v95
    v_exp_f32 v96, v96
    v_exp_f32 v97, v97
    v_exp_f32 v98, v98
    v_exp_f32 v99, v99
    v_mfma_f32_32x32x16_bf16 v[56:71], v[184:187], v[104:107], v[56:71]
    buffer_load_dwordx4 v197, s[8:11], m0 offen offset:1024 sc1 lds
    v_cvt_pk_bf16_f32 v108, v96, v97
    v_cvt_pk_bf16_f32 v109, v98, v99
    v_exp_f32 v100, v100
    v_exp_f32 v101, v101
    v_exp_f32 v102, v102
    v_exp_f32 v103, v103
    v_cvt_pk_bf16_f32 v110, v100, v101
    v_cvt_pk_bf16_f32 v111, v102, v103
    v_mfma_f32_32x32x16_bf16 v[88:103], v[136:139], v[116:119], 0
    v_exp_f32 v72, v72
    v_exp_f32 v73, v73
    v_exp_f32 v74, v74
    v_exp_f32 v75, v75
    v_mfma_f32_32x32x16_bf16 v[56:71], v[188:191], v[108:111], v[56:71]
    buffer_load_dwordx4 v[148:151], v192, s[8:11], s21 offen offset:1536
    v_cvt_pk_bf16_f32 v104, v72, v73
    v_cvt_pk_bf16_f32 v105, v74, v75
    v_exp_f32 v76, v76
    v_exp_f32 v77, v77
    v_exp_f32 v78, v78
    v_exp_f32 v79, v79
    v_mfma_f32_32x32x8_bf16 v[88:103], v[152:153], v[130:131], v[88:103]
    v_cvt_pk_bf16_f32 v106, v76, v77
    v_cvt_pk_bf16_f32 v107, v78, v79
    v_exp_f32 v80, v80
    v_exp_f32 v81, v81
    v_exp_f32 v82, v82
    v_exp_f32 v83, v83
    v_mfma_f32_32x32x16_bf16 v[8:23], v[160:163], v[104:107], v[8:23]
    buffer_load_dwordx4 v197, s[8:11], m0 offen offset:2048 sc1 lds
    v_cvt_pk_bf16_f32 v108, v80, v81
    v_cvt_pk_bf16_f32 v109, v82, v83
    v_exp_f32 v84, v84
    v_exp_f32 v85, v85
    v_exp_f32 v86, v86
    v_exp_f32 v87, v87
    v_cvt_pk_bf16_f32 v110, v84, v85
    v_cvt_pk_bf16_f32 v111, v86, v87
    v_mfma_f32_32x32x16_bf16 v[72:87], v[136:139], v[120:123], 0
    v_exp_f32 v88, v88
    v_exp_f32 v89, v89
    v_exp_f32 v90, v90
    v_exp_f32 v91, v91
    v_mfma_f32_32x32x16_bf16 v[8:23], v[164:167], v[108:111], v[8:23]
    buffer_load_dwordx2 v[158:159], v193, s[8:11], s21 offen offset:1536
    v_cvt_pk_bf16_f32 v104, v88, v89
    v_cvt_pk_bf16_f32 v105, v90, v91
    v_exp_f32 v92, v92
    v_exp_f32 v93, v93
    v_exp_f32 v94, v94
    v_exp_f32 v95, v95
    v_mfma_f32_32x32x8_bf16 v[72:87], v[152:153], v[132:133], v[72:87]
    v_cvt_pk_bf16_f32 v106, v92, v93
    v_cvt_pk_bf16_f32 v107, v94, v95
    v_exp_f32 v96, v96
    v_exp_f32 v97, v97
    v_exp_f32 v98, v98
    v_exp_f32 v99, v99
    v_mfma_f32_32x32x16_bf16 v[24:39], v[160:163], v[104:107], v[24:39]
    buffer_load_dwordx4 v197, s[8:11], m0 offen offset:3072 sc1 lds
    v_cvt_pk_bf16_f32 v108, v96, v97
    v_cvt_pk_bf16_f32 v109, v98, v99
    v_exp_f32 v100, v100
    v_exp_f32 v101, v101
    v_exp_f32 v102, v102
    v_exp_f32 v103, v103
    v_cvt_pk_bf16_f32 v110, v100, v101
    v_cvt_pk_bf16_f32 v111, v102, v103
    v_mfma_f32_32x32x16_bf16 v[88:103], v[136:139], v[124:127], 0
    v_exp_f32 v72, v72
    v_exp_f32 v73, v73
    v_exp_f32 v74, v74
    v_exp_f32 v75, v75
    v_mfma_f32_32x32x16_bf16 v[24:39], v[164:167], v[108:111], v[24:39]
    buffer_load_dwordx4 v[184:187], v204, s[8:11], s22 offen
    v_cvt_pk_bf16_f32 v104, v72, v73
    v_cvt_pk_bf16_f32 v105, v74, v75
    v_exp_f32 v76, v76
    v_exp_f32 v77, v77
    v_exp_f32 v78, v78
    v_exp_f32 v79, v79
    v_mfma_f32_32x32x8_bf16 v[88:103], v[152:153], v[134:135], v[88:103]
    v_cvt_pk_bf16_f32 v106, v76, v77
    v_cvt_pk_bf16_f32 v107, v78, v79
    v_exp_f32 v80, v80
    v_exp_f32 v81, v81
    v_exp_f32 v82, v82
    v_exp_f32 v83, v83
    v_mfma_f32_32x32x16_bf16 v[40:55], v[160:163], v[104:107], v[40:55]
    s_add_u32 m0, s67, 16384
    s_nop 0
    buffer_load_dwordx4 v197, s[8:11], m0 offen offset:0 sc1 lds
    v_cvt_pk_bf16_f32 v108, v80, v81
    v_cvt_pk_bf16_f32 v109, v82, v83
    v_exp_f32 v84, v84
    v_exp_f32 v85, v85
    v_exp_f32 v86, v86
    v_exp_f32 v87, v87
    v_cvt_pk_bf16_f32 v110, v84, v85
    v_cvt_pk_bf16_f32 v111, v86, v87
    s_waitcnt vmcnt(14)
    v_mfma_f32_32x32x16_bf16 v[72:87], v[140:143], v[112:115], 0
    v_exp_f32 v88, v88
    v_exp_f32 v89, v89
    v_exp_f32 v90, v90
    v_exp_f32 v91, v91
    v_mfma_f32_32x32x16_bf16 v[40:55], v[164:167], v[108:111], v[40:55]
    buffer_load_dwordx4 v[188:191], v205, s[8:11], s22 offen
    v_cvt_pk_bf16_f32 v104, v88, v89
    v_cvt_pk_bf16_f32 v105, v90, v91
    v_exp_f32 v92, v92
    v_exp_f32 v93, v93
    v_exp_f32 v94, v94
    v_exp_f32 v95, v95
    v_mfma_f32_32x32x8_bf16 v[72:87], v[154:155], v[128:129], v[72:87]
    v_cvt_pk_bf16_f32 v106, v92, v93
    v_cvt_pk_bf16_f32 v107, v94, v95
    v_exp_f32 v96, v96
    v_exp_f32 v97, v97
    v_exp_f32 v98, v98
    v_exp_f32 v99, v99
    v_mfma_f32_32x32x16_bf16 v[56:71], v[160:163], v[104:107], v[56:71]
    s_mov_b32 s23, 3145728
    buffer_load_dword v7, v196, s[52:55], s23 offen
    v_cvt_pk_bf16_f32 v108, v96, v97
    v_cvt_pk_bf16_f32 v109, v98, v99
    v_exp_f32 v100, v100
    v_exp_f32 v101, v101
    v_exp_f32 v102, v102
    v_exp_f32 v103, v103
    v_cvt_pk_bf16_f32 v110, v100, v101
    v_cvt_pk_bf16_f32 v111, v102, v103
    v_mfma_f32_32x32x16_bf16 v[88:103], v[140:143], v[116:119], 0
    v_exp_f32 v72, v72
    v_exp_f32 v73, v73
    v_exp_f32 v74, v74
    v_exp_f32 v75, v75
    v_mfma_f32_32x32x16_bf16 v[56:71], v[164:167], v[108:111], v[56:71]
    s_add_u32 s22, s22, 165888
    s_add_u32 s21, s21, 2048
    buffer_load_dwordx4 v[136:139], v192, s[8:11], s21 offen offset:0
    v_cvt_pk_bf16_f32 v104, v72, v73
    v_cvt_pk_bf16_f32 v105, v74, v75
    v_exp_f32 v76, v76
    v_exp_f32 v77, v77
    v_exp_f32 v78, v78
    v_exp_f32 v79, v79
    v_mfma_f32_32x32x8_bf16 v[88:103], v[154:155], v[130:131], v[88:103]
    v_cvt_pk_bf16_f32 v106, v76, v77
    v_cvt_pk_bf16_f32 v107, v78, v79
    v_exp_f32 v80, v80
    v_exp_f32 v81, v81
    v_exp_f32 v82, v82
    v_exp_f32 v83, v83
    v_mfma_f32_32x32x16_bf16 v[8:23], v[168:171], v[104:107], v[8:23]
    v_cvt_pk_bf16_f32 v108, v80, v81
    v_cvt_pk_bf16_f32 v109, v82, v83
    v_exp_f32 v84, v84
    v_exp_f32 v85, v85
    v_exp_f32 v86, v86
    v_exp_f32 v87, v87
    v_cvt_pk_bf16_f32 v110, v84, v85
    v_cvt_pk_bf16_f32 v111, v86, v87
    v_mfma_f32_32x32x16_bf16 v[72:87], v[140:143], v[120:123], 0
    v_exp_f32 v88, v88
    v_exp_f32 v89, v89
    v_exp_f32 v90, v90
    v_exp_f32 v91, v91
    v_mfma_f32_32x32x16_bf16 v[8:23], v[172:175], v[108:111], v[8:23]
    buffer_load_dwordx2 v[152:153], v193, s[8:11], s21 offen offset:0
    v_cvt_pk_bf16_f32 v104, v88, v89
    v_cvt_pk_bf16_f32 v105, v90, v91
    v_exp_f32 v92, v92
    v_exp_f32 v93, v93
    v_exp_f32 v94, v94
    v_exp_f32 v95, v95
    v_mfma_f32_32x32x8_bf16 v[72:87], v[154:155], v[132:133], v[72:87]
    v_cvt_pk_bf16_f32 v106, v92, v93
    v_cvt_pk_bf16_f32 v107, v94, v95
    v_exp_f32 v96, v96
    v_exp_f32 v97, v97
    v_exp_f32 v98, v98
    v_exp_f32 v99, v99
    v_mfma_f32_32x32x16_bf16 v[24:39], v[168:171], v[104:107], v[24:39]
    v_cvt_pk_bf16_f32 v108, v96, v97
    v_cvt_pk_bf16_f32 v109, v98, v99
    v_exp_f32 v100, v100
    v_exp_f32 v101, v101
    v_exp_f32 v102, v102
    v_exp_f32 v103, v103
    v_cvt_pk_bf16_f32 v110, v100, v101
    v_cvt_pk_bf16_f32 v111, v102, v103
    v_mfma_f32_32x32x16_bf16 v[88:103], v[140:143], v[124:127], 0
    v_exp_f32 v72, v72
    v_exp_f32 v73, v73
    v_exp_f32 v74, v74
    v_exp_f32 v75, v75
    v_mfma_f32_32x32x16_bf16 v[24:39], v[172:175], v[108:111], v[24:39]
    buffer_load_dwordx4 v[160:163], v198, s[8:11], s22 offen
    v_cvt_pk_bf16_f32 v104, v72, v73
    v_cvt_pk_bf16_f32 v105, v74, v75
    v_exp_f32 v76, v76
    v_exp_f32 v77, v77
    v_exp_f32 v78, v78
    v_exp_f32 v79, v79
    v_mfma_f32_32x32x8_bf16 v[88:103], v[154:155], v[134:135], v[88:103]
    v_cvt_pk_bf16_f32 v106, v76, v77
    v_cvt_pk_bf16_f32 v107, v78, v79
    v_exp_f32 v80, v80
    v_exp_f32 v81, v81
    v_exp_f32 v82, v82
    v_exp_f32 v83, v83
    v_mfma_f32_32x32x16_bf16 v[40:55], v[168:171], v[104:107], v[40:55]
    v_cvt_pk_bf16_f32 v108, v80, v81
    v_cvt_pk_bf16_f32 v109, v82, v83
    v_exp_f32 v84, v84
    v_exp_f32 v85, v85
    v_exp_f32 v86, v86
    v_exp_f32 v87, v87
    v_cvt_pk_bf16_f32 v110, v84, v85
    v_cvt_pk_bf16_f32 v111, v86, v87
    s_waitcnt vmcnt(12)
    v_mfma_f32_32x32x16_bf16 v[72:87], v[144:147], v[112:115], 0
    v_exp_f32 v88, v88
    v_exp_f32 v89, v89
    v_exp_f32 v90, v90
    v_exp_f32 v91, v91
    v_mfma_f32_32x32x16_bf16 v[40:55], v[172:175], v[108:111], v[40:55]
    buffer_load_dwordx4 v[164:167], v199, s[8:11], s22 offen
    v_cvt_pk_bf16_f32 v104, v88, v89
    v_cvt_pk_bf16_f32 v105, v90, v91
    v_exp_f32 v92, v92
    v_exp_f32 v93, v93
    v_exp_f32 v94, v94
    v_exp_f32 v95, v95
    v_mfma_f32_32x32x8_bf16 v[72:87], v[156:157], v[128:129], v[72:87]
    v_cvt_pk_bf16_f32 v106, v92, v93
    v_cvt_pk_bf16_f32 v107, v94, v95
    v_exp_f32 v96, v96
    v_exp_f32 v97, v97
    v_exp_f32 v98, v98
    v_exp_f32 v99, v99
    v_mfma_f32_32x32x16_bf16 v[56:71], v[168:171], v[104:107], v[56:71]
    v_cvt_pk_bf16_f32 v108, v96, v97
    v_cvt_pk_bf16_f32 v109, v98, v99
    v_exp_f32 v100, v100
    v_exp_f32 v101, v101
    v_exp_f32 v102, v102
    v_exp_f32 v103, v103
    v_cvt_pk_bf16_f32 v110, v100, v101
    v_cvt_pk_bf16_f32 v111, v102, v103
    v_mfma_f32_32x32x16_bf16 v[88:103], v[144:147], v[116:119], 0
    v_exp_f32 v72, v72
    v_exp_f32 v73, v73
    v_exp_f32 v74, v74
    v_exp_f32 v75, v75
    v_mfma_f32_32x32x16_bf16 v[56:71], v[172:175], v[108:111], v[56:71]
    buffer_load_dwordx4 v[140:143], v192, s[8:11], s21 offen offset:512
    v_cvt_pk_bf16_f32 v104, v72, v73
    v_cvt_pk_bf16_f32 v105, v74, v75
    v_exp_f32 v76, v76
    v_exp_f32 v77, v77
    v_exp_f32 v78, v78
    v_exp_f32 v79, v79
    v_mfma_f32_32x32x8_bf16 v[88:103], v[156:157], v[130:131], v[88:103]
    v_cvt_pk_bf16_f32 v106, v76, v77
    v_cvt_pk_bf16_f32 v107, v78, v79
    v_exp_f32 v80, v80
    v_exp_f32 v81, v81
    v_exp_f32 v82, v82
    v_exp_f32 v83, v83
    v_mfma_f32_32x32x16_bf16 v[8:23], v[176:179], v[104:107], v[8:23]
    v_cvt_pk_bf16_f32 v108, v80, v81
    v_cvt_pk_bf16_f32 v109, v82, v83
    v_exp_f32 v84, v84
    v_exp_f32 v85, v85
    v_exp_f32 v86, v86
    v_exp_f32 v87, v87
    v_cvt_pk_bf16_f32 v110, v84, v85
    v_cvt_pk_bf16_f32 v111, v86, v87
    v_mfma_f32_32x32x16_bf16 v[72:87], v[144:147], v[120:123], 0
    v_exp_f32 v88, v88
    v_exp_f32 v89, v89
    v_exp_f32 v90, v90
    v_exp_f32 v91, v91
    v_mfma_f32_32x32x16_bf16 v[8:23], v[180:183], v[108:111], v[8:23]
    buffer_load_dwordx2 v[154:155], v193, s[8:11], s21 offen offset:512
    v_cvt_pk_bf16_f32 v104, v88, v89
    v_cvt_pk_bf16_f32 v105, v90, v91
    v_exp_f32 v92, v92
    v_exp_f32 v93, v93
    v_exp_f32 v94, v94
    v_exp_f32 v95, v95
    v_mfma_f32_32x32x8_bf16 v[72:87], v[156:157], v[132:133], v[72:87]
    v_cvt_pk_bf16_f32 v106, v92, v93
    v_cvt_pk_bf16_f32 v107, v94, v95
    v_exp_f32 v96, v96
    v_exp_f32 v97, v97
    v_exp_f32 v98, v98
    v_exp_f32 v99, v99
    v_mfma_f32_32x32x16_bf16 v[24:39], v[176:179], v[104:107], v[24:39]
    v_cvt_pk_bf16_f32 v108, v96, v97
    v_cvt_pk_bf16_f32 v109, v98, v99
    v_exp_f32 v100, v100
    v_exp_f32 v101, v101
    v_exp_f32 v102, v102
    v_exp_f32 v103, v103
    v_cvt_pk_bf16_f32 v110, v100, v101
    v_cvt_pk_bf16_f32 v111, v102, v103
    v_mfma_f32_32x32x16_bf16 v[88:103], v[144:147], v[124:127], 0
    v_exp_f32 v72, v72
    v_exp_f32 v73, v73
    v_exp_f32 v74, v74
    v_exp_f32 v75, v75
    v_mfma_f32_32x32x16_bf16 v[24:39], v[180:183], v[108:111], v[24:39]
    buffer_load_dwordx4 v[168:171], v200, s[8:11], s22 offen
    v_cvt_pk_bf16_f32 v104, v72, v73
    v_cvt_pk_bf16_f32 v105, v74, v75
    v_exp_f32 v76, v76
    v_exp_f32 v77, v77
    v_exp_f32 v78, v78
    v_exp_f32 v79, v79
    v_mfma_f32_32x32x8_bf16 v[88:103], v[156:157], v[134:135], v[88:103]
    v_cvt_pk_bf16_f32 v106, v76, v77
    v_cvt_pk_bf16_f32 v107, v78, v79
    v_exp_f32 v80, v80
    v_exp_f32 v81, v81
    v_exp_f32 v82, v82
    v_exp_f32 v83, v83
    v_mfma_f32_32x32x16_bf16 v[40:55], v[176:179], v[104:107], v[40:55]
    v_cvt_pk_bf16_f32 v108, v80, v81
    v_cvt_pk_bf16_f32 v109, v82, v83
    v_exp_f32 v84, v84
    v_exp_f32 v85, v85
    v_exp_f32 v86, v86
    v_exp_f32 v87, v87
    v_cvt_pk_bf16_f32 v110, v84, v85
    v_cvt_pk_bf16_f32 v111, v86, v87
    s_waitcnt vmcnt(8)
    v_mfma_f32_32x32x16_bf16 v[72:87], v[148:151], v[112:115], 0
    v_exp_f32 v88, v88
    v_exp_f32 v89, v89
    v_exp_f32 v90, v90
    v_exp_f32 v91, v91
    v_mfma_f32_32x32x16_bf16 v[40:55], v[180:183], v[108:111], v[40:55]
    buffer_load_dwordx4 v[172:175], v201, s[8:11], s22 offen
    v_cvt_pk_bf16_f32 v104, v88, v89
    v_cvt_pk_bf16_f32 v105, v90, v91
    v_exp_f32 v92, v92
    v_exp_f32 v93, v93
    v_exp_f32 v94, v94
    v_exp_f32 v95, v95
    v_mfma_f32_32x32x8_bf16 v[72:87], v[158:159], v[128:129], v[72:87]
    v_cvt_pk_bf16_f32 v106, v92, v93
    v_cvt_pk_bf16_f32 v107, v94, v95
    v_exp_f32 v96, v96
    v_exp_f32 v97, v97
    v_exp_f32 v98, v98
    v_exp_f32 v99, v99
    v_mfma_f32_32x32x16_bf16 v[56:71], v[176:179], v[104:107], v[56:71]
    v_cvt_pk_bf16_f32 v108, v96, v97
    v_cvt_pk_bf16_f32 v109, v98, v99
    v_exp_f32 v100, v100
    v_exp_f32 v101, v101
    v_exp_f32 v102, v102
    v_exp_f32 v103, v103
    v_cvt_pk_bf16_f32 v110, v100, v101
    v_cvt_pk_bf16_f32 v111, v102, v103
    v_mfma_f32_32x32x16_bf16 v[88:103], v[148:151], v[116:119], 0
    v_exp_f32 v72, v72
    v_exp_f32 v73, v73
    v_exp_f32 v74, v74
    v_exp_f32 v75, v75
    v_mfma_f32_32x32x16_bf16 v[56:71], v[180:183], v[108:111], v[56:71]
    buffer_load_dwordx4 v[144:147], v192, s[8:11], s21 offen offset:1024
    v_cvt_pk_bf16_f32 v104, v72, v73
    v_cvt_pk_bf16_f32 v105, v74, v75
    v_exp_f32 v76, v76
    v_exp_f32 v77, v77
    v_exp_f32 v78, v78
    v_exp_f32 v79, v79
    v_mfma_f32_32x32x8_bf16 v[88:103], v[158:159], v[130:131], v[88:103]
    v_cvt_pk_bf16_f32 v106, v76, v77
    v_cvt_pk_bf16_f32 v107, v78, v79
    v_exp_f32 v80, v80
    v_exp_f32 v81, v81
    v_exp_f32 v82, v82
    v_exp_f32 v83, v83
    v_mfma_f32_32x32x16_bf16 v[8:23], v[184:187], v[104:107], v[8:23]
    buffer_load_dwordx4 v197, s[8:11], m0 offen offset:1024 sc1 lds
    v_cvt_pk_bf16_f32 v108, v80, v81
    v_cvt_pk_bf16_f32 v109, v82, v83
    v_exp_f32 v84, v84
    v_exp_f32 v85, v85
    v_exp_f32 v86, v86
    v_exp_f32 v87, v87
    v_cvt_pk_bf16_f32 v110, v84, v85
    v_cvt_pk_bf16_f32 v111, v86, v87
    v_mfma_f32_32x32x16_bf16 v[72:87], v[148:151], v[120:123], 0
    v_exp_f32 v88, v88
    v_exp_f32 v89, v89
    v_exp_f32 v90, v90
    v_exp_f32 v91, v91
    v_mfma_f32_32x32x16_bf16 v[8:23], v[188:191], v[108:111], v[8:23]
    buffer_load_dwordx2 v[156:157], v193, s[8:11], s21 offen offset:1024
    v_cvt_pk_bf16_f32 v104, v88, v89
    v_cvt_pk_bf16_f32 v105, v90, v91
    v_exp_f32 v92, v92
    v_exp_f32 v93, v93
    v_exp_f32 v94, v94
    v_exp_f32 v95, v95
    v_mfma_f32_32x32x8_bf16 v[72:87], v[158:159], v[132:133], v[72:87]
    v_cvt_pk_bf16_f32 v106, v92, v93
    v_cvt_pk_bf16_f32 v107, v94, v95
    v_exp_f32 v96, v96
    v_exp_f32 v97, v97
    v_exp_f32 v98, v98
    v_exp_f32 v99, v99
    v_mfma_f32_32x32x16_bf16 v[24:39], v[184:187], v[104:107], v[24:39]
    buffer_load_dwordx4 v197, s[8:11], m0 offen offset:2048 sc1 lds
    v_cvt_pk_bf16_f32 v108, v96, v97
    v_cvt_pk_bf16_f32 v109, v98, v99
    v_exp_f32 v100, v100
    v_exp_f32 v101, v101
    v_exp_f32 v102, v102
    v_exp_f32 v103, v103
    v_cvt_pk_bf16_f32 v110, v100, v101
    v_cvt_pk_bf16_f32 v111, v102, v103
    v_mfma_f32_32x32x16_bf16 v[88:103], v[148:151], v[124:127], 0
    v_exp_f32 v72, v72
    v_exp_f32 v73, v73
    v_exp_f32 v74, v74
    v_exp_f32 v75, v75
    v_mfma_f32_32x32x16_bf16 v[24:39], v[188:191], v[108:111], v[24:39]
    buffer_load_dwordx4 v[176:179], v202, s[8:11], s22 offen
    v_cvt_pk_bf16_f32 v104, v72, v73
    v_cvt_pk_bf16_f32 v105, v74, v75
    v_exp_f32 v76, v76
    v_exp_f32 v77, v77
    v_exp_f32 v78, v78
    v_exp_f32 v79, v79
    v_mfma_f32_32x32x8_bf16 v[88:103], v[158:159], v[134:135], v[88:103]
    v_cvt_pk_bf16_f32 v106, v76, v77
    v_cvt_pk_bf16_f32 v107, v78, v79
    v_exp_f32 v80, v80
    v_exp_f32 v81, v81
    v_exp_f32 v82, v82
    v_exp_f32 v83, v83
    v_mfma_f32_32x32x16_bf16 v[40:55], v[184:187], v[104:107], v[40:55]
    buffer_load_dwordx4 v197, s[8:11], m0 offen offset:3072 sc1 lds
    v_cvt_pk_bf16_f32 v108, v80, v81
    v_cvt_pk_bf16_f32 v109, v82, v83
    v_exp_f32 v84, v84
    v_exp_f32 v85, v85
    v_exp_f32 v86, v86
    v_exp_f32 v87, v87
    v_cvt_pk_bf16_f32 v110, v84, v85
    v_cvt_pk_bf16_f32 v111, v86, v87
    s_waitcnt vmcnt(10)
    v_mfma_f32_32x32x16_bf16 v[72:87], v[136:139], v[112:115], 0
    v_exp_f32 v88, v88
    v_exp_f32 v89, v89
    v_exp_f32 v90, v90
    v_exp_f32 v91, v91
    v_mfma_f32_32x32x16_bf16 v[40:55], v[188:191], v[108:111], v[40:55]
    buffer_load_dwordx4 v[180:183], v203, s[8:11], s22 offen
    v_cvt_pk_bf16_f32 v104, v88, v89
    v_cvt_pk_bf16_f32 v105, v90, v91
    v_exp_f32 v92, v92
    v_exp_f32 v93, v93
    v_exp_f32 v94, v94
    v_exp_f32 v95, v95
    v_mfma_f32_32x32x8_bf16 v[72:87], v[152:153], v[128:129], v[72:87]
    v_cvt_pk_bf16_f32 v106, v92, v93
    v_cvt_pk_bf16_f32 v107, v94, v95
    v_exp_f32 v96, v96
    v_exp_f32 v97, v97
    v_exp_f32 v98, v98
    v_exp_f32 v99, v99
    v_mfma_f32_32x32x16_bf16 v[56:71], v[184:187], v[104:107], v[56:71]
    s_add_u32 m0, s67, 20480
    s_nop 0
    buffer_load_dwordx4 v197, s[8:11], m0 offen offset:0 sc1 lds
    v_cvt_pk_bf16_f32 v108, v96, v97
    v_cvt_pk_bf16_f32 v109, v98, v99
    v_exp_f32 v100, v100
    v_exp_f32 v101, v101
    v_exp_f32 v102, v102
    v_exp_f32 v103, v103
    v_cvt_pk_bf16_f32 v110, v100, v101
    v_cvt_pk_bf16_f32 v111, v102, v103
    v_mfma_f32_32x32x16_bf16 v[88:103], v[136:139], v[116:119], 0
    v_exp_f32 v72, v72
    v_exp_f32 v73, v73
    v_exp_f32 v74, v74
    v_exp_f32 v75, v75
    v_mfma_f32_32x32x16_bf16 v[56:71], v[188:191], v[108:111], v[56:71]
    buffer_load_dwordx4 v[148:151], v192, s[8:11], s21 offen offset:1536
    v_cvt_pk_bf16_f32 v104, v72, v73
    v_cvt_pk_bf16_f32 v105, v74, v75
    v_exp_f32 v76, v76
    v_exp_f32 v77, v77
    v_exp_f32 v78, v78
    v_exp_f32 v79, v79
    v_mfma_f32_32x32x8_bf16 v[88:103], v[152:153], v[130:131], v[88:103]
    v_cvt_pk_bf16_f32 v106, v76, v77
    v_cvt_pk_bf16_f32 v107, v78, v79
    v_exp_f32 v80, v80
    v_exp_f32 v81, v81
    v_exp_f32 v82, v82
    v_exp_f32 v83, v83
    v_mfma_f32_32x32x16_bf16 v[8:23], v[160:163], v[104:107], v[8:23]
    buffer_load_dwordx4 v197, s[8:11], m0 offen offset:1024 sc1 lds
    v_cvt_pk_bf16_f32 v108, v80, v81
    v_cvt_pk_bf16_f32 v109, v82, v83
    v_exp_f32 v84, v84
    v_exp_f32 v85, v85
    v_exp_f32 v86, v86
    v_exp_f32 v87, v87
    v_cvt_pk_bf16_f32 v110, v84, v85
    v_cvt_pk_bf16_f32 v111, v86, v87
    v_mfma_f32_32x32x16_bf16 v[72:87], v[136:139], v[120:123], 0
    v_exp_f32 v88, v88
    v_exp_f32 v89, v89
    v_exp_f32 v90, v90
    v_exp_f32 v91, v91
    v_mfma_f32_32x32x16_bf16 v[8:23], v[164:167], v[108:111], v[8:23]
    buffer_load_dwordx2 v[158:159], v193, s[8:11], s21 offen offset:1536
    v_cvt_pk_bf16_f32 v104, v88, v89
    v_cvt_pk_bf16_f32 v105, v90, v91
    v_exp_f32 v92, v92
    v_exp_f32 v93, v93
    v_exp_f32 v94, v94
    v_exp_f32 v95, v95
    v_mfma_f32_32x32x8_bf16 v[72:87], v[152:153], v[132:133], v[72:87]
    v_cvt_pk_bf16_f32 v106, v92, v93
    v_cvt_pk_bf16_f32 v107, v94, v95
    v_exp_f32 v96, v96
    v_exp_f32 v97, v97
    v_exp_f32 v98, v98
    v_exp_f32 v99, v99
    v_mfma_f32_32x32x16_bf16 v[24:39], v[160:163], v[104:107], v[24:39]
    buffer_load_dwordx4 v197, s[8:11], m0 offen offset:2048 sc1 lds
    v_cvt_pk_bf16_f32 v108, v96, v97
    v_cvt_pk_bf16_f32 v109, v98, v99
    v_exp_f32 v100, v100
    v_exp_f32 v101, v101
    v_exp_f32 v102, v102
    v_exp_f32 v103, v103
    v_cvt_pk_bf16_f32 v110, v100, v101
    v_cvt_pk_bf16_f32 v111, v102, v103
    v_mfma_f32_32x32x16_bf16 v[88:103], v[136:139], v[124:127], 0
    v_exp_f32 v72, v72
    v_exp_f32 v73, v73
    v_exp_f32 v74, v74
    v_exp_f32 v75, v75
    v_mfma_f32_32x32x16_bf16 v[24:39], v[164:167], v[108:111], v[24:39]
    buffer_load_dwordx4 v[184:187], v204, s[8:11], s22 offen
    v_cvt_pk_bf16_f32 v104, v72, v73
    v_cvt_pk_bf16_f32 v105, v74, v75
    v_exp_f32 v76, v76
    v_exp_f32 v77, v77
    v_exp_f32 v78, v78
    v_exp_f32 v79, v79
    v_mfma_f32_32x32x8_bf16 v[88:103], v[152:153], v[134:135], v[88:103]
    v_cvt_pk_bf16_f32 v106, v76, v77
    v_cvt_pk_bf16_f32 v107, v78, v79
    v_exp_f32 v80, v80
    v_exp_f32 v81, v81
    v_exp_f32 v82, v82
    v_exp_f32 v83, v83
    v_mfma_f32_32x32x16_bf16 v[40:55], v[160:163], v[104:107], v[40:55]
    buffer_load_dwordx4 v197, s[8:11], m0 offen offset:3072 sc1 lds
    v_cvt_pk_bf16_f32 v108, v80, v81
    v_cvt_pk_bf16_f32 v109, v82, v83
    v_exp_f32 v84, v84
    v_exp_f32 v85, v85
    v_exp_f32 v86, v86
    v_exp_f32 v87, v87
    v_cvt_pk_bf16_f32 v110, v84, v85
    v_cvt_pk_bf16_f32 v111, v86, v87
    s_waitcnt vmcnt(14)
    v_mfma_f32_32x32x16_bf16 v[72:87], v[140:143], v[112:115], 0
    v_exp_f32 v88, v88
    v_exp_f32 v89, v89
    v_exp_f32 v90, v90
    v_exp_f32 v91, v91
    v_mfma_f32_32x32x16_bf16 v[40:55], v[164:167], v[108:111], v[40:55]
    buffer_load_dwordx4 v[188:191], v205, s[8:11], s22 offen
    v_cvt_pk_bf16_f32 v104, v88, v89
    v_cvt_pk_bf16_f32 v105, v90, v91
    v_exp_f32 v92, v92
    v_exp_f32 v93, v93
    v_exp_f32 v94, v94
    v_exp_f32 v95, v95
    v_mfma_f32_32x32x8_bf16 v[72:87], v[154:155], v[128:129], v[72:87]
    v_cvt_pk_bf16_f32 v106, v92, v93
    v_cvt_pk_bf16_f32 v107, v94, v95
    v_exp_f32 v96, v96
    v_exp_f32 v97, v97
    v_exp_f32 v98, v98
    v_exp_f32 v99, v99
    v_mfma_f32_32x32x16_bf16 v[56:71], v[160:163], v[104:107], v[56:71]
    s_mov_b32 s23, 4718592
    buffer_load_dword v7, v196, s[52:55], s23 offen
    v_cvt_pk_bf16_f32 v108, v96, v97
    v_cvt_pk_bf16_f32 v109, v98, v99
    v_exp_f32 v100, v100
    v_exp_f32 v101, v101
    v_exp_f32 v102, v102
    v_exp_f32 v103, v103
    v_cvt_pk_bf16_f32 v110, v100, v101
    v_cvt_pk_bf16_f32 v111, v102, v103
    v_mfma_f32_32x32x16_bf16 v[88:103], v[140:143], v[116:119], 0
    v_exp_f32 v72, v72
    v_exp_f32 v73, v73
    v_exp_f32 v74, v74
    v_exp_f32 v75, v75
    v_mfma_f32_32x32x16_bf16 v[56:71], v[164:167], v[108:111], v[56:71]
    s_add_u32 s22, s22, 165888
    s_add_u32 s21, s21, 2048
    buffer_load_dwordx4 v[136:139], v192, s[8:11], s21 offen offset:0
    v_cvt_pk_bf16_f32 v104, v72, v73
    v_cvt_pk_bf16_f32 v105, v74, v75
    v_exp_f32 v76, v76
    v_exp_f32 v77, v77
    v_exp_f32 v78, v78
    v_exp_f32 v79, v79
    v_mfma_f32_32x32x8_bf16 v[88:103], v[154:155], v[130:131], v[88:103]
    v_cvt_pk_bf16_f32 v106, v76, v77
    v_cvt_pk_bf16_f32 v107, v78, v79
    v_exp_f32 v80, v80
    v_exp_f32 v81, v81
    v_exp_f32 v82, v82
    v_exp_f32 v83, v83
    v_mfma_f32_32x32x16_bf16 v[8:23], v[168:171], v[104:107], v[8:23]
    v_cvt_pk_bf16_f32 v108, v80, v81
    v_cvt_pk_bf16_f32 v109, v82, v83
    v_exp_f32 v84, v84
    v_exp_f32 v85, v85
    v_exp_f32 v86, v86
    v_exp_f32 v87, v87
    v_cvt_pk_bf16_f32 v110, v84, v85
    v_cvt_pk_bf16_f32 v111, v86, v87
    v_mfma_f32_32x32x16_bf16 v[72:87], v[140:143], v[120:123], 0
    v_exp_f32 v88, v88
    v_exp_f32 v89, v89
    v_exp_f32 v90, v90
    v_exp_f32 v91, v91
    v_mfma_f32_32x32x16_bf16 v[8:23], v[172:175], v[108:111], v[8:23]
    buffer_load_dwordx2 v[152:153], v193, s[8:11], s21 offen offset:0
    v_cvt_pk_bf16_f32 v104, v88, v89
    v_cvt_pk_bf16_f32 v105, v90, v91
    v_exp_f32 v92, v92
    v_exp_f32 v93, v93
    v_exp_f32 v94, v94
    v_exp_f32 v95, v95
    v_mfma_f32_32x32x8_bf16 v[72:87], v[154:155], v[132:133], v[72:87]
    v_cvt_pk_bf16_f32 v106, v92, v93
    v_cvt_pk_bf16_f32 v107, v94, v95
    v_exp_f32 v96, v96
    v_exp_f32 v97, v97
    v_exp_f32 v98, v98
    v_exp_f32 v99, v99
    v_mfma_f32_32x32x16_bf16 v[24:39], v[168:171], v[104:107], v[24:39]
    v_cvt_pk_bf16_f32 v108, v96, v97
    v_cvt_pk_bf16_f32 v109, v98, v99
    v_exp_f32 v100, v100
    v_exp_f32 v101, v101
    v_exp_f32 v102, v102
    v_exp_f32 v103, v103
    v_cvt_pk_bf16_f32 v110, v100, v101
    v_cvt_pk_bf16_f32 v111, v102, v103
    v_mfma_f32_32x32x16_bf16 v[88:103], v[140:143], v[124:127], 0
    v_exp_f32 v72, v72
    v_exp_f32 v73, v73
    v_exp_f32 v74, v74
    v_exp_f32 v75, v75
    v_mfma_f32_32x32x16_bf16 v[24:39], v[172:175], v[108:111], v[24:39]
    buffer_load_dwordx4 v[160:163], v198, s[8:11], s22 offen
    v_cvt_pk_bf16_f32 v104, v72, v73
    v_cvt_pk_bf16_f32 v105, v74, v75
    v_exp_f32 v76, v76
    v_exp_f32 v77, v77
    v_exp_f32 v78, v78
    v_exp_f32 v79, v79
    v_mfma_f32_32x32x8_bf16 v[88:103], v[154:155], v[134:135], v[88:103]
    v_cvt_pk_bf16_f32 v106, v76, v77
    v_cvt_pk_bf16_f32 v107, v78, v79
    v_exp_f32 v80, v80
    v_exp_f32 v81, v81
    v_exp_f32 v82, v82
    v_exp_f32 v83, v83
    v_mfma_f32_32x32x16_bf16 v[40:55], v[168:171], v[104:107], v[40:55]
    v_cvt_pk_bf16_f32 v108, v80, v81
    v_cvt_pk_bf16_f32 v109, v82, v83
    v_exp_f32 v84, v84
    v_exp_f32 v85, v85
    v_exp_f32 v86, v86
    v_exp_f32 v87, v87
    v_cvt_pk_bf16_f32 v110, v84, v85
    v_cvt_pk_bf16_f32 v111, v86, v87
    s_waitcnt vmcnt(12)
    v_mfma_f32_32x32x16_bf16 v[72:87], v[144:147], v[112:115], 0
    v_exp_f32 v88, v88
    v_exp_f32 v89, v89
    v_exp_f32 v90, v90
    v_exp_f32 v91, v91
    v_mfma_f32_32x32x16_bf16 v[40:55], v[172:175], v[108:111], v[40:55]
    buffer_load_dwordx4 v[164:167], v199, s[8:11], s22 offen
    v_cvt_pk_bf16_f32 v104, v88, v89
    v_cvt_pk_bf16_f32 v105, v90, v91
    v_exp_f32 v92, v92
    v_exp_f32 v93, v93
    v_exp_f32 v94, v94
    v_exp_f32 v95, v95
    v_mfma_f32_32x32x8_bf16 v[72:87], v[156:157], v[128:129], v[72:87]
    v_cvt_pk_bf16_f32 v106, v92, v93
    v_cvt_pk_bf16_f32 v107, v94, v95
    v_exp_f32 v96, v96
    v_exp_f32 v97, v97
    v_exp_f32 v98, v98
    v_exp_f32 v99, v99
    v_mfma_f32_32x32x16_bf16 v[56:71], v[168:171], v[104:107], v[56:71]
    v_cvt_pk_bf16_f32 v108, v96, v97
    v_cvt_pk_bf16_f32 v109, v98, v99
    v_exp_f32 v100, v100
    v_exp_f32 v101, v101
    v_exp_f32 v102, v102
    v_exp_f32 v103, v103
    v_cvt_pk_bf16_f32 v110, v100, v101
    v_cvt_pk_bf16_f32 v111, v102, v103
    v_mfma_f32_32x32x16_bf16 v[88:103], v[144:147], v[116:119], 0
    v_exp_f32 v72, v72
    v_exp_f32 v73, v73
    v_exp_f32 v74, v74
    v_exp_f32 v75, v75
    v_mfma_f32_32x32x16_bf16 v[56:71], v[172:175], v[108:111], v[56:71]
    buffer_load_dwordx4 v[140:143], v192, s[8:11], s21 offen offset:512
    v_cvt_pk_bf16_f32 v104, v72, v73
    v_cvt_pk_bf16_f32 v105, v74, v75
    v_exp_f32 v76, v76
    v_exp_f32 v77, v77
    v_exp_f32 v78, v78
    v_exp_f32 v79, v79
    v_mfma_f32_32x32x8_bf16 v[88:103], v[156:157], v[130:131], v[88:103]
    v_cvt_pk_bf16_f32 v106, v76, v77
    v_cvt_pk_bf16_f32 v107, v78, v79
    v_exp_f32 v80, v80
    v_exp_f32 v81, v81
    v_exp_f32 v82, v82
    v_exp_f32 v83, v83
    v_mfma_f32_32x32x16_bf16 v[8:23], v[176:179], v[104:107], v[8:23]
    v_cvt_pk_bf16_f32 v108, v80, v81
    v_cvt_pk_bf16_f32 v109, v82, v83
    v_exp_f32 v84, v84
    v_exp_f32 v85, v85
    v_exp_f32 v86, v86
    v_exp_f32 v87, v87
    v_cvt_pk_bf16_f32 v110, v84, v85
    v_cvt_pk_bf16_f32 v111, v86, v87
    v_mfma_f32_32x32x16_bf16 v[72:87], v[144:147], v[120:123], 0
    v_exp_f32 v88, v88
    v_exp_f32 v89, v89
    v_exp_f32 v90, v90
    v_exp_f32 v91, v91
    v_mfma_f32_32x32x16_bf16 v[8:23], v[180:183], v[108:111], v[8:23]
    buffer_load_dwordx2 v[154:155], v193, s[8:11], s21 offen offset:512
    v_cvt_pk_bf16_f32 v104, v88, v89
    v_cvt_pk_bf16_f32 v105, v90, v91
    v_exp_f32 v92, v92
    v_exp_f32 v93, v93
    v_exp_f32 v94, v94
    v_exp_f32 v95, v95
    v_mfma_f32_32x32x8_bf16 v[72:87], v[156:157], v[132:133], v[72:87]
    v_cvt_pk_bf16_f32 v106, v92, v93
    v_cvt_pk_bf16_f32 v107, v94, v95
    v_exp_f32 v96, v96
    v_exp_f32 v97, v97
    v_exp_f32 v98, v98
    v_exp_f32 v99, v99
    v_mfma_f32_32x32x16_bf16 v[24:39], v[176:179], v[104:107], v[24:39]
    v_cvt_pk_bf16_f32 v108, v96, v97
    v_cvt_pk_bf16_f32 v109, v98, v99
    v_exp_f32 v100, v100
    v_exp_f32 v101, v101
    v_exp_f32 v102, v102
    v_exp_f32 v103, v103
    v_cvt_pk_bf16_f32 v110, v100, v101
    v_cvt_pk_bf16_f32 v111, v102, v103
    v_mfma_f32_32x32x16_bf16 v[88:103], v[144:147], v[124:127], 0
    v_exp_f32 v72, v72
    v_exp_f32 v73, v73
    v_exp_f32 v74, v74
    v_exp_f32 v75, v75
    v_mfma_f32_32x32x16_bf16 v[24:39], v[180:183], v[108:111], v[24:39]
    buffer_load_dwordx4 v[168:171], v200, s[8:11], s22 offen
    v_cvt_pk_bf16_f32 v104, v72, v73
    v_cvt_pk_bf16_f32 v105, v74, v75
    v_exp_f32 v76, v76
    v_exp_f32 v77, v77
    v_exp_f32 v78, v78
    v_exp_f32 v79, v79
    v_mfma_f32_32x32x8_bf16 v[88:103], v[156:157], v[134:135], v[88:103]
    v_cvt_pk_bf16_f32 v106, v76, v77
    v_cvt_pk_bf16_f32 v107, v78, v79
    v_exp_f32 v80, v80
    v_exp_f32 v81, v81
    v_exp_f32 v82, v82
    v_exp_f32 v83, v83
    v_mfma_f32_32x32x16_bf16 v[40:55], v[176:179], v[104:107], v[40:55]
    v_cvt_pk_bf16_f32 v108, v80, v81
    v_cvt_pk_bf16_f32 v109, v82, v83
    v_exp_f32 v84, v84
    v_exp_f32 v85, v85
    v_exp_f32 v86, v86
    v_exp_f32 v87, v87
    v_cvt_pk_bf16_f32 v110, v84, v85
    v_cvt_pk_bf16_f32 v111, v86, v87
    s_waitcnt vmcnt(8)
    v_mfma_f32_32x32x16_bf16 v[72:87], v[148:151], v[112:115], 0
    v_exp_f32 v88, v88
    v_exp_f32 v89, v89
    v_exp_f32 v90, v90
    v_exp_f32 v91, v91
    v_mfma_f32_32x32x16_bf16 v[40:55], v[180:183], v[108:111], v[40:55]
    buffer_load_dwordx4 v[172:175], v201, s[8:11], s22 offen
    v_cvt_pk_bf16_f32 v104, v88, v89
    v_cvt_pk_bf16_f32 v105, v90, v91
    v_exp_f32 v92, v92
    v_exp_f32 v93, v93
    v_exp_f32 v94, v94
    v_exp_f32 v95, v95
    v_mfma_f32_32x32x8_bf16 v[72:87], v[158:159], v[128:129], v[72:87]
    v_cvt_pk_bf16_f32 v106, v92, v93
    v_cvt_pk_bf16_f32 v107, v94, v95
    v_exp_f32 v96, v96
    v_exp_f32 v97, v97
    v_exp_f32 v98, v98
    v_exp_f32 v99, v99
    v_mfma_f32_32x32x16_bf16 v[56:71], v[176:179], v[104:107], v[56:71]
    v_cvt_pk_bf16_f32 v108, v96, v97
    v_cvt_pk_bf16_f32 v109, v98, v99
    v_exp_f32 v100, v100
    v_exp_f32 v101, v101
    v_exp_f32 v102, v102
    v_exp_f32 v103, v103
    v_cvt_pk_bf16_f32 v110, v100, v101
    v_cvt_pk_bf16_f32 v111, v102, v103
    v_mfma_f32_32x32x16_bf16 v[88:103], v[148:151], v[116:119], 0
    v_exp_f32 v72, v72
    v_exp_f32 v73, v73
    v_exp_f32 v74, v74
    v_exp_f32 v75, v75
    v_mfma_f32_32x32x16_bf16 v[56:71], v[180:183], v[108:111], v[56:71]
    buffer_load_dwordx4 v[144:147], v192, s[8:11], s21 offen offset:1024
    v_cvt_pk_bf16_f32 v104, v72, v73
    v_cvt_pk_bf16_f32 v105, v74, v75
    v_exp_f32 v76, v76
    v_exp_f32 v77, v77
    v_exp_f32 v78, v78
    v_exp_f32 v79, v79
    v_mfma_f32_32x32x8_bf16 v[88:103], v[158:159], v[130:131], v[88:103]
    v_cvt_pk_bf16_f32 v106, v76, v77
    v_cvt_pk_bf16_f32 v107, v78, v79
    v_exp_f32 v80, v80
    v_exp_f32 v81, v81
    v_exp_f32 v82, v82
    v_exp_f32 v83, v83
    v_mfma_f32_32x32x16_bf16 v[8:23], v[184:187], v[104:107], v[8:23]
    s_add_u32 m0, s67, 24576
    s_nop 0
    buffer_load_dwordx4 v197, s[8:11], m0 offen offset:0 sc1 lds
    v_cvt_pk_bf16_f32 v108, v80, v81
    v_cvt_pk_bf16_f32 v109, v82, v83
    v_exp_f32 v84, v84
    v_exp_f32 v85, v85
    v_exp_f32 v86, v86
    v_exp_f32 v87, v87
    v_cvt_pk_bf16_f32 v110, v84, v85
    v_cvt_pk_bf16_f32 v111, v86, v87
    v_mfma_f32_32x32x16_bf16 v[72:87], v[148:151], v[120:123], 0
    v_exp_f32 v88, v88
    v_exp_f32 v89, v89
    v_exp_f32 v90, v90
    v_exp_f32 v91, v91
    v_mfma_f32_32x32x16_bf16 v[8:23], v[188:191], v[108:111], v[8:23]
    buffer_load_dwordx2 v[156:157], v193, s[8:11], s21 offen offset:1024
    v_cvt_pk_bf16_f32 v104, v88, v89
    v_cvt_pk_bf16_f32 v105, v90, v91
    v_exp_f32 v92, v92
    v_exp_f32 v93, v93
    v_exp_f32 v94, v94
    v_exp_f32 v95, v95
    v_mfma_f32_32x32x8_bf16 v[72:87], v[158:159], v[132:133], v[72:87]
    v_cvt_pk_bf16_f32 v106, v92, v93
    v_cvt_pk_bf16_f32 v107, v94, v95
    v_exp_f32 v96, v96
    v_exp_f32 v97, v97
    v_exp_f32 v98, v98
    v_exp_f32 v99, v99
    v_mfma_f32_32x32x16_bf16 v[24:39], v[184:187], v[104:107], v[24:39]
    v_accvgpr_write_b32 a252, -1
    v_accvgpr_write_b32 a253, -1
    v_accvgpr_write_b32 a254, -1
    v_accvgpr_write_b32 a255, -1
    buffer_store_dwordx4 a[252:255], v252, s[8:11], s59 offen sc1
    v_cvt_pk_bf16_f32 v108, v96, v97
    v_cvt_pk_bf16_f32 v109, v98, v99
    v_exp_f32 v100, v100
    v_exp_f32 v101, v101
    v_exp_f32 v102, v102
    v_exp_f32 v103, v103
    v_cvt_pk_bf16_f32 v110, v100, v101
    v_cvt_pk_bf16_f32 v111, v102, v103
    v_mfma_f32_32x32x16_bf16 v[88:103], v[148:151], v[124:127], 0
    v_exp_f32 v72, v72
    v_exp_f32 v73, v73
    v_exp_f32 v74, v74
    v_exp_f32 v75, v75
    v_mfma_f32_32x32x16_bf16 v[24:39], v[188:191], v[108:111], v[24:39]
    buffer_load_dwordx4 v[176:179], v202, s[8:11], s22 offen
    v_cvt_pk_bf16_f32 v104, v72, v73
    v_cvt_pk_bf16_f32 v105, v74, v75
    v_exp_f32 v76, v76
    v_exp_f32 v77, v77
    v_exp_f32 v78, v78
    v_exp_f32 v79, v79
    v_mfma_f32_32x32x8_bf16 v[88:103], v[158:159], v[134:135], v[88:103]
    v_cvt_pk_bf16_f32 v106, v76, v77
    v_cvt_pk_bf16_f32 v107, v78, v79
    v_exp_f32 v80, v80
    v_exp_f32 v81, v81
    v_exp_f32 v82, v82
    v_exp_f32 v83, v83
    v_mfma_f32_32x32x16_bf16 v[40:55], v[184:187], v[104:107], v[40:55]
    buffer_store_dwordx4 a[252:255], v252, s[8:11], s59 offen offset:512 sc1
    v_cvt_pk_bf16_f32 v108, v80, v81
    v_cvt_pk_bf16_f32 v109, v82, v83
    v_exp_f32 v84, v84
    v_exp_f32 v85, v85
    v_exp_f32 v86, v86
    v_exp_f32 v87, v87
    v_cvt_pk_bf16_f32 v110, v84, v85
    v_cvt_pk_bf16_f32 v111, v86, v87
    s_waitcnt vmcnt(10)
    v_mfma_f32_32x32x16_bf16 v[72:87], v[136:139], v[112:115], 0
    v_exp_f32 v88, v88
    v_exp_f32 v89, v89
    v_exp_f32 v90, v90
    v_exp_f32 v91, v91
    v_mfma_f32_32x32x16_bf16 v[40:55], v[188:191], v[108:111], v[40:55]
    buffer_load_dwordx4 v[180:183], v203, s[8:11], s22 offen
    v_cvt_pk_bf16_f32 v104, v88, v89
    v_cvt_pk_bf16_f32 v105, v90, v91
    v_exp_f32 v92, v92
    v_exp_f32 v93, v93
    v_exp_f32 v94, v94
    v_exp_f32 v95, v95
    v_mfma_f32_32x32x8_bf16 v[72:87], v[152:153], v[128:129], v[72:87]
    v_cvt_pk_bf16_f32 v106, v92, v93
    v_cvt_pk_bf16_f32 v107, v94, v95
    v_exp_f32 v96, v96
    v_exp_f32 v97, v97
    v_exp_f32 v98, v98
    v_exp_f32 v99, v99
    v_mfma_f32_32x32x16_bf16 v[56:71], v[184:187], v[104:107], v[56:71]
    s_waitcnt lgkmcnt(0)
    s_add_u32 m0, s15, 16384
    s_nop 0
    buffer_load_dwordx4 v220, s[44:47], s84 offen offset:0 lds
    v_cvt_pk_bf16_f32 v108, v96, v97
    v_cvt_pk_bf16_f32 v109, v98, v99
    v_exp_f32 v100, v100
    v_exp_f32 v101, v101
    v_exp_f32 v102, v102
    v_exp_f32 v103, v103
    v_cvt_pk_bf16_f32 v110, v100, v101
    v_cvt_pk_bf16_f32 v111, v102, v103
    v_mfma_f32_32x32x16_bf16 v[88:103], v[136:139], v[116:119], 0
    v_exp_f32 v72, v72
    v_exp_f32 v73, v73
    v_exp_f32 v74, v74
    v_exp_f32 v75, v75
    v_mfma_f32_32x32x16_bf16 v[56:71], v[188:191], v[108:111], v[56:71]
    buffer_load_dwordx4 v[148:151], v192, s[8:11], s21 offen offset:1536
    v_cvt_pk_bf16_f32 v104, v72, v73
    v_cvt_pk_bf16_f32 v105, v74, v75
    v_exp_f32 v76, v76
    v_exp_f32 v77, v77
    v_exp_f32 v78, v78
    v_exp_f32 v79, v79
    v_mfma_f32_32x32x8_bf16 v[88:103], v[152:153], v[130:131], v[88:103]
    v_cvt_pk_bf16_f32 v106, v76, v77
    v_cvt_pk_bf16_f32 v107, v78, v79
    v_exp_f32 v80, v80
    v_exp_f32 v81, v81
    v_exp_f32 v82, v82
    v_exp_f32 v83, v83
    v_mfma_f32_32x32x16_bf16 v[8:23], v[160:163], v[104:107], v[8:23]
    buffer_load_dwordx4 v221, s[44:47], s84 offen offset:1024 lds
    v_cvt_pk_bf16_f32 v108, v80, v81
    v_cvt_pk_bf16_f32 v109, v82, v83
    v_exp_f32 v84, v84
    v_exp_f32 v85, v85
    v_exp_f32 v86, v86
    v_exp_f32 v87, v87
    v_cvt_pk_bf16_f32 v110, v84, v85
    v_cvt_pk_bf16_f32 v111, v86, v87
    v_mfma_f32_32x32x16_bf16 v[72:87], v[136:139], v[120:123], 0
    v_exp_f32 v88, v88
    v_exp_f32 v89, v89
    v_exp_f32 v90, v90
    v_exp_f32 v91, v91
    v_mfma_f32_32x32x16_bf16 v[8:23], v[164:167], v[108:111], v[8:23]
    buffer_load_dwordx2 v[158:159], v193, s[8:11], s21 offen offset:1536
    v_cvt_pk_bf16_f32 v104, v88, v89
    v_cvt_pk_bf16_f32 v105, v90, v91
    v_exp_f32 v92, v92
    v_exp_f32 v93, v93
    v_exp_f32 v94, v94
    v_exp_f32 v95, v95
    v_mfma_f32_32x32x8_bf16 v[72:87], v[152:153], v[132:133], v[72:87]
    v_cvt_pk_bf16_f32 v106, v92, v93
    v_cvt_pk_bf16_f32 v107, v94, v95
    v_exp_f32 v96, v96
    v_exp_f32 v97, v97
    v_exp_f32 v98, v98
    v_exp_f32 v99, v99
    v_mfma_f32_32x32x16_bf16 v[24:39], v[160:163], v[104:107], v[24:39]
    buffer_load_dwordx4 v222, s[44:47], s84 offen offset:2048 lds
    v_cvt_pk_bf16_f32 v108, v96, v97
    v_cvt_pk_bf16_f32 v109, v98, v99
    v_exp_f32 v100, v100
    v_exp_f32 v101, v101
    v_exp_f32 v102, v102
    v_exp_f32 v103, v103
    v_cvt_pk_bf16_f32 v110, v100, v101
    v_cvt_pk_bf16_f32 v111, v102, v103
    v_mfma_f32_32x32x16_bf16 v[88:103], v[136:139], v[124:127], 0
    v_exp_f32 v72, v72
    v_exp_f32 v73, v73
    v_exp_f32 v74, v74
    v_exp_f32 v75, v75
    v_mfma_f32_32x32x16_bf16 v[24:39], v[164:167], v[108:111], v[24:39]
    buffer_load_dwordx4 v[184:187], v204, s[8:11], s22 offen
    v_cvt_pk_bf16_f32 v104, v72, v73
    v_cvt_pk_bf16_f32 v105, v74, v75
    v_exp_f32 v76, v76
    v_exp_f32 v77, v77
    v_exp_f32 v78, v78
    v_exp_f32 v79, v79
    v_mfma_f32_32x32x8_bf16 v[88:103], v[152:153], v[134:135], v[88:103]
    v_cvt_pk_bf16_f32 v106, v76, v77
    v_cvt_pk_bf16_f32 v107, v78, v79
    v_exp_f32 v80, v80
    v_exp_f32 v81, v81
    v_exp_f32 v82, v82
    v_exp_f32 v83, v83
    v_mfma_f32_32x32x16_bf16 v[40:55], v[160:163], v[104:107], v[40:55]
    buffer_load_dwordx4 v223, s[44:47], s84 offen offset:3072 lds
    v_cvt_pk_bf16_f32 v108, v80, v81
    v_cvt_pk_bf16_f32 v109, v82, v83
    v_exp_f32 v84, v84
    v_exp_f32 v85, v85
    v_exp_f32 v86, v86
    v_exp_f32 v87, v87
    v_cvt_pk_bf16_f32 v110, v84, v85
    v_cvt_pk_bf16_f32 v111, v86, v87
    s_waitcnt vmcnt(14)
    v_mfma_f32_32x32x16_bf16 v[72:87], v[140:143], v[112:115], 0
    v_exp_f32 v88, v88
    v_exp_f32 v89, v89
    v_exp_f32 v90, v90
    v_exp_f32 v91, v91
    v_mfma_f32_32x32x16_bf16 v[40:55], v[164:167], v[108:111], v[40:55]
    buffer_load_dwordx4 v[188:191], v205, s[8:11], s22 offen
    v_cvt_pk_bf16_f32 v104, v88, v89
    v_cvt_pk_bf16_f32 v105, v90, v91
    v_exp_f32 v92, v92
    v_exp_f32 v93, v93
    v_exp_f32 v94, v94
    v_exp_f32 v95, v95
    v_mfma_f32_32x32x8_bf16 v[72:87], v[154:155], v[128:129], v[72:87]
    v_cvt_pk_bf16_f32 v106, v92, v93
    v_cvt_pk_bf16_f32 v107, v94, v95
    v_exp_f32 v96, v96
    v_exp_f32 v97, v97
    v_exp_f32 v98, v98
    v_exp_f32 v99, v99
    v_mfma_f32_32x32x16_bf16 v[56:71], v[160:163], v[104:107], v[56:71]
    buffer_load_dword v7, v196, s[80:83], 0 offen
    v_cvt_pk_bf16_f32 v108, v96, v97
    v_cvt_pk_bf16_f32 v109, v98, v99
    v_exp_f32 v100, v100
    v_exp_f32 v101, v101
    v_exp_f32 v102, v102
    v_exp_f32 v103, v103
    v_cvt_pk_bf16_f32 v110, v100, v101
    v_cvt_pk_bf16_f32 v111, v102, v103
    v_mfma_f32_32x32x16_bf16 v[88:103], v[140:143], v[116:119], 0
    v_exp_f32 v72, v72
    v_exp_f32 v73, v73
    v_exp_f32 v74, v74
    v_exp_f32 v75, v75
    v_mfma_f32_32x32x16_bf16 v[56:71], v[164:167], v[108:111], v[56:71]
    s_add_u32 s22, s22, 165888
    s_add_u32 s21, s21, 2048
    buffer_load_dwordx4 v[136:139], v192, s[8:11], s21 offen offset:0
    v_cvt_pk_bf16_f32 v104, v72, v73
    v_cvt_pk_bf16_f32 v105, v74, v75
    v_exp_f32 v76, v76
    v_exp_f32 v77, v77
    v_exp_f32 v78, v78
    v_exp_f32 v79, v79
    v_mfma_f32_32x32x8_bf16 v[88:103], v[154:155], v[130:131], v[88:103]
    v_cvt_pk_bf16_f32 v106, v76, v77
    v_cvt_pk_bf16_f32 v107, v78, v79
    v_exp_f32 v80, v80
    v_exp_f32 v81, v81
    v_exp_f32 v82, v82
    v_exp_f32 v83, v83
    v_mfma_f32_32x32x16_bf16 v[8:23], v[168:171], v[104:107], v[8:23]
    v_cvt_pk_bf16_f32 v108, v80, v81
    v_cvt_pk_bf16_f32 v109, v82, v83
    v_exp_f32 v84, v84
    v_exp_f32 v85, v85
    v_exp_f32 v86, v86
    v_exp_f32 v87, v87
    v_cvt_pk_bf16_f32 v110, v84, v85
    v_cvt_pk_bf16_f32 v111, v86, v87
    v_mfma_f32_32x32x16_bf16 v[72:87], v[140:143], v[120:123], 0
    v_exp_f32 v88, v88
    v_exp_f32 v89, v89
    v_exp_f32 v90, v90
    v_exp_f32 v91, v91
    v_mfma_f32_32x32x16_bf16 v[8:23], v[172:175], v[108:111], v[8:23]
    buffer_load_dwordx2 v[152:153], v193, s[8:11], s21 offen offset:0
    v_cvt_pk_bf16_f32 v104, v88, v89
    v_cvt_pk_bf16_f32 v105, v90, v91
    v_exp_f32 v92, v92
    v_exp_f32 v93, v93
    v_exp_f32 v94, v94
    v_exp_f32 v95, v95
    v_mfma_f32_32x32x8_bf16 v[72:87], v[154:155], v[132:133], v[72:87]
    v_cvt_pk_bf16_f32 v106, v92, v93
    v_cvt_pk_bf16_f32 v107, v94, v95
    v_exp_f32 v96, v96
    v_exp_f32 v97, v97
    v_exp_f32 v98, v98
    v_exp_f32 v99, v99
    v_mfma_f32_32x32x16_bf16 v[24:39], v[168:171], v[104:107], v[24:39]
    v_cvt_pk_bf16_f32 v108, v96, v97
    v_cvt_pk_bf16_f32 v109, v98, v99
    v_exp_f32 v100, v100
    v_exp_f32 v101, v101
    v_exp_f32 v102, v102
    v_exp_f32 v103, v103
    v_cvt_pk_bf16_f32 v110, v100, v101
    v_cvt_pk_bf16_f32 v111, v102, v103
    v_mfma_f32_32x32x16_bf16 v[88:103], v[140:143], v[124:127], 0
    v_exp_f32 v72, v72
    v_exp_f32 v73, v73
    v_exp_f32 v74, v74
    v_exp_f32 v75, v75
    v_mfma_f32_32x32x16_bf16 v[24:39], v[172:175], v[108:111], v[24:39]
    buffer_load_dwordx4 v[160:163], v198, s[8:11], s22 offen
    v_cvt_pk_bf16_f32 v104, v72, v73
    v_cvt_pk_bf16_f32 v105, v74, v75
    v_exp_f32 v76, v76
    v_exp_f32 v77, v77
    v_exp_f32 v78, v78
    v_exp_f32 v79, v79
    v_mfma_f32_32x32x8_bf16 v[88:103], v[154:155], v[134:135], v[88:103]
    v_cvt_pk_bf16_f32 v106, v76, v77
    v_cvt_pk_bf16_f32 v107, v78, v79
    v_exp_f32 v80, v80
    v_exp_f32 v81, v81
    v_exp_f32 v82, v82
    v_exp_f32 v83, v83
    v_mfma_f32_32x32x16_bf16 v[40:55], v[168:171], v[104:107], v[40:55]
    v_cvt_pk_bf16_f32 v108, v80, v81
    v_cvt_pk_bf16_f32 v109, v82, v83
    v_exp_f32 v84, v84
    v_exp_f32 v85, v85
    v_exp_f32 v86, v86
    v_exp_f32 v87, v87
    v_cvt_pk_bf16_f32 v110, v84, v85
    v_cvt_pk_bf16_f32 v111, v86, v87
    s_waitcnt vmcnt(12)
    v_mfma_f32_32x32x16_bf16 v[72:87], v[144:147], v[112:115], 0
    v_exp_f32 v88, v88
    v_exp_f32 v89, v89
    v_exp_f32 v90, v90
    v_exp_f32 v91, v91
    v_mfma_f32_32x32x16_bf16 v[40:55], v[172:175], v[108:111], v[40:55]
    buffer_load_dwordx4 v[164:167], v199, s[8:11], s22 offen
    v_cvt_pk_bf16_f32 v104, v88, v89
    v_cvt_pk_bf16_f32 v105, v90, v91
    v_exp_f32 v92, v92
    v_exp_f32 v93, v93
    v_exp_f32 v94, v94
    v_exp_f32 v95, v95
    v_mfma_f32_32x32x8_bf16 v[72:87], v[156:157], v[128:129], v[72:87]
    v_cvt_pk_bf16_f32 v106, v92, v93
    v_cvt_pk_bf16_f32 v107, v94, v95
    v_exp_f32 v96, v96
    v_exp_f32 v97, v97
    v_exp_f32 v98, v98
    v_exp_f32 v99, v99
    v_mfma_f32_32x32x16_bf16 v[56:71], v[168:171], v[104:107], v[56:71]
    v_cvt_pk_bf16_f32 v108, v96, v97
    v_cvt_pk_bf16_f32 v109, v98, v99
    v_exp_f32 v100, v100
    v_exp_f32 v101, v101
    v_exp_f32 v102, v102
    v_exp_f32 v103, v103
    v_cvt_pk_bf16_f32 v110, v100, v101
    v_cvt_pk_bf16_f32 v111, v102, v103
    v_mfma_f32_32x32x16_bf16 v[88:103], v[144:147], v[116:119], 0
    v_exp_f32 v72, v72
    v_exp_f32 v73, v73
    v_exp_f32 v74, v74
    v_exp_f32 v75, v75
    v_mfma_f32_32x32x16_bf16 v[56:71], v[172:175], v[108:111], v[56:71]
    buffer_load_dwordx4 v[140:143], v192, s[8:11], s21 offen offset:512
    v_cvt_pk_bf16_f32 v104, v72, v73
    v_cvt_pk_bf16_f32 v105, v74, v75
    v_exp_f32 v76, v76
    v_exp_f32 v77, v77
    v_exp_f32 v78, v78
    v_exp_f32 v79, v79
    v_mfma_f32_32x32x8_bf16 v[88:103], v[156:157], v[130:131], v[88:103]
    v_cvt_pk_bf16_f32 v106, v76, v77
    v_cvt_pk_bf16_f32 v107, v78, v79
    v_exp_f32 v80, v80
    v_exp_f32 v81, v81
    v_exp_f32 v82, v82
    v_exp_f32 v83, v83
    v_mfma_f32_32x32x16_bf16 v[8:23], v[176:179], v[104:107], v[8:23]
    v_cvt_pk_bf16_f32 v108, v80, v81
    v_cvt_pk_bf16_f32 v109, v82, v83
    v_exp_f32 v84, v84
    v_exp_f32 v85, v85
    v_exp_f32 v86, v86
    v_exp_f32 v87, v87
    v_cvt_pk_bf16_f32 v110, v84, v85
    v_cvt_pk_bf16_f32 v111, v86, v87
    v_mfma_f32_32x32x16_bf16 v[72:87], v[144:147], v[120:123], 0
    v_exp_f32 v88, v88
    v_exp_f32 v89, v89
    v_exp_f32 v90, v90
    v_exp_f32 v91, v91
    v_mfma_f32_32x32x16_bf16 v[8:23], v[180:183], v[108:111], v[8:23]
    buffer_load_dwordx2 v[154:155], v193, s[8:11], s21 offen offset:512
    v_cvt_pk_bf16_f32 v104, v88, v89
    v_cvt_pk_bf16_f32 v105, v90, v91
    v_exp_f32 v92, v92
    v_exp_f32 v93, v93
    v_exp_f32 v94, v94
    v_exp_f32 v95, v95
    v_mfma_f32_32x32x8_bf16 v[72:87], v[156:157], v[132:133], v[72:87]
    v_cvt_pk_bf16_f32 v106, v92, v93
    v_cvt_pk_bf16_f32 v107, v94, v95
    v_exp_f32 v96, v96
    v_exp_f32 v97, v97
    v_exp_f32 v98, v98
    v_exp_f32 v99, v99
    v_mfma_f32_32x32x16_bf16 v[24:39], v[176:179], v[104:107], v[24:39]
    v_cvt_pk_bf16_f32 v108, v96, v97
    v_cvt_pk_bf16_f32 v109, v98, v99
    v_exp_f32 v100, v100
    v_exp_f32 v101, v101
    v_exp_f32 v102, v102
    v_exp_f32 v103, v103
    v_cvt_pk_bf16_f32 v110, v100, v101
    v_cvt_pk_bf16_f32 v111, v102, v103
    v_mfma_f32_32x32x16_bf16 v[88:103], v[144:147], v[124:127], 0
    v_exp_f32 v72, v72
    v_exp_f32 v73, v73
    v_exp_f32 v74, v74
    v_exp_f32 v75, v75
    v_mfma_f32_32x32x16_bf16 v[24:39], v[180:183], v[108:111], v[24:39]
    buffer_load_dwordx4 v[168:171], v200, s[8:11], s22 offen
    v_cvt_pk_bf16_f32 v104, v72, v73
    v_cvt_pk_bf16_f32 v105, v74, v75
    v_exp_f32 v76, v76
    v_exp_f32 v77, v77
    v_exp_f32 v78, v78
    v_exp_f32 v79, v79
    v_mfma_f32_32x32x8_bf16 v[88:103], v[156:157], v[134:135], v[88:103]
    v_cvt_pk_bf16_f32 v106, v76, v77
    v_cvt_pk_bf16_f32 v107, v78, v79
    v_exp_f32 v80, v80
    v_exp_f32 v81, v81
    v_exp_f32 v82, v82
    v_exp_f32 v83, v83
    v_mfma_f32_32x32x16_bf16 v[40:55], v[176:179], v[104:107], v[40:55]
    v_cvt_pk_bf16_f32 v108, v80, v81
    v_cvt_pk_bf16_f32 v109, v82, v83
    v_exp_f32 v84, v84
    v_exp_f32 v85, v85
    v_exp_f32 v86, v86
    v_exp_f32 v87, v87
    v_cvt_pk_bf16_f32 v110, v84, v85
    v_cvt_pk_bf16_f32 v111, v86, v87
    s_waitcnt vmcnt(8)
    v_mfma_f32_32x32x16_bf16 v[72:87], v[148:151], v[112:115], 0
    v_exp_f32 v88, v88
    v_exp_f32 v89, v89
    v_exp_f32 v90, v90
    v_exp_f32 v91, v91
    v_mfma_f32_32x32x16_bf16 v[40:55], v[180:183], v[108:111], v[40:55]
    buffer_load_dwordx4 v[172:175], v201, s[8:11], s22 offen
    v_cvt_pk_bf16_f32 v104, v88, v89
    v_cvt_pk_bf16_f32 v105, v90, v91
    v_exp_f32 v92, v92
    v_exp_f32 v93, v93
    v_exp_f32 v94, v94
    v_exp_f32 v95, v95
    v_mfma_f32_32x32x8_bf16 v[72:87], v[158:159], v[128:129], v[72:87]
    v_cvt_pk_bf16_f32 v106, v92, v93
    v_cvt_pk_bf16_f32 v107, v94, v95
    v_exp_f32 v96, v96
    v_exp_f32 v97, v97
    v_exp_f32 v98, v98
    v_exp_f32 v99, v99
    v_mfma_f32_32x32x16_bf16 v[56:71], v[176:179], v[104:107], v[56:71]
    v_cvt_pk_bf16_f32 v108, v96, v97
    v_cvt_pk_bf16_f32 v109, v98, v99
    v_exp_f32 v100, v100
    v_exp_f32 v101, v101
    v_exp_f32 v102, v102
    v_exp_f32 v103, v103
    v_cvt_pk_bf16_f32 v110, v100, v101
    v_cvt_pk_bf16_f32 v111, v102, v103
    v_mfma_f32_32x32x16_bf16 v[88:103], v[148:151], v[116:119], 0
    v_exp_f32 v72, v72
    v_exp_f32 v73, v73
    v_exp_f32 v74, v74
    v_exp_f32 v75, v75
    v_mfma_f32_32x32x16_bf16 v[56:71], v[180:183], v[108:111], v[56:71]
    buffer_load_dwordx4 v[144:147], v192, s[8:11], s21 offen offset:1024
    v_cvt_pk_bf16_f32 v104, v72, v73
    v_cvt_pk_bf16_f32 v105, v74, v75
    v_exp_f32 v76, v76
    v_exp_f32 v77, v77
    v_exp_f32 v78, v78
    v_exp_f32 v79, v79
    v_mfma_f32_32x32x8_bf16 v[88:103], v[158:159], v[130:131], v[88:103]
    v_cvt_pk_bf16_f32 v106, v76, v77
    v_cvt_pk_bf16_f32 v107, v78, v79
    v_exp_f32 v80, v80
    v_exp_f32 v81, v81
    v_exp_f32 v82, v82
    v_exp_f32 v83, v83
    v_mfma_f32_32x32x16_bf16 v[8:23], v[184:187], v[104:107], v[8:23]
    buffer_store_dwordx4 a[252:255], v241, s[8:11], 0 offen sc1
    v_cvt_pk_bf16_f32 v108, v80, v81
    v_cvt_pk_bf16_f32 v109, v82, v83
    v_exp_f32 v84, v84
    v_exp_f32 v85, v85
    v_exp_f32 v86, v86
    v_exp_f32 v87, v87
    v_cvt_pk_bf16_f32 v110, v84, v85
    v_cvt_pk_bf16_f32 v111, v86, v87
    v_mfma_f32_32x32x16_bf16 v[72:87], v[148:151], v[120:123], 0
    v_exp_f32 v88, v88
    v_exp_f32 v89, v89
    v_exp_f32 v90, v90
    v_exp_f32 v91, v91
    v_mfma_f32_32x32x16_bf16 v[8:23], v[188:191], v[108:111], v[8:23]
    buffer_load_dwordx2 v[156:157], v193, s[8:11], s21 offen offset:1024
    v_cvt_pk_bf16_f32 v104, v88, v89
    v_cvt_pk_bf16_f32 v105, v90, v91
    v_exp_f32 v92, v92
    v_exp_f32 v93, v93
    v_exp_f32 v94, v94
    v_exp_f32 v95, v95
    v_mfma_f32_32x32x8_bf16 v[72:87], v[158:159], v[132:133], v[72:87]
    v_cvt_pk_bf16_f32 v106, v92, v93
    v_cvt_pk_bf16_f32 v107, v94, v95
    v_exp_f32 v96, v96
    v_exp_f32 v97, v97
    v_exp_f32 v98, v98
    v_exp_f32 v99, v99
    v_mfma_f32_32x32x16_bf16 v[24:39], v[184:187], v[104:107], v[24:39]
    buffer_store_dwordx4 a[252:255], v241, s[8:11], 0 offen offset:512 sc1
    v_cvt_pk_bf16_f32 v108, v96, v97
    v_cvt_pk_bf16_f32 v109, v98, v99
    v_exp_f32 v100, v100
    v_exp_f32 v101, v101
    v_exp_f32 v102, v102
    v_exp_f32 v103, v103
    v_cvt_pk_bf16_f32 v110, v100, v101
    v_cvt_pk_bf16_f32 v111, v102, v103
    v_mfma_f32_32x32x16_bf16 v[88:103], v[148:151], v[124:127], 0
    v_exp_f32 v72, v72
    v_exp_f32 v73, v73
    v_exp_f32 v74, v74
    v_exp_f32 v75, v75
    v_mfma_f32_32x32x16_bf16 v[24:39], v[188:191], v[108:111], v[24:39]
    buffer_load_dwordx4 v[176:179], v202, s[8:11], s22 offen
    ds_read_b64_tr_b16 a[0:1], v224 offset:16384
    ds_read_b64_tr_b16 a[2:3], v224 offset:16896
    ds_read_b64_tr_b16 a[4:5], v225 offset:16384
    ds_read_b64_tr_b16 a[6:7], v225 offset:16896
    ds_read_b64_tr_b16 a[8:9], v226 offset:16384
    ds_read_b64_tr_b16 a[10:11], v226 offset:16896
    ds_read_b64_tr_b16 a[12:13], v227 offset:16384
    ds_read_b64_tr_b16 a[14:15], v227 offset:16896
    v_cvt_pk_bf16_f32 v104, v72, v73
    v_cvt_pk_bf16_f32 v105, v74, v75
    v_exp_f32 v76, v76
    v_exp_f32 v77, v77
    v_exp_f32 v78, v78
    v_exp_f32 v79, v79
    v_mfma_f32_32x32x8_bf16 v[88:103], v[158:159], v[134:135], v[88:103]
    v_cvt_pk_bf16_f32 v106, v76, v77
    v_cvt_pk_bf16_f32 v107, v78, v79
    v_exp_f32 v80, v80
    v_exp_f32 v81, v81
    v_exp_f32 v82, v82
    v_exp_f32 v83, v83
    v_mfma_f32_32x32x16_bf16 v[40:55], v[184:187], v[104:107], v[40:55]
    buffer_store_dwordx4 a[252:255], v242, s[48:51], 0 offen sc1
    v_cvt_pk_bf16_f32 v108, v80, v81
    v_cvt_pk_bf16_f32 v109, v82, v83
    v_exp_f32 v84, v84
    v_exp_f32 v85, v85
    v_exp_f32 v86, v86
    v_exp_f32 v87, v87
    v_cvt_pk_bf16_f32 v110, v84, v85
    v_cvt_pk_bf16_f32 v111, v86, v87
    s_waitcnt vmcnt(10)
    v_mfma_f32_32x32x16_bf16 v[72:87], v[136:139], v[112:115], 0
    v_exp_f32 v88, v88
    v_exp_f32 v89, v89
    v_exp_f32 v90, v90
    v_exp_f32 v91, v91
    v_mfma_f32_32x32x16_bf16 v[40:55], v[188:191], v[108:111], v[40:55]
    buffer_load_dwordx4 v[180:183], v203, s[8:11], s22 offen
    v_cvt_pk_bf16_f32 v104, v88, v89
    v_cvt_pk_bf16_f32 v105, v90, v91
    v_exp_f32 v92, v92
    v_exp_f32 v93, v93
    v_exp_f32 v94, v94
    v_exp_f32 v95, v95
    v_mfma_f32_32x32x8_bf16 v[72:87], v[152:153], v[128:129], v[72:87]
    v_cvt_pk_bf16_f32 v106, v92, v93
    v_cvt_pk_bf16_f32 v107, v94, v95
    v_exp_f32 v96, v96
    v_exp_f32 v97, v97
    v_exp_f32 v98, v98
    v_exp_f32 v99, v99
    v_mfma_f32_32x32x16_bf16 v[56:71], v[184:187], v[104:107], v[56:71]
    s_waitcnt lgkmcnt(0)
    s_add_u32 m0, s15, 16384
    s_nop 0
    buffer_load_dwordx4 v220, s[44:47], s85 offen offset:0 lds
    v_cvt_pk_bf16_f32 v108, v96, v97
    v_cvt_pk_bf16_f32 v109, v98, v99
    v_exp_f32 v100, v100
    v_exp_f32 v101, v101
    v_exp_f32 v102, v102
    v_exp_f32 v103, v103
    v_cvt_pk_bf16_f32 v110, v100, v101
    v_cvt_pk_bf16_f32 v111, v102, v103
    v_mfma_f32_32x32x16_bf16 v[88:103], v[136:139], v[116:119], 0
    v_exp_f32 v72, v72
    v_exp_f32 v73, v73
    v_exp_f32 v74, v74
    v_exp_f32 v75, v75
    v_mfma_f32_32x32x16_bf16 v[56:71], v[188:191], v[108:111], v[56:71]
    buffer_load_dwordx4 v[148:151], v192, s[8:11], s21 offen offset:1536
    v_cvt_pk_bf16_f32 v104, v72, v73
    v_cvt_pk_bf16_f32 v105, v74, v75
    v_exp_f32 v76, v76
    v_exp_f32 v77, v77
    v_exp_f32 v78, v78
    v_exp_f32 v79, v79
    v_mfma_f32_32x32x8_bf16 v[88:103], v[152:153], v[130:131], v[88:103]
    v_cvt_pk_bf16_f32 v106, v76, v77
    v_cvt_pk_bf16_f32 v107, v78, v79
    v_exp_f32 v80, v80
    v_exp_f32 v81, v81
    v_exp_f32 v82, v82
    v_exp_f32 v83, v83
    v_mfma_f32_32x32x16_bf16 v[8:23], v[160:163], v[104:107], v[8:23]
    buffer_load_dwordx4 v221, s[44:47], s85 offen offset:1024 lds
    v_cvt_pk_bf16_f32 v108, v80, v81
    v_cvt_pk_bf16_f32 v109, v82, v83
    v_exp_f32 v84, v84
    v_exp_f32 v85, v85
    v_exp_f32 v86, v86
    v_exp_f32 v87, v87
    v_cvt_pk_bf16_f32 v110, v84, v85
    v_cvt_pk_bf16_f32 v111, v86, v87
    v_mfma_f32_32x32x16_bf16 v[72:87], v[136:139], v[120:123], 0
    v_exp_f32 v88, v88
    v_exp_f32 v89, v89
    v_exp_f32 v90, v90
    v_exp_f32 v91, v91
    v_mfma_f32_32x32x16_bf16 v[8:23], v[164:167], v[108:111], v[8:23]
    buffer_load_dwordx2 v[158:159], v193, s[8:11], s21 offen offset:1536
    v_cvt_pk_bf16_f32 v104, v88, v89
    v_cvt_pk_bf16_f32 v105, v90, v91
    v_exp_f32 v92, v92
    v_exp_f32 v93, v93
    v_exp_f32 v94, v94
    v_exp_f32 v95, v95
    v_mfma_f32_32x32x8_bf16 v[72:87], v[152:153], v[132:133], v[72:87]
    v_cvt_pk_bf16_f32 v106, v92, v93
    v_cvt_pk_bf16_f32 v107, v94, v95
    v_exp_f32 v96, v96
    v_exp_f32 v97, v97
    v_exp_f32 v98, v98
    v_exp_f32 v99, v99
    v_mfma_f32_32x32x16_bf16 v[24:39], v[160:163], v[104:107], v[24:39]
    buffer_load_dwordx4 v222, s[44:47], s85 offen offset:2048 lds
    v_cvt_pk_bf16_f32 v108, v96, v97
    v_cvt_pk_bf16_f32 v109, v98, v99
    v_exp_f32 v100, v100
    v_exp_f32 v101, v101
    v_exp_f32 v102, v102
    v_exp_f32 v103, v103
    v_cvt_pk_bf16_f32 v110, v100, v101
    v_cvt_pk_bf16_f32 v111, v102, v103
    v_mfma_f32_32x32x16_bf16 v[88:103], v[136:139], v[124:127], 0
    v_exp_f32 v72, v72
    v_exp_f32 v73, v73
    v_exp_f32 v74, v74
    v_exp_f32 v75, v75
    v_mfma_f32_32x32x16_bf16 v[24:39], v[164:167], v[108:111], v[24:39]
    buffer_load_dwordx4 v[184:187], v204, s[8:11], s22 offen
    v_cvt_pk_bf16_f32 v104, v72, v73
    v_cvt_pk_bf16_f32 v105, v74, v75
    v_exp_f32 v76, v76
    v_exp_f32 v77, v77
    v_exp_f32 v78, v78
    v_exp_f32 v79, v79
    v_mfma_f32_32x32x8_bf16 v[88:103], v[152:153], v[134:135], v[88:103]
    v_cvt_pk_bf16_f32 v106, v76, v77
    v_cvt_pk_bf16_f32 v107, v78, v79
    v_exp_f32 v80, v80
    v_exp_f32 v81, v81
    v_exp_f32 v82, v82
    v_exp_f32 v83, v83
    v_mfma_f32_32x32x16_bf16 v[40:55], v[160:163], v[104:107], v[40:55]
    buffer_load_dwordx4 v223, s[44:47], s85 offen offset:3072 lds
    v_cvt_pk_bf16_f32 v108, v80, v81
    v_cvt_pk_bf16_f32 v109, v82, v83
    v_exp_f32 v84, v84
    v_exp_f32 v85, v85
    v_exp_f32 v86, v86
    v_exp_f32 v87, v87
    v_cvt_pk_bf16_f32 v110, v84, v85
    v_cvt_pk_bf16_f32 v111, v86, v87
    s_waitcnt vmcnt(14)
    v_mfma_f32_32x32x16_bf16 v[72:87], v[140:143], v[112:115], 0
    v_exp_f32 v88, v88
    v_exp_f32 v89, v89
    v_exp_f32 v90, v90
    v_exp_f32 v91, v91
    v_mfma_f32_32x32x16_bf16 v[40:55], v[164:167], v[108:111], v[40:55]
    buffer_load_dwordx4 v[188:191], v205, s[8:11], s22 offen
    v_cvt_pk_bf16_f32 v104, v88, v89
    v_cvt_pk_bf16_f32 v105, v90, v91
    v_exp_f32 v92, v92
    v_exp_f32 v93, v93
    v_exp_f32 v94, v94
    v_exp_f32 v95, v95
    v_mfma_f32_32x32x8_bf16 v[72:87], v[154:155], v[128:129], v[72:87]
    v_cvt_pk_bf16_f32 v106, v92, v93
    v_cvt_pk_bf16_f32 v107, v94, v95
    v_exp_f32 v96, v96
    v_exp_f32 v97, v97
    v_exp_f32 v98, v98
    v_exp_f32 v99, v99
    v_mfma_f32_32x32x16_bf16 v[56:71], v[160:163], v[104:107], v[56:71]
    s_mov_b32 s23, 1572864
    buffer_load_dword v7, v196, s[80:83], s23 offen
    v_cvt_pk_bf16_f32 v108, v96, v97
    v_cvt_pk_bf16_f32 v109, v98, v99
    v_exp_f32 v100, v100
    v_exp_f32 v101, v101
    v_exp_f32 v102, v102
    v_exp_f32 v103, v103
    v_cvt_pk_bf16_f32 v110, v100, v101
    v_cvt_pk_bf16_f32 v111, v102, v103
    v_mfma_f32_32x32x16_bf16 v[88:103], v[140:143], v[116:119], 0
    v_exp_f32 v72, v72
    v_exp_f32 v73, v73
    v_exp_f32 v74, v74
    v_exp_f32 v75, v75
    v_mfma_f32_32x32x16_bf16 v[56:71], v[164:167], v[108:111], v[56:71]
    s_add_u32 s22, s22, 165888
    s_add_u32 s21, s21, 2048
    buffer_load_dwordx4 v[136:139], v192, s[8:11], s21 offen offset:0
    v_cvt_pk_bf16_f32 v104, v72, v73
    v_cvt_pk_bf16_f32 v105, v74, v75
    v_exp_f32 v76, v76
    v_exp_f32 v77, v77
    v_exp_f32 v78, v78
    v_exp_f32 v79, v79
    v_mfma_f32_32x32x8_bf16 v[88:103], v[154:155], v[130:131], v[88:103]
    v_cvt_pk_bf16_f32 v106, v76, v77
    v_cvt_pk_bf16_f32 v107, v78, v79
    v_exp_f32 v80, v80
    v_exp_f32 v81, v81
    v_exp_f32 v82, v82
    v_exp_f32 v83, v83
    v_mfma_f32_32x32x16_bf16 v[8:23], v[168:171], v[104:107], v[8:23]
    v_cvt_pk_bf16_f32 v108, v80, v81
    v_cvt_pk_bf16_f32 v109, v82, v83
    v_exp_f32 v84, v84
    v_exp_f32 v85, v85
    v_exp_f32 v86, v86
    v_exp_f32 v87, v87
    v_cvt_pk_bf16_f32 v110, v84, v85
    v_cvt_pk_bf16_f32 v111, v86, v87
    v_mfma_f32_32x32x16_bf16 v[72:87], v[140:143], v[120:123], 0
    v_exp_f32 v88, v88
    v_exp_f32 v89, v89
    v_exp_f32 v90, v90
    v_exp_f32 v91, v91
    v_mfma_f32_32x32x16_bf16 v[8:23], v[172:175], v[108:111], v[8:23]
    buffer_load_dwordx2 v[152:153], v193, s[8:11], s21 offen offset:0
    v_cvt_pk_bf16_f32 v104, v88, v89
    v_cvt_pk_bf16_f32 v105, v90, v91
    v_exp_f32 v92, v92
    v_exp_f32 v93, v93
    v_exp_f32 v94, v94
    v_exp_f32 v95, v95
    v_mfma_f32_32x32x8_bf16 v[72:87], v[154:155], v[132:133], v[72:87]
    v_cvt_pk_bf16_f32 v106, v92, v93
    v_cvt_pk_bf16_f32 v107, v94, v95
    v_exp_f32 v96, v96
    v_exp_f32 v97, v97
    v_exp_f32 v98, v98
    v_exp_f32 v99, v99
    v_mfma_f32_32x32x16_bf16 v[24:39], v[168:171], v[104:107], v[24:39]
    v_cvt_pk_bf16_f32 v108, v96, v97
    v_cvt_pk_bf16_f32 v109, v98, v99
    v_exp_f32 v100, v100
    v_exp_f32 v101, v101
    v_exp_f32 v102, v102
    v_exp_f32 v103, v103
    v_cvt_pk_bf16_f32 v110, v100, v101
    v_cvt_pk_bf16_f32 v111, v102, v103
    v_mfma_f32_32x32x16_bf16 v[88:103], v[140:143], v[124:127], 0
    v_exp_f32 v72, v72
    v_exp_f32 v73, v73
    v_exp_f32 v74, v74
    v_exp_f32 v75, v75
    v_mfma_f32_32x32x16_bf16 v[24:39], v[172:175], v[108:111], v[24:39]
    buffer_load_dwordx4 v[160:163], v198, s[8:11], s22 offen
    v_cvt_pk_bf16_f32 v104, v72, v73
    v_cvt_pk_bf16_f32 v105, v74, v75
    v_exp_f32 v76, v76
    v_exp_f32 v77, v77
    v_exp_f32 v78, v78
    v_exp_f32 v79, v79
    v_mfma_f32_32x32x8_bf16 v[88:103], v[154:155], v[134:135], v[88:103]
    v_cvt_pk_bf16_f32 v106, v76, v77
    v_cvt_pk_bf16_f32 v107, v78, v79
    v_exp_f32 v80, v80
    v_exp_f32 v81, v81
    v_exp_f32 v82, v82
    v_exp_f32 v83, v83
    v_mfma_f32_32x32x16_bf16 v[40:55], v[168:171], v[104:107], v[40:55]
    v_cvt_pk_bf16_f32 v108, v80, v81
    v_cvt_pk_bf16_f32 v109, v82, v83
    v_exp_f32 v84, v84
    v_exp_f32 v85, v85
    v_exp_f32 v86, v86
    v_exp_f32 v87, v87
    v_cvt_pk_bf16_f32 v110, v84, v85
    v_cvt_pk_bf16_f32 v111, v86, v87
    s_waitcnt vmcnt(12)
    v_mfma_f32_32x32x16_bf16 v[72:87], v[144:147], v[112:115], 0
    v_exp_f32 v88, v88
    v_exp_f32 v89, v89
    v_exp_f32 v90, v90
    v_exp_f32 v91, v91
    v_mfma_f32_32x32x16_bf16 v[40:55], v[172:175], v[108:111], v[40:55]
    buffer_load_dwordx4 v[164:167], v199, s[8:11], s22 offen
    v_cvt_pk_bf16_f32 v104, v88, v89
    v_cvt_pk_bf16_f32 v105, v90, v91
    v_exp_f32 v92, v92
    v_exp_f32 v93, v93
    v_exp_f32 v94, v94
    v_exp_f32 v95, v95
    v_mfma_f32_32x32x8_bf16 v[72:87], v[156:157], v[128:129], v[72:87]
    v_cvt_pk_bf16_f32 v106, v92, v93
    v_cvt_pk_bf16_f32 v107, v94, v95
    v_exp_f32 v96, v96
    v_exp_f32 v97, v97
    v_exp_f32 v98, v98
    v_exp_f32 v99, v99
    v_mfma_f32_32x32x16_bf16 v[56:71], v[168:171], v[104:107], v[56:71]
    v_cvt_pk_bf16_f32 v108, v96, v97
    v_cvt_pk_bf16_f32 v109, v98, v99
    v_exp_f32 v100, v100
    v_exp_f32 v101, v101
    v_exp_f32 v102, v102
    v_exp_f32 v103, v103
    v_cvt_pk_bf16_f32 v110, v100, v101
    v_cvt_pk_bf16_f32 v111, v102, v103
    v_mfma_f32_32x32x16_bf16 v[88:103], v[144:147], v[116:119], 0
    v_exp_f32 v72, v72
    v_exp_f32 v73, v73
    v_exp_f32 v74, v74
    v_exp_f32 v75, v75
    v_mfma_f32_32x32x16_bf16 v[56:71], v[172:175], v[108:111], v[56:71]
    buffer_load_dwordx4 v[140:143], v192, s[8:11], s21 offen offset:512
    v_cvt_pk_bf16_f32 v104, v72, v73
    v_cvt_pk_bf16_f32 v105, v74, v75
    v_exp_f32 v76, v76
    v_exp_f32 v77, v77
    v_exp_f32 v78, v78
    v_exp_f32 v79, v79
    v_mfma_f32_32x32x8_bf16 v[88:103], v[156:157], v[130:131], v[88:103]
    v_cvt_pk_bf16_f32 v106, v76, v77
    v_cvt_pk_bf16_f32 v107, v78, v79
    v_exp_f32 v80, v80
    v_exp_f32 v81, v81
    v_exp_f32 v82, v82
    v_exp_f32 v83, v83
    v_mfma_f32_32x32x16_bf16 v[8:23], v[176:179], v[104:107], v[8:23]
    v_cvt_pk_bf16_f32 v108, v80, v81
    v_cvt_pk_bf16_f32 v109, v82, v83
    v_exp_f32 v84, v84
    v_exp_f32 v85, v85
    v_exp_f32 v86, v86
    v_exp_f32 v87, v87
    v_cvt_pk_bf16_f32 v110, v84, v85
    v_cvt_pk_bf16_f32 v111, v86, v87
    v_mfma_f32_32x32x16_bf16 v[72:87], v[144:147], v[120:123], 0
    v_exp_f32 v88, v88
    v_exp_f32 v89, v89
    v_exp_f32 v90, v90
    v_exp_f32 v91, v91
    v_mfma_f32_32x32x16_bf16 v[8:23], v[180:183], v[108:111], v[8:23]
    buffer_load_dwordx2 v[154:155], v193, s[8:11], s21 offen offset:512
    v_cvt_pk_bf16_f32 v104, v88, v89
    v_cvt_pk_bf16_f32 v105, v90, v91
    v_exp_f32 v92, v92
    v_exp_f32 v93, v93
    v_exp_f32 v94, v94
    v_exp_f32 v95, v95
    v_mfma_f32_32x32x8_bf16 v[72:87], v[156:157], v[132:133], v[72:87]
    v_cvt_pk_bf16_f32 v106, v92, v93
    v_cvt_pk_bf16_f32 v107, v94, v95
    v_exp_f32 v96, v96
    v_exp_f32 v97, v97
    v_exp_f32 v98, v98
    v_exp_f32 v99, v99
    v_mfma_f32_32x32x16_bf16 v[24:39], v[176:179], v[104:107], v[24:39]
    v_cvt_pk_bf16_f32 v108, v96, v97
    v_cvt_pk_bf16_f32 v109, v98, v99
    v_exp_f32 v100, v100
    v_exp_f32 v101, v101
    v_exp_f32 v102, v102
    v_exp_f32 v103, v103
    v_cvt_pk_bf16_f32 v110, v100, v101
    v_cvt_pk_bf16_f32 v111, v102, v103
    v_mfma_f32_32x32x16_bf16 v[88:103], v[144:147], v[124:127], 0
    v_exp_f32 v72, v72
    v_exp_f32 v73, v73
    v_exp_f32 v74, v74
    v_exp_f32 v75, v75
    v_mfma_f32_32x32x16_bf16 v[24:39], v[180:183], v[108:111], v[24:39]
    buffer_load_dwordx4 v[168:171], v200, s[8:11], s22 offen
    v_cvt_pk_bf16_f32 v104, v72, v73
    v_cvt_pk_bf16_f32 v105, v74, v75
    v_exp_f32 v76, v76
    v_exp_f32 v77, v77
    v_exp_f32 v78, v78
    v_exp_f32 v79, v79
    v_mfma_f32_32x32x8_bf16 v[88:103], v[156:157], v[134:135], v[88:103]
    v_cvt_pk_bf16_f32 v106, v76, v77
    v_cvt_pk_bf16_f32 v107, v78, v79
    v_exp_f32 v80, v80
    v_exp_f32 v81, v81
    v_exp_f32 v82, v82
    v_exp_f32 v83, v83
    v_mfma_f32_32x32x16_bf16 v[40:55], v[176:179], v[104:107], v[40:55]
    v_cvt_pk_bf16_f32 v108, v80, v81
    v_cvt_pk_bf16_f32 v109, v82, v83
    v_exp_f32 v84, v84
    v_exp_f32 v85, v85
    v_exp_f32 v86, v86
    v_exp_f32 v87, v87
    v_cvt_pk_bf16_f32 v110, v84, v85
    v_cvt_pk_bf16_f32 v111, v86, v87
    s_waitcnt vmcnt(8)
    v_mfma_f32_32x32x16_bf16 v[72:87], v[148:151], v[112:115], 0
    v_exp_f32 v88, v88
    v_exp_f32 v89, v89
    v_exp_f32 v90, v90
    v_exp_f32 v91, v91
    v_mfma_f32_32x32x16_bf16 v[40:55], v[180:183], v[108:111], v[40:55]
    buffer_load_dwordx4 v[172:175], v201, s[8:11], s22 offen
    v_cvt_pk_bf16_f32 v104, v88, v89
    v_cvt_pk_bf16_f32 v105, v90, v91
    v_exp_f32 v92, v92
    v_exp_f32 v93, v93
    v_exp_f32 v94, v94
    v_exp_f32 v95, v95
    v_mfma_f32_32x32x8_bf16 v[72:87], v[158:159], v[128:129], v[72:87]
    v_cvt_pk_bf16_f32 v106, v92, v93
    v_cvt_pk_bf16_f32 v107, v94, v95
    v_exp_f32 v96, v96
    v_exp_f32 v97, v97
    v_exp_f32 v98, v98
    v_exp_f32 v99, v99
    v_mfma_f32_32x32x16_bf16 v[56:71], v[176:179], v[104:107], v[56:71]
    v_cvt_pk_bf16_f32 v108, v96, v97
    v_cvt_pk_bf16_f32 v109, v98, v99
    v_exp_f32 v100, v100
    v_exp_f32 v101, v101
    v_exp_f32 v102, v102
    v_exp_f32 v103, v103
    v_cvt_pk_bf16_f32 v110, v100, v101
    v_cvt_pk_bf16_f32 v111, v102, v103
    v_mfma_f32_32x32x16_bf16 v[88:103], v[148:151], v[116:119], 0
    v_exp_f32 v72, v72
    v_exp_f32 v73, v73
    v_exp_f32 v74, v74
    v_exp_f32 v75, v75
    v_mfma_f32_32x32x16_bf16 v[56:71], v[180:183], v[108:111], v[56:71]
    buffer_load_dwordx4 v[144:147], v192, s[8:11], s21 offen offset:1024
    v_cvt_pk_bf16_f32 v104, v72, v73
    v_cvt_pk_bf16_f32 v105, v74, v75
    v_exp_f32 v76, v76
    v_exp_f32 v77, v77
    v_exp_f32 v78, v78
    v_exp_f32 v79, v79
    v_mfma_f32_32x32x8_bf16 v[88:103], v[158:159], v[130:131], v[88:103]
    v_cvt_pk_bf16_f32 v106, v76, v77
    v_cvt_pk_bf16_f32 v107, v78, v79
    v_exp_f32 v80, v80
    v_exp_f32 v81, v81
    v_exp_f32 v82, v82
    v_exp_f32 v83, v83
    v_mfma_f32_32x32x16_bf16 v[8:23], v[184:187], v[104:107], v[8:23]
    s_mov_b32 s23, 40960
    buffer_store_dwordx4 a[252:255], v242, s[48:51], s23 offen sc1
    v_cvt_pk_bf16_f32 v108, v80, v81
    v_cvt_pk_bf16_f32 v109, v82, v83
    v_exp_f32 v84, v84
    v_exp_f32 v85, v85
    v_exp_f32 v86, v86
    v_exp_f32 v87, v87
    v_cvt_pk_bf16_f32 v110, v84, v85
    v_cvt_pk_bf16_f32 v111, v86, v87
    v_mfma_f32_32x32x16_bf16 v[72:87], v[148:151], v[120:123], 0
    v_exp_f32 v88, v88
    v_exp_f32 v89, v89
    v_exp_f32 v90, v90
    v_exp_f32 v91, v91
    v_mfma_f32_32x32x16_bf16 v[8:23], v[188:191], v[108:111], v[8:23]
    buffer_load_dwordx2 v[156:157], v193, s[8:11], s21 offen offset:1024
    v_cvt_pk_bf16_f32 v104, v88, v89
    v_cvt_pk_bf16_f32 v105, v90, v91
    v_exp_f32 v92, v92
    v_exp_f32 v93, v93
    v_exp_f32 v94, v94
    v_exp_f32 v95, v95
    v_mfma_f32_32x32x8_bf16 v[72:87], v[158:159], v[132:133], v[72:87]
    v_cvt_pk_bf16_f32 v106, v92, v93
    v_cvt_pk_bf16_f32 v107, v94, v95
    v_exp_f32 v96, v96
    v_exp_f32 v97, v97
    v_exp_f32 v98, v98
    v_exp_f32 v99, v99
    v_mfma_f32_32x32x16_bf16 v[24:39], v[184:187], v[104:107], v[24:39]
    s_mov_b32 exec_hi, 0
    buffer_store_dwordx4 a[252:255], v233, s[8:11], s60 offen sc1
    buffer_store_dwordx4 a[252:255], v241, s[8:11], 0 offen offset:1024 sc1
    s_mov_b64 exec, -1
    v_cvt_pk_bf16_f32 v108, v96, v97
    v_cvt_pk_bf16_f32 v109, v98, v99
    v_exp_f32 v100, v100
    v_exp_f32 v101, v101
    v_exp_f32 v102, v102
    v_exp_f32 v103, v103
    v_cvt_pk_bf16_f32 v110, v100, v101
    v_cvt_pk_bf16_f32 v111, v102, v103
    v_mfma_f32_32x32x16_bf16 v[88:103], v[148:151], v[124:127], 0
    v_exp_f32 v72, v72
    v_exp_f32 v73, v73
    v_exp_f32 v74, v74
    v_exp_f32 v75, v75
    v_mfma_f32_32x32x16_bf16 v[24:39], v[188:191], v[108:111], v[24:39]
    buffer_load_dwordx4 v[176:179], v202, s[8:11], s22 offen
    ds_read_b64_tr_b16 a[16:17], v224 offset:16384
    ds_read_b64_tr_b16 a[18:19], v224 offset:16896
    ds_read_b64_tr_b16 a[20:21], v225 offset:16384
    ds_read_b64_tr_b16 a[22:23], v225 offset:16896
    ds_read_b64_tr_b16 a[24:25], v226 offset:16384
    ds_read_b64_tr_b16 a[26:27], v226 offset:16896
    ds_read_b64_tr_b16 a[28:29], v227 offset:16384
    ds_read_b64_tr_b16 a[30:31], v227 offset:16896
    v_cvt_pk_bf16_f32 v104, v72, v73
    v_cvt_pk_bf16_f32 v105, v74, v75
    v_exp_f32 v76, v76
    v_exp_f32 v77, v77
    v_exp_f32 v78, v78
    v_exp_f32 v79, v79
    v_mfma_f32_32x32x8_bf16 v[88:103], v[158:159], v[134:135], v[88:103]
    v_cvt_pk_bf16_f32 v106, v76, v77
    v_cvt_pk_bf16_f32 v107, v78, v79
    v_exp_f32 v80, v80
    v_exp_f32 v81, v81
    v_exp_f32 v82, v82
    v_exp_f32 v83, v83
    v_mfma_f32_32x32x16_bf16 v[40:55], v[184:187], v[104:107], v[40:55]
    v_cvt_pk_bf16_f32 v108, v80, v81
    v_cvt_pk_bf16_f32 v109, v82, v83
    v_exp_f32 v84, v84
    v_exp_f32 v85, v85
    v_exp_f32 v86, v86
    v_exp_f32 v87, v87
    v_cvt_pk_bf16_f32 v110, v84, v85
    v_cvt_pk_bf16_f32 v111, v86, v87
    s_waitcnt vmcnt(10)
    v_mfma_f32_32x32x16_bf16 v[72:87], v[136:139], v[112:115], 0
    v_exp_f32 v88, v88
    v_exp_f32 v89, v89
    v_exp_f32 v90, v90
    v_exp_f32 v91, v91
    v_mfma_f32_32x32x16_bf16 v[40:55], v[188:191], v[108:111], v[40:55]
    buffer_load_dwordx4 v[180:183], v203, s[8:11], s22 offen
    v_cvt_pk_bf16_f32 v104, v88, v89
    v_cvt_pk_bf16_f32 v105, v90, v91
    v_exp_f32 v92, v92
    v_exp_f32 v93, v93
    v_exp_f32 v94, v94
    v_exp_f32 v95, v95
    v_mfma_f32_32x32x8_bf16 v[72:87], v[152:153], v[128:129], v[72:87]
    v_cvt_pk_bf16_f32 v106, v92, v93
    v_cvt_pk_bf16_f32 v107, v94, v95
    v_exp_f32 v96, v96
    v_exp_f32 v97, v97
    v_exp_f32 v98, v98
    v_exp_f32 v99, v99
    v_mfma_f32_32x32x16_bf16 v[56:71], v[184:187], v[104:107], v[56:71]
    s_waitcnt lgkmcnt(0)
    s_add_u32 m0, s15, 16384
    s_nop 0
    buffer_load_dwordx4 v220, s[44:47], s86 offen offset:0 lds
    v_cvt_pk_bf16_f32 v108, v96, v97
    v_cvt_pk_bf16_f32 v109, v98, v99
    v_exp_f32 v100, v100
    v_exp_f32 v101, v101
    v_exp_f32 v102, v102
    v_exp_f32 v103, v103
    v_cvt_pk_bf16_f32 v110, v100, v101
    v_cvt_pk_bf16_f32 v111, v102, v103
    v_mfma_f32_32x32x16_bf16 v[88:103], v[136:139], v[116:119], 0
    v_exp_f32 v72, v72
    v_exp_f32 v73, v73
    v_exp_f32 v74, v74
    v_exp_f32 v75, v75
    v_mfma_f32_32x32x16_bf16 v[56:71], v[188:191], v[108:111], v[56:71]
    buffer_load_dwordx4 v[148:151], v192, s[8:11], s21 offen offset:1536
    v_cvt_pk_bf16_f32 v104, v72, v73
    v_cvt_pk_bf16_f32 v105, v74, v75
    v_exp_f32 v76, v76
    v_exp_f32 v77, v77
    v_exp_f32 v78, v78
    v_exp_f32 v79, v79
    v_mfma_f32_32x32x8_bf16 v[88:103], v[152:153], v[130:131], v[88:103]
    v_cvt_pk_bf16_f32 v106, v76, v77
    v_cvt_pk_bf16_f32 v107, v78, v79
    v_exp_f32 v80, v80
    v_exp_f32 v81, v81
    v_exp_f32 v82, v82
    v_exp_f32 v83, v83
    v_mfma_f32_32x32x16_bf16 v[8:23], v[160:163], v[104:107], v[8:23]
    buffer_load_dwordx4 v221, s[44:47], s86 offen offset:1024 lds
    v_cvt_pk_bf16_f32 v108, v80, v81
    v_cvt_pk_bf16_f32 v109, v82, v83
    v_exp_f32 v84, v84
    v_exp_f32 v85, v85
    v_exp_f32 v86, v86
    v_exp_f32 v87, v87
    v_cvt_pk_bf16_f32 v110, v84, v85
    v_cvt_pk_bf16_f32 v111, v86, v87
    v_mfma_f32_32x32x16_bf16 v[72:87], v[136:139], v[120:123], 0
    v_exp_f32 v88, v88
    v_exp_f32 v89, v89
    v_exp_f32 v90, v90
    v_exp_f32 v91, v91
    v_mfma_f32_32x32x16_bf16 v[8:23], v[164:167], v[108:111], v[8:23]
    buffer_load_dwordx2 v[158:159], v193, s[8:11], s21 offen offset:1536
    v_cvt_pk_bf16_f32 v104, v88, v89
    v_cvt_pk_bf16_f32 v105, v90, v91
    v_exp_f32 v92, v92
    v_exp_f32 v93, v93
    v_exp_f32 v94, v94
    v_exp_f32 v95, v95
    v_mfma_f32_32x32x8_bf16 v[72:87], v[152:153], v[132:133], v[72:87]
    v_cvt_pk_bf16_f32 v106, v92, v93
    v_cvt_pk_bf16_f32 v107, v94, v95
    v_exp_f32 v96, v96
    v_exp_f32 v97, v97
    v_exp_f32 v98, v98
    v_exp_f32 v99, v99
    v_mfma_f32_32x32x16_bf16 v[24:39], v[160:163], v[104:107], v[24:39]
    buffer_load_dwordx4 v222, s[44:47], s86 offen offset:2048 lds
    v_cvt_pk_bf16_f32 v108, v96, v97
    v_cvt_pk_bf16_f32 v109, v98, v99
    v_exp_f32 v100, v100
    v_exp_f32 v101, v101
    v_exp_f32 v102, v102
    v_exp_f32 v103, v103
    v_cvt_pk_bf16_f32 v110, v100, v101
    v_cvt_pk_bf16_f32 v111, v102, v103
    v_mfma_f32_32x32x16_bf16 v[88:103], v[136:139], v[124:127], 0
    v_exp_f32 v72, v72
    v_exp_f32 v73, v73
    v_exp_f32 v74, v74
    v_exp_f32 v75, v75
    v_mfma_f32_32x32x16_bf16 v[24:39], v[164:167], v[108:111], v[24:39]
    buffer_load_dwordx4 v[184:187], v204, s[8:11], s22 offen
    v_cvt_pk_bf16_f32 v104, v72, v73
    v_cvt_pk_bf16_f32 v105, v74, v75
    v_exp_f32 v76, v76
    v_exp_f32 v77, v77
    v_exp_f32 v78, v78
    v_exp_f32 v79, v79
    v_mfma_f32_32x32x8_bf16 v[88:103], v[152:153], v[134:135], v[88:103]
    v_cvt_pk_bf16_f32 v106, v76, v77
    v_cvt_pk_bf16_f32 v107, v78, v79
    v_exp_f32 v80, v80
    v_exp_f32 v81, v81
    v_exp_f32 v82, v82
    v_exp_f32 v83, v83
    v_mfma_f32_32x32x16_bf16 v[40:55], v[160:163], v[104:107], v[40:55]
    buffer_load_dwordx4 v223, s[44:47], s86 offen offset:3072 lds
    v_cvt_pk_bf16_f32 v108, v80, v81
    v_cvt_pk_bf16_f32 v109, v82, v83
    v_exp_f32 v84, v84
    v_exp_f32 v85, v85
    v_exp_f32 v86, v86
    v_exp_f32 v87, v87
    v_cvt_pk_bf16_f32 v110, v84, v85
    v_cvt_pk_bf16_f32 v111, v86, v87
    s_waitcnt vmcnt(14)
    v_mfma_f32_32x32x16_bf16 v[72:87], v[140:143], v[112:115], 0
    v_exp_f32 v88, v88
    v_exp_f32 v89, v89
    v_exp_f32 v90, v90
    v_exp_f32 v91, v91
    v_mfma_f32_32x32x16_bf16 v[40:55], v[164:167], v[108:111], v[40:55]
    buffer_load_dwordx4 v[188:191], v205, s[8:11], s22 offen
    v_cvt_pk_bf16_f32 v104, v88, v89
    v_cvt_pk_bf16_f32 v105, v90, v91
    v_exp_f32 v92, v92
    v_exp_f32 v93, v93
    v_exp_f32 v94, v94
    v_exp_f32 v95, v95
    v_mfma_f32_32x32x8_bf16 v[72:87], v[154:155], v[128:129], v[72:87]
    v_cvt_pk_bf16_f32 v106, v92, v93
    v_cvt_pk_bf16_f32 v107, v94, v95
    v_exp_f32 v96, v96
    v_exp_f32 v97, v97
    v_exp_f32 v98, v98
    v_exp_f32 v99, v99
    v_mfma_f32_32x32x16_bf16 v[56:71], v[160:163], v[104:107], v[56:71]
    s_mov_b32 s23, 3145728
    buffer_load_dword v7, v196, s[80:83], s23 offen
    v_cvt_pk_bf16_f32 v108, v96, v97
    v_cvt_pk_bf16_f32 v109, v98, v99
    v_exp_f32 v100, v100
    v_exp_f32 v101, v101
    v_exp_f32 v102, v102
    v_exp_f32 v103, v103
    v_cvt_pk_bf16_f32 v110, v100, v101
    v_cvt_pk_bf16_f32 v111, v102, v103
    v_mfma_f32_32x32x16_bf16 v[88:103], v[140:143], v[116:119], 0
    v_exp_f32 v72, v72
    v_exp_f32 v73, v73
    v_exp_f32 v74, v74
    v_exp_f32 v75, v75
    v_mfma_f32_32x32x16_bf16 v[56:71], v[164:167], v[108:111], v[56:71]
    s_add_u32 s22, s22, 165888
    s_add_u32 s21, s21, 2048
    buffer_load_dwordx4 v[136:139], v192, s[8:11], s21 offen offset:0
    v_cvt_pk_bf16_f32 v104, v72, v73
    v_cvt_pk_bf16_f32 v105, v74, v75
    v_exp_f32 v76, v76
    v_exp_f32 v77, v77
    v_exp_f32 v78, v78
    v_exp_f32 v79, v79
    v_mfma_f32_32x32x8_bf16 v[88:103], v[154:155], v[130:131], v[88:103]
    v_cvt_pk_bf16_f32 v106, v76, v77
    v_cvt_pk_bf16_f32 v107, v78, v79
    v_exp_f32 v80, v80
    v_exp_f32 v81, v81
    v_exp_f32 v82, v82
    v_exp_f32 v83, v83
    v_mfma_f32_32x32x16_bf16 v[8:23], v[168:171], v[104:107], v[8:23]
    v_cvt_pk_bf16_f32 v108, v80, v81
    v_cvt_pk_bf16_f32 v109, v82, v83
    v_exp_f32 v84, v84
    v_exp_f32 v85, v85
    v_exp_f32 v86, v86
    v_exp_f32 v87, v87
    v_cvt_pk_bf16_f32 v110, v84, v85
    v_cvt_pk_bf16_f32 v111, v86, v87
    v_mfma_f32_32x32x16_bf16 v[72:87], v[140:143], v[120:123], 0
    v_exp_f32 v88, v88
    v_exp_f32 v89, v89
    v_exp_f32 v90, v90
    v_exp_f32 v91, v91
    v_mfma_f32_32x32x16_bf16 v[8:23], v[172:175], v[108:111], v[8:23]
    buffer_load_dwordx2 v[152:153], v193, s[8:11], s21 offen offset:0
    v_cvt_pk_bf16_f32 v104, v88, v89
    v_cvt_pk_bf16_f32 v105, v90, v91
    v_exp_f32 v92, v92
    v_exp_f32 v93, v93
    v_exp_f32 v94, v94
    v_exp_f32 v95, v95
    v_mfma_f32_32x32x8_bf16 v[72:87], v[154:155], v[132:133], v[72:87]
    v_cvt_pk_bf16_f32 v106, v92, v93
    v_cvt_pk_bf16_f32 v107, v94, v95
    v_exp_f32 v96, v96
    v_exp_f32 v97, v97
    v_exp_f32 v98, v98
    v_exp_f32 v99, v99
    v_mfma_f32_32x32x16_bf16 v[24:39], v[168:171], v[104:107], v[24:39]
    v_cvt_pk_bf16_f32 v108, v96, v97
    v_cvt_pk_bf16_f32 v109, v98, v99
    v_exp_f32 v100, v100
    v_exp_f32 v101, v101
    v_exp_f32 v102, v102
    v_exp_f32 v103, v103
    v_cvt_pk_bf16_f32 v110, v100, v101
    v_cvt_pk_bf16_f32 v111, v102, v103
    v_mfma_f32_32x32x16_bf16 v[88:103], v[140:143], v[124:127], 0
    v_exp_f32 v72, v72
    v_exp_f32 v73, v73
    v_exp_f32 v74, v74
    v_exp_f32 v75, v75
    v_mfma_f32_32x32x16_bf16 v[24:39], v[172:175], v[108:111], v[24:39]
    buffer_load_dwordx4 v[160:163], v198, s[8:11], s22 offen
    v_cvt_pk_bf16_f32 v104, v72, v73
    v_cvt_pk_bf16_f32 v105, v74, v75
    v_exp_f32 v76, v76
    v_exp_f32 v77, v77
    v_exp_f32 v78, v78
    v_exp_f32 v79, v79
    v_mfma_f32_32x32x8_bf16 v[88:103], v[154:155], v[134:135], v[88:103]
    v_cvt_pk_bf16_f32 v106, v76, v77
    v_cvt_pk_bf16_f32 v107, v78, v79
    v_exp_f32 v80, v80
    v_exp_f32 v81, v81
    v_exp_f32 v82, v82
    v_exp_f32 v83, v83
    v_mfma_f32_32x32x16_bf16 v[40:55], v[168:171], v[104:107], v[40:55]
    v_cvt_pk_bf16_f32 v108, v80, v81
    v_cvt_pk_bf16_f32 v109, v82, v83
    v_exp_f32 v84, v84
    v_exp_f32 v85, v85
    v_exp_f32 v86, v86
    v_exp_f32 v87, v87
    v_cvt_pk_bf16_f32 v110, v84, v85
    v_cvt_pk_bf16_f32 v111, v86, v87
    s_waitcnt vmcnt(12)
    v_mfma_f32_32x32x16_bf16 v[72:87], v[144:147], v[112:115], 0
    v_exp_f32 v88, v88
    v_exp_f32 v89, v89
    v_exp_f32 v90, v90
    v_exp_f32 v91, v91
    v_mfma_f32_32x32x16_bf16 v[40:55], v[172:175], v[108:111], v[40:55]
    buffer_load_dwordx4 v[164:167], v199, s[8:11], s22 offen
    v_cvt_pk_bf16_f32 v104, v88, v89
    v_cvt_pk_bf16_f32 v105, v90, v91
    v_exp_f32 v92, v92
    v_exp_f32 v93, v93
    v_exp_f32 v94, v94
    v_exp_f32 v95, v95
    v_mfma_f32_32x32x8_bf16 v[72:87], v[156:157], v[128:129], v[72:87]
    v_cvt_pk_bf16_f32 v106, v92, v93
    v_cvt_pk_bf16_f32 v107, v94, v95
    v_exp_f32 v96, v96
    v_exp_f32 v97, v97
    v_exp_f32 v98, v98
    v_exp_f32 v99, v99
    v_mfma_f32_32x32x16_bf16 v[56:71], v[168:171], v[104:107], v[56:71]
    v_cvt_pk_bf16_f32 v108, v96, v97
    v_cvt_pk_bf16_f32 v109, v98, v99
    v_exp_f32 v100, v100
    v_exp_f32 v101, v101
    v_exp_f32 v102, v102
    v_exp_f32 v103, v103
    v_cvt_pk_bf16_f32 v110, v100, v101
    v_cvt_pk_bf16_f32 v111, v102, v103
    v_mfma_f32_32x32x16_bf16 v[88:103], v[144:147], v[116:119], 0
    v_exp_f32 v72, v72
    v_exp_f32 v73, v73
    v_exp_f32 v74, v74
    v_exp_f32 v75, v75
    v_mfma_f32_32x32x16_bf16 v[56:71], v[172:175], v[108:111], v[56:71]
    buffer_load_dwordx4 v[140:143], v192, s[8:11], s21 offen offset:512
    v_cvt_pk_bf16_f32 v104, v72, v73
    v_cvt_pk_bf16_f32 v105, v74, v75
    v_exp_f32 v76, v76
    v_exp_f32 v77, v77
    v_exp_f32 v78, v78
    v_exp_f32 v79, v79
    v_mfma_f32_32x32x8_bf16 v[88:103], v[156:157], v[130:131], v[88:103]
    v_cvt_pk_bf16_f32 v106, v76, v77
    v_cvt_pk_bf16_f32 v107, v78, v79
    v_exp_f32 v80, v80
    v_exp_f32 v81, v81
    v_exp_f32 v82, v82
    v_exp_f32 v83, v83
    v_mfma_f32_32x32x16_bf16 v[8:23], v[176:179], v[104:107], v[8:23]
    v_cvt_pk_bf16_f32 v108, v80, v81
    v_cvt_pk_bf16_f32 v109, v82, v83
    v_exp_f32 v84, v84
    v_exp_f32 v85, v85
    v_exp_f32 v86, v86
    v_exp_f32 v87, v87
    v_cvt_pk_bf16_f32 v110, v84, v85
    v_cvt_pk_bf16_f32 v111, v86, v87
    v_mfma_f32_32x32x16_bf16 v[72:87], v[144:147], v[120:123], 0
    v_exp_f32 v88, v88
    v_exp_f32 v89, v89
    v_exp_f32 v90, v90
    v_exp_f32 v91, v91
    v_mfma_f32_32x32x16_bf16 v[8:23], v[180:183], v[108:111], v[8:23]
    buffer_load_dwordx2 v[154:155], v193, s[8:11], s21 offen offset:512
    v_cvt_pk_bf16_f32 v104, v88, v89
    v_cvt_pk_bf16_f32 v105, v90, v91
    v_exp_f32 v92, v92
    v_exp_f32 v93, v93
    v_exp_f32 v94, v94
    v_exp_f32 v95, v95
    v_mfma_f32_32x32x8_bf16 v[72:87], v[156:157], v[132:133], v[72:87]
    v_cvt_pk_bf16_f32 v106, v92, v93
    v_cvt_pk_bf16_f32 v107, v94, v95
    v_exp_f32 v96, v96
    v_exp_f32 v97, v97
    v_exp_f32 v98, v98
    v_exp_f32 v99, v99
    v_mfma_f32_32x32x16_bf16 v[24:39], v[176:179], v[104:107], v[24:39]
    v_cvt_pk_bf16_f32 v108, v96, v97
    v_cvt_pk_bf16_f32 v109, v98, v99
    v_exp_f32 v100, v100
    v_exp_f32 v101, v101
    v_exp_f32 v102, v102
    v_exp_f32 v103, v103
    v_cvt_pk_bf16_f32 v110, v100, v101
    v_cvt_pk_bf16_f32 v111, v102, v103
    v_mfma_f32_32x32x16_bf16 v[88:103], v[144:147], v[124:127], 0
    v_exp_f32 v72, v72
    v_exp_f32 v73, v73
    v_exp_f32 v74, v74
    v_exp_f32 v75, v75
    v_mfma_f32_32x32x16_bf16 v[24:39], v[180:183], v[108:111], v[24:39]
    buffer_load_dwordx4 v[168:171], v200, s[8:11], s22 offen
    v_cvt_pk_bf16_f32 v104, v72, v73
    v_cvt_pk_bf16_f32 v105, v74, v75
    v_exp_f32 v76, v76
    v_exp_f32 v77, v77
    v_exp_f32 v78, v78
    v_exp_f32 v79, v79
    v_mfma_f32_32x32x8_bf16 v[88:103], v[156:157], v[134:135], v[88:103]
    v_cvt_pk_bf16_f32 v106, v76, v77
    v_cvt_pk_bf16_f32 v107, v78, v79
    v_exp_f32 v80, v80
    v_exp_f32 v81, v81
    v_exp_f32 v82, v82
    v_exp_f32 v83, v83
    v_mfma_f32_32x32x16_bf16 v[40:55], v[176:179], v[104:107], v[40:55]
    v_cvt_pk_bf16_f32 v108, v80, v81
    v_cvt_pk_bf16_f32 v109, v82, v83
    v_exp_f32 v84, v84
    v_exp_f32 v85, v85
    v_exp_f32 v86, v86
    v_exp_f32 v87, v87
    v_cvt_pk_bf16_f32 v110, v84, v85
    v_cvt_pk_bf16_f32 v111, v86, v87
    s_waitcnt vmcnt(8)
    v_mfma_f32_32x32x16_bf16 v[72:87], v[148:151], v[112:115], 0
    v_exp_f32 v88, v88
    v_exp_f32 v89, v89
    v_exp_f32 v90, v90
    v_exp_f32 v91, v91
    v_mfma_f32_32x32x16_bf16 v[40:55], v[180:183], v[108:111], v[40:55]
    buffer_load_dwordx4 v[172:175], v201, s[8:11], s22 offen
    v_cvt_pk_bf16_f32 v104, v88, v89
    v_cvt_pk_bf16_f32 v105, v90, v91
    v_exp_f32 v92, v92
    v_exp_f32 v93, v93
    v_exp_f32 v94, v94
    v_exp_f32 v95, v95
    v_mfma_f32_32x32x8_bf16 v[72:87], v[158:159], v[128:129], v[72:87]
    v_cvt_pk_bf16_f32 v106, v92, v93
    v_cvt_pk_bf16_f32 v107, v94, v95
    v_exp_f32 v96, v96
    v_exp_f32 v97, v97
    v_exp_f32 v98, v98
    v_exp_f32 v99, v99
    v_mfma_f32_32x32x16_bf16 v[56:71], v[176:179], v[104:107], v[56:71]
    v_cvt_pk_bf16_f32 v108, v96, v97
    v_cvt_pk_bf16_f32 v109, v98, v99
    v_exp_f32 v100, v100
    v_exp_f32 v101, v101
    v_exp_f32 v102, v102
    v_exp_f32 v103, v103
    v_cvt_pk_bf16_f32 v110, v100, v101
    v_cvt_pk_bf16_f32 v111, v102, v103
    v_mfma_f32_32x32x16_bf16 v[88:103], v[148:151], v[116:119], 0
    v_exp_f32 v72, v72
    v_exp_f32 v73, v73
    v_exp_f32 v74, v74
    v_exp_f32 v75, v75
    v_mfma_f32_32x32x16_bf16 v[56:71], v[180:183], v[108:111], v[56:71]
    buffer_load_dwordx4 v[144:147], v192, s[8:11], s21 offen offset:1024
    v_cvt_pk_bf16_f32 v104, v72, v73
    v_cvt_pk_bf16_f32 v105, v74, v75
    v_exp_f32 v76, v76
    v_exp_f32 v77, v77
    v_exp_f32 v78, v78
    v_exp_f32 v79, v79
    v_mfma_f32_32x32x8_bf16 v[88:103], v[158:159], v[130:131], v[88:103]
    v_cvt_pk_bf16_f32 v106, v76, v77
    v_cvt_pk_bf16_f32 v107, v78, v79
    v_exp_f32 v80, v80
    v_exp_f32 v81, v81
    v_exp_f32 v82, v82
    v_exp_f32 v83, v83
    v_mfma_f32_32x32x16_bf16 v[8:23], v[184:187], v[104:107], v[8:23]
    v_cvt_pk_bf16_f32 v108, v80, v81
    v_cvt_pk_bf16_f32 v109, v82, v83
    v_exp_f32 v84, v84
    v_exp_f32 v85, v85
    v_exp_f32 v86, v86
    v_exp_f32 v87, v87
    v_cvt_pk_bf16_f32 v110, v84, v85
    v_cvt_pk_bf16_f32 v111, v86, v87
    v_mfma_f32_32x32x16_bf16 v[72:87], v[148:151], v[120:123], 0
    v_exp_f32 v88, v88
    v_exp_f32 v89, v89
    v_exp_f32 v90, v90
    v_exp_f32 v91, v91
    v_mfma_f32_32x32x16_bf16 v[8:23], v[188:191], v[108:111], v[8:23]
    buffer_load_dwordx2 v[156:157], v193, s[8:11], s21 offen offset:1024
    v_cvt_pk_bf16_f32 v104, v88, v89
    v_cvt_pk_bf16_f32 v105, v90, v91
    v_exp_f32 v92, v92
    v_exp_f32 v93, v93
    v_exp_f32 v94, v94
    v_exp_f32 v95, v95
    v_mfma_f32_32x32x8_bf16 v[72:87], v[158:159], v[132:133], v[72:87]
    v_cvt_pk_bf16_f32 v106, v92, v93
    v_cvt_pk_bf16_f32 v107, v94, v95
    v_exp_f32 v96, v96
    v_exp_f32 v97, v97
    v_exp_f32 v98, v98
    v_exp_f32 v99, v99
    v_mfma_f32_32x32x16_bf16 v[24:39], v[184:187], v[104:107], v[24:39]
    v_cvt_pk_bf16_f32 v108, v96, v97
    v_cvt_pk_bf16_f32 v109, v98, v99
    v_exp_f32 v100, v100
    v_exp_f32 v101, v101
    v_exp_f32 v102, v102
    v_exp_f32 v103, v103
    v_cvt_pk_bf16_f32 v110, v100, v101
    v_cvt_pk_bf16_f32 v111, v102, v103
    v_mfma_f32_32x32x16_bf16 v[88:103], v[148:151], v[124:127], 0
    v_exp_f32 v72, v72
    v_exp_f32 v73, v73
    v_exp_f32 v74, v74
    v_exp_f32 v75, v75
    v_mfma_f32_32x32x16_bf16 v[24:39], v[188:191], v[108:111], v[24:39]
    buffer_load_dwordx4 v[176:179], v202, s[8:11], s22 offen
    ds_read_b64_tr_b16 a[32:33], v224 offset:16384
    ds_read_b64_tr_b16 a[34:35], v224 offset:16896
    ds_read_b64_tr_b16 a[36:37], v225 offset:16384
    ds_read_b64_tr_b16 a[38:39], v225 offset:16896
    ds_read_b64_tr_b16 a[40:41], v226 offset:16384
    ds_read_b64_tr_b16 a[42:43], v226 offset:16896
    ds_read_b64_tr_b16 a[44:45], v227 offset:16384
    ds_read_b64_tr_b16 a[46:47], v227 offset:16896
    v_cvt_pk_bf16_f32 v104, v72, v73
    v_cvt_pk_bf16_f32 v105, v74, v75
    v_exp_f32 v76, v76
    v_exp_f32 v77, v77
    v_exp_f32 v78, v78
    v_exp_f32 v79, v79
    v_mfma_f32_32x32x8_bf16 v[88:103], v[158:159], v[134:135], v[88:103]
    v_cvt_pk_bf16_f32 v106, v76, v77
    v_cvt_pk_bf16_f32 v107, v78, v79
    v_exp_f32 v80, v80
    v_exp_f32 v81, v81
    v_exp_f32 v82, v82
    v_exp_f32 v83, v83
    v_mfma_f32_32x32x16_bf16 v[40:55], v[184:187], v[104:107], v[40:55]
    v_cvt_pk_bf16_f32 v108, v80, v81
    v_cvt_pk_bf16_f32 v109, v82, v83
    v_exp_f32 v84, v84
    v_exp_f32 v85, v85
    v_exp_f32 v86, v86
    v_exp_f32 v87, v87
    v_cvt_pk_bf16_f32 v110, v84, v85
    v_cvt_pk_bf16_f32 v111, v86, v87
    s_waitcnt vmcnt(7)
    v_mfma_f32_32x32x16_bf16 v[72:87], v[136:139], v[112:115], 0
    v_exp_f32 v88, v88
    v_exp_f32 v89, v89
    v_exp_f32 v90, v90
    v_exp_f32 v91, v91
    v_mfma_f32_32x32x16_bf16 v[40:55], v[188:191], v[108:111], v[40:55]
    buffer_load_dwordx4 v[180:183], v203, s[8:11], s22 offen
    v_cvt_pk_bf16_f32 v104, v88, v89
    v_cvt_pk_bf16_f32 v105, v90, v91
    v_exp_f32 v92, v92
    v_exp_f32 v93, v93
    v_exp_f32 v94, v94
    v_exp_f32 v95, v95
    v_mfma_f32_32x32x8_bf16 v[72:87], v[152:153], v[128:129], v[72:87]
    v_cvt_pk_bf16_f32 v106, v92, v93
    v_cvt_pk_bf16_f32 v107, v94, v95
    v_exp_f32 v96, v96
    v_exp_f32 v97, v97
    v_exp_f32 v98, v98
    v_exp_f32 v99, v99
    v_mfma_f32_32x32x16_bf16 v[56:71], v[184:187], v[104:107], v[56:71]
    s_waitcnt lgkmcnt(0)
    s_add_u32 m0, s15, 16384
    s_nop 0
    buffer_load_dwordx4 v220, s[44:47], s90 offen offset:0 lds
    v_cvt_pk_bf16_f32 v108, v96, v97
    v_cvt_pk_bf16_f32 v109, v98, v99
    v_exp_f32 v100, v100
    v_exp_f32 v101, v101
    v_exp_f32 v102, v102
    v_exp_f32 v103, v103
    v_cvt_pk_bf16_f32 v110, v100, v101
    v_cvt_pk_bf16_f32 v111, v102, v103
    v_mfma_f32_32x32x16_bf16 v[88:103], v[136:139], v[116:119], 0
    v_exp_f32 v72, v72
    v_exp_f32 v73, v73
    v_exp_f32 v74, v74
    v_exp_f32 v75, v75
    v_mfma_f32_32x32x16_bf16 v[56:71], v[188:191], v[108:111], v[56:71]
    buffer_load_dwordx4 v[148:151], v192, s[8:11], s21 offen offset:1536
    v_cvt_pk_bf16_f32 v104, v72, v73
    v_cvt_pk_bf16_f32 v105, v74, v75
    v_exp_f32 v76, v76
    v_exp_f32 v77, v77
    v_exp_f32 v78, v78
    v_exp_f32 v79, v79
    v_mfma_f32_32x32x8_bf16 v[88:103], v[152:153], v[130:131], v[88:103]
    v_cvt_pk_bf16_f32 v106, v76, v77
    v_cvt_pk_bf16_f32 v107, v78, v79
    v_exp_f32 v80, v80
    v_exp_f32 v81, v81
    v_exp_f32 v82, v82
    v_exp_f32 v83, v83
    v_mfma_f32_32x32x16_bf16 v[8:23], v[160:163], v[104:107], v[8:23]
    buffer_load_dwordx4 v221, s[44:47], s90 offen offset:1024 lds
    v_cvt_pk_bf16_f32 v108, v80, v81
    v_cvt_pk_bf16_f32 v109, v82, v83
    v_exp_f32 v84, v84
    v_exp_f32 v85, v85
    v_exp_f32 v86, v86
    v_exp_f32 v87, v87
    v_cvt_pk_bf16_f32 v110, v84, v85
    v_cvt_pk_bf16_f32 v111, v86, v87
    v_mfma_f32_32x32x16_bf16 v[72:87], v[136:139], v[120:123], 0
    v_exp_f32 v88, v88
    v_exp_f32 v89, v89
    v_exp_f32 v90, v90
    v_exp_f32 v91, v91
    v_mfma_f32_32x32x16_bf16 v[8:23], v[164:167], v[108:111], v[8:23]
    buffer_load_dwordx2 v[158:159], v193, s[8:11], s21 offen offset:1536
    v_cvt_pk_bf16_f32 v104, v88, v89
    v_cvt_pk_bf16_f32 v105, v90, v91
    v_exp_f32 v92, v92
    v_exp_f32 v93, v93
    v_exp_f32 v94, v94
    v_exp_f32 v95, v95
    v_mfma_f32_32x32x8_bf16 v[72:87], v[152:153], v[132:133], v[72:87]
    v_cvt_pk_bf16_f32 v106, v92, v93
    v_cvt_pk_bf16_f32 v107, v94, v95
    v_exp_f32 v96, v96
    v_exp_f32 v97, v97
    v_exp_f32 v98, v98
    v_exp_f32 v99, v99
    v_mfma_f32_32x32x16_bf16 v[24:39], v[160:163], v[104:107], v[24:39]
    buffer_load_dwordx4 v222, s[44:47], s90 offen offset:2048 lds
    v_cvt_pk_bf16_f32 v108, v96, v97
    v_cvt_pk_bf16_f32 v109, v98, v99
    v_exp_f32 v100, v100
    v_exp_f32 v101, v101
    v_exp_f32 v102, v102
    v_exp_f32 v103, v103
    v_cvt_pk_bf16_f32 v110, v100, v101
    v_cvt_pk_bf16_f32 v111, v102, v103
    v_mfma_f32_32x32x16_bf16 v[88:103], v[136:139], v[124:127], 0
    v_exp_f32 v72, v72
    v_exp_f32 v73, v73
    v_exp_f32 v74, v74
    v_exp_f32 v75, v75
    v_mfma_f32_32x32x16_bf16 v[24:39], v[164:167], v[108:111], v[24:39]
    buffer_load_dwordx4 v[184:187], v204, s[8:11], s22 offen
    v_cvt_pk_bf16_f32 v104, v72, v73
    v_cvt_pk_bf16_f32 v105, v74, v75
    v_exp_f32 v76, v76
    v_exp_f32 v77, v77
    v_exp_f32 v78, v78
    v_exp_f32 v79, v79
    v_mfma_f32_32x32x8_bf16 v[88:103], v[152:153], v[134:135], v[88:103]
    v_cvt_pk_bf16_f32 v106, v76, v77
    v_cvt_pk_bf16_f32 v107, v78, v79
    v_exp_f32 v80, v80
    v_exp_f32 v81, v81
    v_exp_f32 v82, v82
    v_exp_f32 v83, v83
    v_mfma_f32_32x32x16_bf16 v[40:55], v[160:163], v[104:107], v[40:55]
    buffer_load_dwordx4 v223, s[44:47], s90 offen offset:3072 lds
    v_cvt_pk_bf16_f32 v108, v80, v81
    v_cvt_pk_bf16_f32 v109, v82, v83
    v_exp_f32 v84, v84
    v_exp_f32 v85, v85
    v_exp_f32 v86, v86
    v_exp_f32 v87, v87
    v_cvt_pk_bf16_f32 v110, v84, v85
    v_cvt_pk_bf16_f32 v111, v86, v87
    s_waitcnt vmcnt(11)
    v_mfma_f32_32x32x16_bf16 v[72:87], v[140:143], v[112:115], 0
    v_exp_f32 v88, v88
    v_exp_f32 v89, v89
    v_exp_f32 v90, v90
    v_exp_f32 v91, v91
    v_mfma_f32_32x32x16_bf16 v[40:55], v[164:167], v[108:111], v[40:55]
    buffer_load_dwordx4 v[188:191], v205, s[8:11], s22 offen
    v_cvt_pk_bf16_f32 v104, v88, v89
    v_cvt_pk_bf16_f32 v105, v90, v91
    v_exp_f32 v92, v92
    v_exp_f32 v93, v93
    v_exp_f32 v94, v94
    v_exp_f32 v95, v95
    v_mfma_f32_32x32x8_bf16 v[72:87], v[154:155], v[128:129], v[72:87]
    v_cvt_pk_bf16_f32 v106, v92, v93
    v_cvt_pk_bf16_f32 v107, v94, v95
    v_exp_f32 v96, v96
    v_exp_f32 v97, v97
    v_exp_f32 v98, v98
    v_exp_f32 v99, v99
    v_mfma_f32_32x32x16_bf16 v[56:71], v[160:163], v[104:107], v[56:71]
    s_mov_b32 s23, 4718592
    buffer_load_dword v7, v196, s[80:83], s23 offen
    v_cvt_pk_bf16_f32 v108, v96, v97
    v_cvt_pk_bf16_f32 v109, v98, v99
    v_exp_f32 v100, v100
    v_exp_f32 v101, v101
    v_exp_f32 v102, v102
    v_exp_f32 v103, v103
    v_cvt_pk_bf16_f32 v110, v100, v101
    v_cvt_pk_bf16_f32 v111, v102, v103
    v_mfma_f32_32x32x16_bf16 v[88:103], v[140:143], v[116:119], 0
    v_exp_f32 v72, v72
    v_exp_f32 v73, v73
    v_exp_f32 v74, v74
    v_exp_f32 v75, v75
    v_mfma_f32_32x32x16_bf16 v[56:71], v[164:167], v[108:111], v[56:71]
    v_cvt_pk_bf16_f32 v104, v72, v73
    v_cvt_pk_bf16_f32 v105, v74, v75
    v_exp_f32 v76, v76
    v_exp_f32 v77, v77
    v_exp_f32 v78, v78
    v_exp_f32 v79, v79
    v_mfma_f32_32x32x8_bf16 v[88:103], v[154:155], v[130:131], v[88:103]
    v_cvt_pk_bf16_f32 v106, v76, v77
    v_cvt_pk_bf16_f32 v107, v78, v79
    v_exp_f32 v80, v80
    v_exp_f32 v81, v81
    v_exp_f32 v82, v82
    v_exp_f32 v83, v83
    v_mfma_f32_32x32x16_bf16 v[8:23], v[168:171], v[104:107], v[8:23]
    v_cvt_pk_bf16_f32 v108, v80, v81
    v_cvt_pk_bf16_f32 v109, v82, v83
    v_exp_f32 v84, v84
    v_exp_f32 v85, v85
    v_exp_f32 v86, v86
    v_exp_f32 v87, v87
    v_cvt_pk_bf16_f32 v110, v84, v85
    v_cvt_pk_bf16_f32 v111, v86, v87
    v_mfma_f32_32x32x16_bf16 v[72:87], v[140:143], v[120:123], 0
    v_exp_f32 v88, v88
    v_exp_f32 v89, v89
    v_exp_f32 v90, v90
    v_exp_f32 v91, v91
    v_mfma_f32_32x32x16_bf16 v[8:23], v[172:175], v[108:111], v[8:23]
    v_cvt_pk_bf16_f32 v104, v88, v89
    v_cvt_pk_bf16_f32 v105, v90, v91
    v_exp_f32 v92, v92
    v_exp_f32 v93, v93
    v_exp_f32 v94, v94
    v_exp_f32 v95, v95
    v_mfma_f32_32x32x8_bf16 v[72:87], v[154:155], v[132:133], v[72:87]
    v_cvt_pk_bf16_f32 v106, v92, v93
    v_cvt_pk_bf16_f32 v107, v94, v95
    v_exp_f32 v96, v96
    v_exp_f32 v97, v97
    v_exp_f32 v98, v98
    v_exp_f32 v99, v99
    v_mfma_f32_32x32x16_bf16 v[24:39], v[168:171], v[104:107], v[24:39]
    v_cvt_pk_bf16_f32 v108, v96, v97
    v_cvt_pk_bf16_f32 v109, v98, v99
    v_exp_f32 v100, v100
    v_exp_f32 v101, v101
    v_exp_f32 v102, v102
    v_exp_f32 v103, v103
    v_cvt_pk_bf16_f32 v110, v100, v101
    v_cvt_pk_bf16_f32 v111, v102, v103
    v_mfma_f32_32x32x16_bf16 v[88:103], v[140:143], v[124:127], 0
    v_exp_f32 v72, v72
    v_exp_f32 v73, v73
    v_exp_f32 v74, v74
    v_exp_f32 v75, v75
    v_mfma_f32_32x32x16_bf16 v[24:39], v[172:175], v[108:111], v[24:39]
    v_cvt_pk_bf16_f32 v104, v72, v73
    v_cvt_pk_bf16_f32 v105, v74, v75
    v_exp_f32 v76, v76
    v_exp_f32 v77, v77
    v_exp_f32 v78, v78
    v_exp_f32 v79, v79
    v_mfma_f32_32x32x8_bf16 v[88:103], v[154:155], v[134:135], v[88:103]
    v_cvt_pk_bf16_f32 v106, v76, v77
    v_cvt_pk_bf16_f32 v107, v78, v79
    v_exp_f32 v80, v80
    v_exp_f32 v81, v81
    v_exp_f32 v82, v82
    v_exp_f32 v83, v83
    v_mfma_f32_32x32x16_bf16 v[40:55], v[168:171], v[104:107], v[40:55]
    v_cvt_pk_bf16_f32 v108, v80, v81
    v_cvt_pk_bf16_f32 v109, v82, v83
    v_exp_f32 v84, v84
    v_exp_f32 v85, v85
    v_exp_f32 v86, v86
    v_exp_f32 v87, v87
    v_cvt_pk_bf16_f32 v110, v84, v85
    v_cvt_pk_bf16_f32 v111, v86, v87
    s_waitcnt vmcnt(9)
    v_mfma_f32_32x32x16_bf16 v[72:87], v[144:147], v[112:115], 0
    v_exp_f32 v88, v88
    v_exp_f32 v89, v89
    v_exp_f32 v90, v90
    v_exp_f32 v91, v91
    v_mfma_f32_32x32x16_bf16 v[40:55], v[172:175], v[108:111], v[40:55]
    s_waitcnt vmcnt(2)
    ds_read_b64_tr_b16 a[48:49], v224 offset:16384
    ds_read_b64_tr_b16 a[50:51], v224 offset:16896
    ds_read_b64_tr_b16 a[52:53], v225 offset:16384
    ds_read_b64_tr_b16 a[54:55], v225 offset:16896
    ds_read_b64_tr_b16 a[56:57], v226 offset:16384
    ds_read_b64_tr_b16 a[58:59], v226 offset:16896
    ds_read_b64_tr_b16 a[60:61], v227 offset:16384
    ds_read_b64_tr_b16 a[62:63], v227 offset:16896
    v_cvt_pk_bf16_f32 v104, v88, v89
    v_cvt_pk_bf16_f32 v105, v90, v91
    v_exp_f32 v92, v92
    v_exp_f32 v93, v93
    v_exp_f32 v94, v94
    v_exp_f32 v95, v95
    v_mfma_f32_32x32x8_bf16 v[72:87], v[156:157], v[128:129], v[72:87]
    v_cvt_pk_bf16_f32 v106, v92, v93
    v_cvt_pk_bf16_f32 v107, v94, v95
    v_exp_f32 v96, v96
    v_exp_f32 v97, v97
    v_exp_f32 v98, v98
    v_exp_f32 v99, v99
    v_mfma_f32_32x32x16_bf16 v[56:71], v[168:171], v[104:107], v[56:71]
    v_cvt_pk_bf16_f32 v108, v96, v97
    v_cvt_pk_bf16_f32 v109, v98, v99
    v_exp_f32 v100, v100
    v_exp_f32 v101, v101
    v_exp_f32 v102, v102
    v_exp_f32 v103, v103
    v_cvt_pk_bf16_f32 v110, v100, v101
    v_cvt_pk_bf16_f32 v111, v102, v103
    v_mfma_f32_32x32x16_bf16 v[88:103], v[144:147], v[116:119], 0
    v_exp_f32 v72, v72
    v_exp_f32 v73, v73
    v_exp_f32 v74, v74
    v_exp_f32 v75, v75
    v_mfma_f32_32x32x16_bf16 v[56:71], v[172:175], v[108:111], v[56:71]
    v_cvt_pk_bf16_f32 v104, v72, v73
    v_cvt_pk_bf16_f32 v105, v74, v75
    v_exp_f32 v76, v76
    v_exp_f32 v77, v77
    v_exp_f32 v78, v78
    v_exp_f32 v79, v79
    v_mfma_f32_32x32x8_bf16 v[88:103], v[156:157], v[130:131], v[88:103]
    v_cvt_pk_bf16_f32 v106, v76, v77
    v_cvt_pk_bf16_f32 v107, v78, v79
    v_exp_f32 v80, v80
    v_exp_f32 v81, v81
    v_exp_f32 v82, v82
    v_exp_f32 v83, v83
    v_mfma_f32_32x32x16_bf16 v[8:23], v[176:179], v[104:107], v[8:23]
    s_waitcnt lgkmcnt(0)
    s_add_u32 m0, s15, 16384
    s_add_u32 s24, s84, 1572864
    buffer_load_dwordx4 v220, s[44:47], s24 offen offset:0 lds
    v_cvt_pk_bf16_f32 v108, v80, v81
    v_cvt_pk_bf16_f32 v109, v82, v83
    v_exp_f32 v84, v84
    v_exp_f32 v85, v85
    v_exp_f32 v86, v86
    v_exp_f32 v87, v87
    v_cvt_pk_bf16_f32 v110, v84, v85
    v_cvt_pk_bf16_f32 v111, v86, v87
    v_mfma_f32_32x32x16_bf16 v[72:87], v[144:147], v[120:123], 0
    v_exp_f32 v88, v88
    v_exp_f32 v89, v89
    v_exp_f32 v90, v90
    v_exp_f32 v91, v91
    v_mfma_f32_32x32x16_bf16 v[8:23], v[180:183], v[108:111], v[8:23]
    v_cvt_pk_bf16_f32 v104, v88, v89
    v_cvt_pk_bf16_f32 v105, v90, v91
    v_exp_f32 v92, v92
    v_exp_f32 v93, v93
    v_exp_f32 v94, v94
    v_exp_f32 v95, v95
    v_mfma_f32_32x32x8_bf16 v[72:87], v[156:157], v[132:133], v[72:87]
    v_cvt_pk_bf16_f32 v106, v92, v93
    v_cvt_pk_bf16_f32 v107, v94, v95
    v_exp_f32 v96, v96
    v_exp_f32 v97, v97
    v_exp_f32 v98, v98
    v_exp_f32 v99, v99
    v_mfma_f32_32x32x16_bf16 v[24:39], v[176:179], v[104:107], v[24:39]
    buffer_load_dwordx4 v221, s[44:47], s24 offen offset:1024 lds
    v_cvt_pk_bf16_f32 v108, v96, v97
    v_cvt_pk_bf16_f32 v109, v98, v99
    v_exp_f32 v100, v100
    v_exp_f32 v101, v101
    v_exp_f32 v102, v102
    v_exp_f32 v103, v103
    v_cvt_pk_bf16_f32 v110, v100, v101
    v_cvt_pk_bf16_f32 v111, v102, v103
    v_mfma_f32_32x32x16_bf16 v[88:103], v[144:147], v[124:127], 0
    v_exp_f32 v72, v72
    v_exp_f32 v73, v73
    v_exp_f32 v74, v74
    v_exp_f32 v75, v75
    v_mfma_f32_32x32x16_bf16 v[24:39], v[180:183], v[108:111], v[24:39]
    v_cvt_pk_bf16_f32 v104, v72, v73
    v_cvt_pk_bf16_f32 v105, v74, v75
    v_exp_f32 v76, v76
    v_exp_f32 v77, v77
    v_exp_f32 v78, v78
    v_exp_f32 v79, v79
    v_mfma_f32_32x32x8_bf16 v[88:103], v[156:157], v[134:135], v[88:103]
    v_cvt_pk_bf16_f32 v106, v76, v77
    v_cvt_pk_bf16_f32 v107, v78, v79
    v_exp_f32 v80, v80
    v_exp_f32 v81, v81
    v_exp_f32 v82, v82
    v_exp_f32 v83, v83
    v_mfma_f32_32x32x16_bf16 v[40:55], v[176:179], v[104:107], v[40:55]
    buffer_load_dwordx4 v222, s[44:47], s24 offen offset:2048 lds
    v_cvt_pk_bf16_f32 v108, v80, v81
    v_cvt_pk_bf16_f32 v109, v82, v83
    v_exp_f32 v84, v84
    v_exp_f32 v85, v85
    v_exp_f32 v86, v86
    v_exp_f32 v87, v87
    v_cvt_pk_bf16_f32 v110, v84, v85
    v_cvt_pk_bf16_f32 v111, v86, v87
    s_waitcnt vmcnt(4)
    v_mfma_f32_32x32x16_bf16 v[72:87], v[148:151], v[112:115], 0
    v_exp_f32 v88, v88
    v_exp_f32 v89, v89
    v_exp_f32 v90, v90
    v_exp_f32 v91, v91
    v_mfma_f32_32x32x16_bf16 v[40:55], v[180:183], v[108:111], v[40:55]
    v_cvt_pk_bf16_f32 v104, v88, v89
    v_cvt_pk_bf16_f32 v105, v90, v91
    v_exp_f32 v92, v92
    v_exp_f32 v93, v93
    v_exp_f32 v94, v94
    v_exp_f32 v95, v95
    v_mfma_f32_32x32x8_bf16 v[72:87], v[158:159], v[128:129], v[72:87]
    v_cvt_pk_bf16_f32 v106, v92, v93
    v_cvt_pk_bf16_f32 v107, v94, v95
    v_exp_f32 v96, v96
    v_exp_f32 v97, v97
    v_exp_f32 v98, v98
    v_exp_f32 v99, v99
    v_mfma_f32_32x32x16_bf16 v[56:71], v[176:179], v[104:107], v[56:71]
    buffer_load_dwordx4 v223, s[44:47], s24 offen offset:3072 lds
    v_cvt_pk_bf16_f32 v108, v96, v97
    v_cvt_pk_bf16_f32 v109, v98, v99
    v_exp_f32 v100, v100
    v_exp_f32 v101, v101
    v_exp_f32 v102, v102
    v_exp_f32 v103, v103
    v_cvt_pk_bf16_f32 v110, v100, v101
    v_cvt_pk_bf16_f32 v111, v102, v103
    v_mfma_f32_32x32x16_bf16 v[88:103], v[148:151], v[116:119], 0
    v_exp_f32 v72, v72
    v_exp_f32 v73, v73
    v_exp_f32 v74, v74
    v_exp_f32 v75, v75
    v_mfma_f32_32x32x16_bf16 v[56:71], v[180:183], v[108:111], v[56:71]
    v_cvt_pk_bf16_f32 v104, v72, v73
    v_cvt_pk_bf16_f32 v105, v74, v75
    v_exp_f32 v76, v76
    v_exp_f32 v77, v77
    v_exp_f32 v78, v78
    v_exp_f32 v79, v79
    v_mfma_f32_32x32x8_bf16 v[88:103], v[158:159], v[130:131], v[88:103]
    v_cvt_pk_bf16_f32 v106, v76, v77
    v_cvt_pk_bf16_f32 v107, v78, v79
    v_exp_f32 v80, v80
    v_exp_f32 v81, v81
    v_exp_f32 v82, v82
    v_exp_f32 v83, v83
    v_mfma_f32_32x32x16_bf16 v[8:23], v[184:187], v[104:107], v[8:23]
    v_cvt_pk_bf16_f32 v108, v80, v81
    v_cvt_pk_bf16_f32 v109, v82, v83
    v_exp_f32 v84, v84
    v_exp_f32 v85, v85
    v_exp_f32 v86, v86
    v_exp_f32 v87, v87
    v_cvt_pk_bf16_f32 v110, v84, v85
    v_cvt_pk_bf16_f32 v111, v86, v87
    v_mfma_f32_32x32x16_bf16 v[72:87], v[148:151], v[120:123], 0
    v_exp_f32 v88, v88
    v_exp_f32 v89, v89
    v_exp_f32 v90, v90
    v_exp_f32 v91, v91
    v_mfma_f32_32x32x16_bf16 v[8:23], v[188:191], v[108:111], v[8:23]
    v_cvt_pk_bf16_f32 v104, v88, v89
    v_cvt_pk_bf16_f32 v105, v90, v91
    v_exp_f32 v92, v92
    v_exp_f32 v93, v93
    v_exp_f32 v94, v94
    v_exp_f32 v95, v95
    v_mfma_f32_32x32x8_bf16 v[72:87], v[158:159], v[132:133], v[72:87]
    v_cvt_pk_bf16_f32 v106, v92, v93
    v_cvt_pk_bf16_f32 v107, v94, v95
    v_exp_f32 v96, v96
    v_exp_f32 v97, v97
    v_exp_f32 v98, v98
    v_exp_f32 v99, v99
    v_mfma_f32_32x32x16_bf16 v[24:39], v[184:187], v[104:107], v[24:39]
    v_cvt_pk_bf16_f32 v108, v96, v97
    v_cvt_pk_bf16_f32 v109, v98, v99
    v_exp_f32 v100, v100
    v_exp_f32 v101, v101
    v_exp_f32 v102, v102
    v_exp_f32 v103, v103
    v_cvt_pk_bf16_f32 v110, v100, v101
    v_cvt_pk_bf16_f32 v111, v102, v103
    v_mfma_f32_32x32x16_bf16 v[88:103], v[148:151], v[124:127], 0
    v_exp_f32 v72, v72
    v_exp_f32 v73, v73
    v_exp_f32 v74, v74
    v_exp_f32 v75, v75
    v_mfma_f32_32x32x16_bf16 v[24:39], v[188:191], v[108:111], v[24:39]
    v_cvt_pk_bf16_f32 v104, v72, v73
    v_cvt_pk_bf16_f32 v105, v74, v75
    v_exp_f32 v76, v76
    v_exp_f32 v77, v77
    v_exp_f32 v78, v78
    v_exp_f32 v79, v79
    v_mfma_f32_32x32x8_bf16 v[88:103], v[158:159], v[134:135], v[88:103]
    v_cvt_pk_bf16_f32 v106, v76, v77
    v_cvt_pk_bf16_f32 v107, v78, v79
    v_exp_f32 v80, v80
    v_exp_f32 v81, v81
    v_exp_f32 v82, v82
    v_exp_f32 v83, v83
    v_mfma_f32_32x32x16_bf16 v[40:55], v[184:187], v[104:107], v[40:55]
    v_cvt_pk_bf16_f32 v108, v80, v81
    v_cvt_pk_bf16_f32 v109, v82, v83
    v_exp_f32 v84, v84
    v_exp_f32 v85, v85
    v_exp_f32 v86, v86
    v_exp_f32 v87, v87
    v_cvt_pk_bf16_f32 v110, v84, v85
    v_cvt_pk_bf16_f32 v111, v86, v87
    v_exp_f32 v88, v88
    v_exp_f32 v89, v89
    v_exp_f32 v90, v90
    v_exp_f32 v91, v91
    v_mfma_f32_32x32x16_bf16 v[40:55], v[188:191], v[108:111], v[40:55]
    v_cvt_pk_bf16_f32 v104, v88, v89
    v_cvt_pk_bf16_f32 v105, v90, v91
    v_exp_f32 v92, v92
    v_exp_f32 v93, v93
    v_exp_f32 v94, v94
    v_exp_f32 v95, v95
    v_cvt_pk_bf16_f32 v106, v92, v93
    v_cvt_pk_bf16_f32 v107, v94, v95
    v_exp_f32 v96, v96
    v_exp_f32 v97, v97
    v_exp_f32 v98, v98
    v_exp_f32 v99, v99
    v_mfma_f32_32x32x16_bf16 v[56:71], v[184:187], v[104:107], v[56:71]
    v_cvt_pk_bf16_f32 v108, v96, v97
    v_cvt_pk_bf16_f32 v109, v98, v99
    v_exp_f32 v100, v100
    v_exp_f32 v101, v101
    v_exp_f32 v102, v102
    v_exp_f32 v103, v103
    v_cvt_pk_bf16_f32 v110, v100, v101
    v_cvt_pk_bf16_f32 v111, v102, v103
    s_xor_b32 s23, s14, 2
    s_waitcnt lgkmcnt(0)
    v_mfma_f32_32x32x16_bf16 v[56:71], v[188:191], v[108:111], v[56:71]
    s_lshl_b32 s23, s23, 12
    s_add_u32 s23, s23, 86016
    v_add_u32 v3, s23, v233
    ds_write_b128 v3, v[40:43] offset:32768
    ds_write_b128 v3, v[44:47] offset:33792
    ds_write_b128 v3, v[48:51] offset:34816
    v_add_u32 v6, s15, v233
    s_mov_b32 s23, 0x5f800000
    s_lshl_b32 s24, s14, 2
    s_add_u32 s24, s24, 154112
    v_mov_b32 v4, s24
    v_add_f32 v5, v16, v32
    v_add_f32 v5, v5, v48
    ds_write_b128 v3, v[56:59] offset:35840
    ds_write_b128 v3, v[60:63] offset:49152
    ds_write_b128 v3, v[64:67] offset:50176
    v_add_f32 v5, v5, v64
    v_cmp_nge_f32 vcc, s23, v5
    v_mov_b32 v3, 154112
    s_nop 0
    v_mov_b32 v5, vcc_hi
    ds_write_b32 v4, v5
    s_waitcnt lgkmcnt(0)
    s_barrier
    ds_read_b128 v[72:75], v3
    ds_read_b128 v[40:43], v6 offset:32768
    ds_read_b128 v[44:47], v6 offset:33792
    ds_read_b128 v[48:51], v6 offset:34816
    ds_read_b128 v[56:59], v6 offset:35840
    ds_read_b128 v[60:63], v6 offset:49152
    ds_read_b128 v[64:67], v6 offset:50176
    s_waitcnt lgkmcnt(6)
    v_or3_b32 v72, v72, v73, v74
    v_or_b32 v72, v72, v75
    s_nop 0
    v_readfirstlane_b32 s23, v72
    s_waitcnt lgkmcnt(3)
    v_pk_add_f32 v[16:17], v[16:17], v[48:49]
    v_pk_add_f32 v[8:9], v[8:9], v[40:41]
    v_pk_add_f32 v[10:11], v[10:11], v[42:43]
    v_pk_add_f32 v[12:13], v[12:13], v[44:45]
    v_pk_add_f32 v[14:15], v[14:15], v[46:47]
    v_pk_add_f32 v[18:19], v[18:19], v[50:51]
    s_andn2_b32 s23, s23, s25
    s_cbranch_scc1 L_rompt_kernel_redo
    s_lshl_b32 s24, s69, 7
    s_add_u32 s24, s24, 16853760
    s_cmp_eq_u32 s14, 0
    s_cselect_b32 s24, s24, 1073741824
    v_mul_u32_u24 v1, 1024, v0
    v_mov_b32 v2, 1
    s_mov_b64 exec, 15
    buffer_atomic_add v2, v1, s[8:11], s24 offen sc1
    s_mov_b64 exec, -1
    v_mov_b32 v76, v16
    v_mov_b32 v78, v16
    s_nop 1
    v_permlane32_swap_b32 v76, v78
    s_nop 0
    v_rcp_f32 v78, v78
    s_nop 0
    v_pk_mul_f32 v[8:9], v[8:9], v[78:79] op_sel_hi:[1,0]
    v_pk_mul_f32 v[10:11], v[10:11], v[78:79] op_sel_hi:[1,0]
    v_pk_mul_f32 v[12:13], v[12:13], v[78:79] op_sel_hi:[1,0]
    v_pk_mul_f32 v[14:15], v[14:15], v[78:79] op_sel_hi:[1,0]
    v_pk_mul_f32 v[16:17], v[16:17], v[78:79] op_sel_hi:[1,0]
    v_pk_mul_f32 v[18:19], v[18:19], v[78:79] op_sel_hi:[1,0]
    v_cvt_pk_bf16_f32 v88, v8, v9
    v_cvt_pk_bf16_f32 v89, v10, v11
    v_cvt_pk_bf16_f32 v90, v12, v13
    v_cvt_pk_bf16_f32 v91, v14, v15
    v_min_u32 v91, -2, v91
    buffer_store_dwordx4 v[88:91], v252, s[8:11], s59 offen offset:0 sc1
    v_cvt_pk_bf16_f32 v96, v16, v17
    v_cvt_pk_bf16_f32 v97, v18, v19
    v_min_u32 v97, -2, v97
    s_waitcnt lgkmcnt(0)
    v_pk_add_f32 v[32:33], v[32:33], v[64:65]
    v_pk_add_f32 v[24:25], v[24:25], v[56:57]
    v_pk_add_f32 v[26:27], v[26:27], v[58:59]
    v_pk_add_f32 v[28:29], v[28:29], v[60:61]
    v_pk_add_f32 v[30:31], v[30:31], v[62:63]
    v_pk_add_f32 v[34:35], v[34:35], v[66:67]
    v_mov_b32 v80, v32
    v_mov_b32 v82, v32
    s_nop 1
    v_permlane32_swap_b32 v80, v82
    s_nop 0
    v_rcp_f32 v82, v82
    s_nop 0
    v_pk_mul_f32 v[24:25], v[24:25], v[82:83] op_sel_hi:[1,0]
    v_pk_mul_f32 v[26:27], v[26:27], v[82:83] op_sel_hi:[1,0]
    v_pk_mul_f32 v[28:29], v[28:29], v[82:83] op_sel_hi:[1,0]
    v_pk_mul_f32 v[30:31], v[30:31], v[82:83] op_sel_hi:[1,0]
    v_pk_mul_f32 v[32:33], v[32:33], v[82:83] op_sel_hi:[1,0]
    v_pk_mul_f32 v[34:35], v[34:35], v[82:83] op_sel_hi:[1,0]
    v_cvt_pk_bf16_f32 v92, v24, v25
    v_cvt_pk_bf16_f32 v93, v26, v27
    v_cvt_pk_bf16_f32 v94, v28, v29
    v_cvt_pk_bf16_f32 v95, v30, v31
    v_min_u32 v95, -2, v95
    buffer_store_dwordx4 v[92:95], v252, s[8:11], s59 offen offset:512 sc1
    v_cvt_pk_bf16_f32 v98, v32, v33
    v_cvt_pk_bf16_f32 v99, v34, v35
    v_min_u32 v99, -2, v99
    s_mov_b32 exec_hi, 0
    buffer_store_dwordx4 v[96:99], v233, s[8:11], s60 offen sc1
    s_mov_b64 exec, -1
    s_and_b32 s71, s17, 3
    s_lshl_b32 s71, s71, 3
    s_add_u32 s71, s71, s16
    s_sub_u32 s22, s71, s71
    v_mul_u32_u24 v5, s22, v0
    v_add_lshl_u32 v5, v5, s71, 7
    s_mul_i32 s43, s16, 0
    s_add_u32 s43, s43, 16853760
    s_cmp_eq_u32 s14, 1
    s_cselect_b32 s43, s43, 1073741824
    v_mov_b32 v4, 0
    s_mov_b64 exec, 1
    buffer_atomic_add v4, v5, s[8:11], s43 offen sc0 sc1
    s_mov_b64 exec, -1
    s_waitcnt vmcnt(5)
    ds_read_b64_tr_b16 a[64:65], v224 offset:16384
    ds_read_b64_tr_b16 a[66:67], v224 offset:16896
    ds_read_b64_tr_b16 a[68:69], v225 offset:16384
    ds_read_b64_tr_b16 a[70:71], v225 offset:16896
    ds_read_b64_tr_b16 a[72:73], v226 offset:16384
    ds_read_b64_tr_b16 a[74:75], v226 offset:16896
    ds_read_b64_tr_b16 a[76:77], v227 offset:16384
    ds_read_b64_tr_b16 a[78:79], v227 offset:16896
    s_add_u32 m0, s15, 32768
    s_add_u32 s24, s85, 1572864
    buffer_load_dwordx4 v220, s[44:47], s24 offen offset:0 lds
    buffer_load_dwordx4 v221, s[44:47], s24 offen offset:1024 lds
    buffer_load_dwordx4 v222, s[44:47], s24 offen offset:2048 lds
    buffer_load_dwordx4 v223, s[44:47], s24 offen offset:3072 lds
    s_add_u32 m0, s15, 49152
    s_add_u32 s24, s86, 1572864
    buffer_load_dwordx4 v220, s[44:47], s24 offen offset:0 lds
    buffer_load_dwordx4 v221, s[44:47], s24 offen offset:1024 lds
    buffer_load_dwordx4 v222, s[44:47], s24 offen offset:2048 lds
    buffer_load_dwordx4 v223, s[44:47], s24 offen offset:3072 lds
    ds_read_b128 v[28:31], v233 offset:0
    ds_read_b128 v[32:35], v233 offset:1024
    ds_read_b128 v[36:39], v233 offset:2048
    ds_read_b128 v[40:43], v233 offset:3072
    ds_read_b128 v[44:47], v233 offset:4096
    ds_read_b128 v[48:51], v233 offset:5120
    ds_read_b128 v[52:55], v233 offset:6144
    ds_read_b128 v[56:59], v233 offset:7168
    ds_read_b128 v[60:63], v233 offset:8192
    ds_read_b128 v[64:67], v233 offset:9216
    s_cmp_eq_u32 s43, 1073741824
    s_cbranch_scc1 L_rompt_kernel_p0x
    s_mov_b32 s23, 0x200000
    s_mov_b64 exec, 1
    s_waitcnt vmcnt(8)
L_rompt_kernel_p0:
    v_cmp_gt_u32 vcc, 32, v4
    s_cbranch_vccz L_rompt_kernel_p0y
    s_sub_u32 s23, s23, 1
    s_cbranch_scc1 L_rompt_kernel_p0y
    v_mov_b32 v4, 0
    buffer_atomic_add v4, v5, s[8:11], s43 offen sc0 sc1
    s_waitcnt vmcnt(0)
    s_branch L_rompt_kernel_p0
L_rompt_kernel_p0y:
    s_mov_b64 exec, -1
L_rompt_kernel_p0x:
    s_barrier
    s_mov_b32 s23, 0
    buffer_load_dwordx4 v[88:91], v236, s[8:11], s23 offen sc1
    s_mov_b32 s23, 134144
    buffer_load_dwordx4 v[92:95], v236, s[8:11], s23 offen sc1
    s_mov_b32 s23, 268288
    buffer_load_dwordx4 v[96:99], v236, s[8:11], s23 offen sc1
    s_mov_b32 s23, 402432
    buffer_load_dwordx4 v[100:103], v236, s[8:11], s23 offen sc1
    s_mov_b32 s23, 536576
    buffer_load_dwordx4 v[104:107], v236, s[8:11], s23 offen sc1
    s_mov_b32 s23, 670720
    buffer_load_dwordx4 v[108:111], v236, s[8:11], s23 offen sc1
    s_mov_b32 s23, 804864
    buffer_load_dwordx4 v[112:115], v236, s[8:11], s23 offen sc1
    s_mov_b32 s23, 939008
    buffer_load_dwordx4 v[116:119], v236, s[8:11], s23 offen sc1
    s_waitcnt vmcnt(12)
    ds_read_b64_tr_b16 a[80:81], v224 offset:32768
    ds_read_b64_tr_b16 a[82:83], v224 offset:33280
    ds_read_b64_tr_b16 a[84:85], v225 offset:32768
    ds_read_b64_tr_b16 a[86:87], v225 offset:33280
    ds_read_b64_tr_b16 a[88:89], v226 offset:32768
    ds_read_b64_tr_b16 a[90:91], v226 offset:33280
    ds_read_b64_tr_b16 a[92:93], v227 offset:32768
    ds_read_b64_tr_b16 a[94:95], v227 offset:33280
    s_waitcnt vmcnt(8)
    ds_read_b64_tr_b16 a[96:97], v224 offset:49152
    ds_read_b64_tr_b16 a[98:99], v224 offset:49664
    ds_read_b64_tr_b16 a[100:101], v225 offset:49152
    ds_read_b64_tr_b16 a[102:103], v225 offset:49664
    ds_read_b64_tr_b16 a[104:105], v226 offset:49152
    ds_read_b64_tr_b16 a[106:107], v226 offset:49664
    ds_read_b64_tr_b16 a[108:109], v227 offset:49152
    ds_read_b64_tr_b16 a[110:111], v227 offset:49664
    s_waitcnt vmcnt(7)
    v_cmp_eq_u32 vcc, -1, v91
    s_cbranch_vccnz L_rompt_kernel_c0
L_rompt_kernel_c0r:
    s_waitcnt lgkmcnt(0)
    s_waitcnt lgkmcnt(5)
    v_mfma_f32_16x16x32_bf16 v[8:11], v[28:31], v[88:91], 0
    ds_read_b128 v[68:71], v233 offset:10240
    ds_read_b128 v[72:75], v233 offset:11264
    v_mfma_f32_16x16x32_bf16 v[12:15], v[32:35], v[88:91], 0
    ds_read_b128 v[76:79], v233 offset:12288
    ds_read_b128 v[80:83], v233 offset:13312
    s_waitcnt vmcnt(6)
    v_cmp_eq_u32 vcc, -1, v95
    v_mfma_f32_16x16x32_bf16 v[16:19], v[36:39], v[88:91], 0
    s_cbranch_vccnz L_rompt_kernel_c1
L_rompt_kernel_c1r:
    ds_read_b128 v[84:87], v233 offset:14336
    v_mfma_f32_16x16x32_bf16 v[20:23], v[40:43], v[88:91], 0
    s_mov_b32 s23, 1073152
    v_mfma_f32_16x16x32_bf16 v[24:27], v[44:47], v[88:91], 0
    buffer_load_dwordx4 v[120:123], v236, s[8:11], s23 offen sc1
    s_waitcnt lgkmcnt(5)
    v_mfma_f32_16x16x32_bf16 v[8:11], v[48:51], v[92:95], v[8:11]
    ds_read_b128 v[28:31], v233 offset:15360
    ds_read_b128 v[32:35], v233 offset:16384
    v_mfma_f32_16x16x32_bf16 v[12:15], v[52:55], v[92:95], v[12:15]
    ds_read_b128 v[36:39], v233 offset:17408
    ds_read_b128 v[40:43], v233 offset:18432
    s_waitcnt vmcnt(6)
    v_cmp_eq_u32 vcc, -1, v99
    v_mfma_f32_16x16x32_bf16 v[16:19], v[56:59], v[92:95], v[16:19]
    s_cbranch_vccnz L_rompt_kernel_c2
L_rompt_kernel_c2r:
    ds_read_b128 v[44:47], v233 offset:19456
    v_mfma_f32_16x16x32_bf16 v[20:23], v[60:63], v[92:95], v[20:23]
    s_mov_b32 s23, 1207296
    v_mfma_f32_16x16x32_bf16 v[24:27], v[64:67], v[92:95], v[24:27]
    buffer_load_dwordx4 v[124:127], v236, s[8:11], s23 offen sc1
    s_waitcnt lgkmcnt(5)
    v_mfma_f32_16x16x32_bf16 v[8:11], v[68:71], v[96:99], v[8:11]
    ds_read_b128 v[48:51], v233 offset:20480
    ds_read_b128 v[52:55], v233 offset:21504
    v_mfma_f32_16x16x32_bf16 v[12:15], v[72:75], v[96:99], v[12:15]
    ds_read_b128 v[56:59], v233 offset:22528
    ds_read_b128 v[60:63], v233 offset:23552
    s_waitcnt vmcnt(6)
    v_cmp_eq_u32 vcc, -1, v103
    v_mfma_f32_16x16x32_bf16 v[16:19], v[76:79], v[96:99], v[16:19]
    s_cbranch_vccnz L_rompt_kernel_c3
L_rompt_kernel_c3r:
    ds_read_b128 v[64:67], v233 offset:24576
    v_mfma_f32_16x16x32_bf16 v[20:23], v[80:83], v[96:99], v[20:23]
    s_mov_b32 s23, 1341440
    v_mfma_f32_16x16x32_bf16 v[24:27], v[84:87], v[96:99], v[24:27]
    buffer_load_dwordx4 v[128:131], v236, s[8:11], s23 offen sc1
    s_waitcnt lgkmcnt(5)
    v_mfma_f32_16x16x32_bf16 v[8:11], v[28:31], v[100:103], v[8:11]
    ds_read_b128 v[68:71], v233 offset:25600
    ds_read_b128 v[72:75], v233 offset:26624
    v_mfma_f32_16x16x32_bf16 v[12:15], v[32:35], v[100:103], v[12:15]
    ds_read_b128 v[76:79], v233 offset:27648
    ds_read_b128 v[80:83], v233 offset:28672
    s_waitcnt vmcnt(6)
    v_cmp_eq_u32 vcc, -1, v107
    v_mfma_f32_16x16x32_bf16 v[16:19], v[36:39], v[100:103], v[16:19]
    s_cbranch_vccnz L_rompt_kernel_c4
L_rompt_kernel_c4r:
    ds_read_b128 v[84:87], v233 offset:29696
    v_mfma_f32_16x16x32_bf16 v[20:23], v[40:43], v[100:103], v[20:23]
    s_mov_b32 s23, 1475584
    v_mfma_f32_16x16x32_bf16 v[24:27], v[44:47], v[100:103], v[24:27]
    buffer_load_dwordx4 v[132:135], v236, s[8:11], s23 offen sc1
    s_waitcnt lgkmcnt(5)
    v_mfma_f32_16x16x32_bf16 v[8:11], v[48:51], v[104:107], v[8:11]
    ds_read_b128 v[28:31], v233 offset:30720
    ds_read_b128 v[32:35], v233 offset:31744
    v_mfma_f32_16x16x32_bf16 v[12:15], v[52:55], v[104:107], v[12:15]
    ds_read_b128 v[36:39], v233 offset:32768
    ds_read_b128 v[40:43], v233 offset:33792
    s_waitcnt vmcnt(6)
    v_cmp_eq_u32 vcc, -1, v111
    v_mfma_f32_16x16x32_bf16 v[16:19], v[56:59], v[104:107], v[16:19]
    s_cbranch_vccnz L_rompt_kernel_c5
L_rompt_kernel_c5r:
    ds_read_b128 v[44:47], v233 offset:34816
    v_mfma_f32_16x16x32_bf16 v[20:23], v[60:63], v[104:107], v[20:23]
    s_mov_b32 s23, 1609728
    v_mfma_f32_16x16x32_bf16 v[24:27], v[64:67], v[104:107], v[24:27]
    buffer_load_dwordx4 v[136:139], v236, s[8:11], s23 offen sc1
    s_waitcnt lgkmcnt(5)
    v_mfma_f32_16x16x32_bf16 v[8:11], v[68:71], v[108:111], v[8:11]
    ds_read_b128 v[48:51], v233 offset:35840
    ds_read_b128 v[52:55], v233 offset:36864
    v_mfma_f32_16x16x32_bf16 v[12:15], v[72:75], v[108:111], v[12:15]
    ds_read_b128 v[56:59], v233 offset:37888
    ds_read_b128 v[60:63], v233 offset:38912
    s_waitcnt vmcnt(6)
    v_cmp_eq_u32 vcc, -1, v115
    v_mfma_f32_16x16x32_bf16 v[16:19], v[76:79], v[108:111], v[16:19]
    s_cbranch_vccnz L_rompt_kernel_c6
L_rompt_kernel_c6r:
    ds_read_b128 v[64:67], v233 offset:39936
    v_mfma_f32_16x16x32_bf16 v[20:23], v[80:83], v[108:111], v[20:23]
    s_mov_b32 s23, 1743872
    v_mfma_f32_16x16x32_bf16 v[24:27], v[84:87], v[108:111], v[24:27]
    buffer_load_dwordx4 v[140:143], v236, s[8:11], s23 offen sc1
    s_waitcnt lgkmcnt(5)
    v_mfma_f32_16x16x32_bf16 v[8:11], v[28:31], v[112:115], v[8:11]
    ds_read_b128 v[68:71], v233 offset:40960
    ds_read_b128 v[72:75], v233 offset:41984
    v_mfma_f32_16x16x32_bf16 v[12:15], v[32:35], v[112:115], v[12:15]
    ds_read_b128 v[76:79], v233 offset:43008
    ds_read_b128 v[80:83], v233 offset:44032
    s_waitcnt vmcnt(6)
    v_cmp_eq_u32 vcc, -1, v119
    v_mfma_f32_16x16x32_bf16 v[16:19], v[36:39], v[112:115], v[16:19]
    s_cbranch_vccnz L_rompt_kernel_c7
L_rompt_kernel_c7r:
    ds_read_b128 v[84:87], v233 offset:45056
    v_mfma_f32_16x16x32_bf16 v[20:23], v[40:43], v[112:115], v[20:23]
    s_mov_b32 s23, 1878016
    v_mfma_f32_16x16x32_bf16 v[24:27], v[44:47], v[112:115], v[24:27]
    buffer_load_dwordx4 v[144:147], v236, s[8:11], s23 offen sc1
    s_waitcnt lgkmcnt(5)
    v_mfma_f32_16x16x32_bf16 v[8:11], v[48:51], v[116:119], v[8:11]
    ds_read_b128 v[28:31], v233 offset:46080
    ds_read_b128 v[32:35], v233 offset:47104
    v_mfma_f32_16x16x32_bf16 v[12:15], v[52:55], v[116:119], v[12:15]
    ds_read_b128 v[36:39], v233 offset:48128
    ds_read_b128 v[40:43], v233 offset:49152
    s_waitcnt vmcnt(6)
    v_cmp_eq_u32 vcc, -1, v123
    v_mfma_f32_16x16x32_bf16 v[16:19], v[56:59], v[116:119], v[16:19]
    s_cbranch_vccnz L_rompt_kernel_c8
L_rompt_kernel_c8r:
    ds_read_b128 v[44:47], v233 offset:50176
    v_mfma_f32_16x16x32_bf16 v[20:23], v[60:63], v[116:119], v[20:23]
    s_mov_b32 s23, 2012160
    v_mfma_f32_16x16x32_bf16 v[24:27], v[64:67], v[116:119], v[24:27]
    buffer_load_dwordx4 v[148:151], v236, s[8:11], s23 offen sc1
    s_waitcnt lgkmcnt(5)
    v_mfma_f32_16x16x32_bf16 v[8:11], v[68:71], v[120:123], v[8:11]
    ds_read_b128 v[48:51], v234 offset:0
    ds_read_b128 v[52:55], v234 offset:1024
    v_mfma_f32_16x16x32_bf16 v[12:15], v[72:75], v[120:123], v[12:15]
    ds_read_b128 v[56:59], v234 offset:2048
    ds_read_b128 v[60:63], v234 offset:3072
    s_waitcnt vmcnt(6)
    v_cmp_eq_u32 vcc, -1, v127
    v_mfma_f32_16x16x32_bf16 v[16:19], v[76:79], v[120:123], v[16:19]
    s_cbranch_vccnz L_rompt_kernel_c9
L_rompt_kernel_c9r:
    ds_read_b128 v[64:67], v234 offset:4096
    v_mfma_f32_16x16x32_bf16 v[20:23], v[80:83], v[120:123], v[20:23]
    s_mov_b32 s23, 0
    buffer_load_dwordx2 v[152:153], v237, s[8:11], s23 offen sc1
    v_mfma_f32_16x16x32_bf16 v[24:27], v[84:87], v[120:123], v[24:27]
    s_mov_b32 s23, 16384
    buffer_load_dwordx2 v[154:155], v237, s[8:11], s23 offen sc1
    s_waitcnt lgkmcnt(5)
    v_mfma_f32_16x16x32_bf16 v[8:11], v[28:31], v[124:127], v[8:11]
    ds_read_b128 v[68:71], v234 offset:5120
    ds_read_b128 v[72:75], v234 offset:6144
    v_mfma_f32_16x16x32_bf16 v[12:15], v[32:35], v[124:127], v[12:15]
    ds_read_b128 v[76:79], v234 offset:7168
    ds_read_b128 v[80:83], v234 offset:8192
    s_waitcnt vmcnt(7)
    v_cmp_eq_u32 vcc, -1, v131
    v_mfma_f32_16x16x32_bf16 v[16:19], v[36:39], v[124:127], v[16:19]
    s_cbranch_vccnz L_rompt_kernel_c10
L_rompt_kernel_c10r:
    ds_read_b128 v[84:87], v234 offset:9216
    v_mfma_f32_16x16x32_bf16 v[20:23], v[40:43], v[124:127], v[20:23]
    s_mov_b32 s23, 131072
    buffer_load_dwordx2 v[156:157], v237, s[8:11], s23 offen sc1
    v_mfma_f32_16x16x32_bf16 v[24:27], v[44:47], v[124:127], v[24:27]
    s_mov_b32 s23, 147456
    buffer_load_dwordx2 v[158:159], v237, s[8:11], s23 offen sc1
    s_waitcnt lgkmcnt(5)
    v_mfma_f32_16x16x32_bf16 v[8:11], v[48:51], v[128:131], v[8:11]
    ds_read_b128 v[28:31], v234 offset:10240
    ds_read_b128 v[32:35], v234 offset:11264
    v_mfma_f32_16x16x32_bf16 v[12:15], v[52:55], v[128:131], v[12:15]
    ds_read_b128 v[36:39], v234 offset:12288
    ds_read_b128 v[40:43], v234 offset:13312
    s_waitcnt vmcnt(8)
    v_cmp_eq_u32 vcc, -1, v135
    v_mfma_f32_16x16x32_bf16 v[16:19], v[56:59], v[128:131], v[16:19]
    s_cbranch_vccnz L_rompt_kernel_c11
L_rompt_kernel_c11r:
    ds_read_b128 v[44:47], v234 offset:14336
    v_mfma_f32_16x16x32_bf16 v[20:23], v[60:63], v[128:131], v[20:23]
    s_mov_b32 s23, 262144
    buffer_load_dwordx2 v[160:161], v237, s[8:11], s23 offen sc1
    v_mfma_f32_16x16x32_bf16 v[24:27], v[64:67], v[128:131], v[24:27]
    s_mov_b32 s23, 278528
    buffer_load_dwordx2 v[162:163], v237, s[8:11], s23 offen sc1
    s_waitcnt lgkmcnt(5)
    v_mfma_f32_16x16x32_bf16 v[8:11], v[68:71], v[132:135], v[8:11]
    ds_read_b128 v[48:51], v234 offset:15360
    ds_read_b128 v[52:55], v234 offset:16384
    v_mfma_f32_16x16x32_bf16 v[12:15], v[72:75], v[132:135], v[12:15]
    ds_read_b128 v[56:59], v234 offset:17408
    ds_read_b128 v[60:63], v234 offset:18432
    s_waitcnt vmcnt(9)
    v_cmp_eq_u32 vcc, -1, v139
    v_mfma_f32_16x16x32_bf16 v[16:19], v[76:79], v[132:135], v[16:19]
    s_cbranch_vccnz L_rompt_kernel_c12
L_rompt_kernel_c12r:
    ds_read_b128 v[64:67], v234 offset:19456
    v_mfma_f32_16x16x32_bf16 v[20:23], v[80:83], v[132:135], v[20:23]
    s_mov_b32 s23, 393216
    buffer_load_dwordx2 v[164:165], v237, s[8:11], s23 offen sc1
    v_mfma_f32_16x16x32_bf16 v[24:27], v[84:87], v[132:135], v[24:27]
    s_mov_b32 s23, 409600
    buffer_load_dwordx2 v[166:167], v237, s[8:11], s23 offen sc1
    s_waitcnt lgkmcnt(5)
    v_mfma_f32_16x16x32_bf16 v[8:11], v[28:31], v[136:139], v[8:11]
    ds_read_b128 v[68:71], v234 offset:20480
    ds_read_b128 v[72:75], v234 offset:21504
    v_mfma_f32_16x16x32_bf16 v[12:15], v[32:35], v[136:139], v[12:15]
    ds_read_b128 v[76:79], v234 offset:22528
    ds_read_b128 v[80:83], v234 offset:23552
    s_waitcnt vmcnt(10)
    v_cmp_eq_u32 vcc, -1, v143
    v_mfma_f32_16x16x32_bf16 v[16:19], v[36:39], v[136:139], v[16:19]
    s_cbranch_vccnz L_rompt_kernel_c13
L_rompt_kernel_c13r:
    ds_read_b128 v[84:87], v234 offset:24576
    v_mfma_f32_16x16x32_bf16 v[20:23], v[40:43], v[136:139], v[20:23]
    s_add_u32 m0, s15, 16384
    s_add_u32 s24, s90, 1572864
    buffer_load_dwordx4 v220, s[44:47], s24 offen offset:0 lds
    v_mfma_f32_16x16x32_bf16 v[24:27], v[44:47], v[136:139], v[24:27]
    buffer_load_dwordx4 v221, s[44:47], s24 offen offset:1024 lds
    buffer_load_dwordx4 v222, s[44:47], s24 offen offset:2048 lds
    buffer_load_dwordx4 v223, s[44:47], s24 offen offset:3072 lds
    s_waitcnt lgkmcnt(5)
    v_mfma_f32_16x16x32_bf16 v[8:11], v[48:51], v[140:143], v[8:11]
    ds_read_b128 v[28:31], v234 offset:25600
    ds_read_b128 v[32:35], v234 offset:26624
    v_mfma_f32_16x16x32_bf16 v[12:15], v[52:55], v[140:143], v[12:15]
    ds_read_b128 v[36:39], v234 offset:27648
    ds_read_b128 v[40:43], v234 offset:28672
    s_waitcnt vmcnt(13)
    v_cmp_eq_u32 vcc, -1, v147
    v_mfma_f32_16x16x32_bf16 v[16:19], v[56:59], v[140:143], v[16:19]
    s_cbranch_vccnz L_rompt_kernel_c14
L_rompt_kernel_c14r:
    ds_read_b128 v[44:47], v234 offset:29696
    v_mfma_f32_16x16x32_bf16 v[20:23], v[60:63], v[140:143], v[20:23]
    v_mfma_f32_16x16x32_bf16 v[24:27], v[64:67], v[140:143], v[24:27]
    s_waitcnt lgkmcnt(5)
    v_mfma_f32_16x16x32_bf16 v[8:11], v[68:71], v[144:147], v[8:11]
    ds_read_b128 v[48:51], v234 offset:30720
    ds_read_b128 v[52:55], v234 offset:31744
    v_mfma_f32_16x16x32_bf16 v[12:15], v[72:75], v[144:147], v[12:15]
    ds_read_b128 v[56:59], v234 offset:32768
    ds_read_b128 v[60:63], v234 offset:33792
    s_waitcnt vmcnt(12)
    v_cmp_eq_u32 vcc, -1, v151
    v_mfma_f32_16x16x32_bf16 v[16:19], v[76:79], v[144:147], v[16:19]
    s_cbranch_vccnz L_rompt_kernel_c15
L_rompt_kernel_c15r:
    ds_read_b128 v[64:67], v234 offset:34816
    v_mfma_f32_16x16x32_bf16 v[20:23], v[80:83], v[144:147], v[20:23]
    v_mfma_f32_16x16x32_bf16 v[24:27], v[84:87], v[144:147], v[24:27]
    s_waitcnt lgkmcnt(5)
    v_mfma_f32_16x16x32_bf16 v[8:11], v[28:31], v[148:151], v[8:11]
    ds_read_b128 v[68:71], v234 offset:35840
    ds_read_b128 v[72:75], v234 offset:36864
    v_mfma_f32_16x16x32_bf16 v[12:15], v[32:35], v[148:151], v[12:15]
    ds_read_b128 v[76:79], v234 offset:37888
    ds_read_b128 v[80:83], v234 offset:38912
    s_waitcnt vmcnt(10)
    v_max_u32 v6, v153, v155
    v_cmp_eq_u32 vcc, -1, v6
    v_mfma_f32_16x16x32_bf16 v[16:19], v[36:39], v[148:151], v[16:19]
    s_cbranch_vccnz L_rompt_kernel_c16
L_rompt_kernel_c16r:
    ds_read_b128 v[84:87], v234 offset:39936
    v_mfma_f32_16x16x32_bf16 v[20:23], v[40:43], v[148:151], v[20:23]
    s_add_u32 m0, s15, 32768
    s_add_u32 s24, s84, 3145728
    buffer_load_dwordx4 v220, s[44:47], s24 offen offset:0 lds
    v_mfma_f32_16x16x32_bf16 v[24:27], v[44:47], v[148:151], v[24:27]
    buffer_load_dwordx4 v221, s[44:47], s24 offen offset:1024 lds
    buffer_load_dwordx4 v222, s[44:47], s24 offen offset:2048 lds
    buffer_load_dwordx4 v223, s[44:47], s24 offen offset:3072 lds
    s_waitcnt lgkmcnt(5)
    v_mfma_f32_16x16x32_bf16 v[8:11], v[48:51], v[152:155], v[8:11]
    ds_read_b128 v[28:31], v234 offset:40960
    ds_read_b128 v[32:35], v234 offset:41984
    v_mfma_f32_16x16x32_bf16 v[12:15], v[52:55], v[152:155], v[12:15]
    ds_read_b128 v[36:39], v234 offset:43008
    ds_read_b128 v[40:43], v234 offset:44032
    s_waitcnt vmcnt(12)
    v_max_u32 v6, v157, v159
    v_cmp_eq_u32 vcc, -1, v6
    v_mfma_f32_16x16x32_bf16 v[16:19], v[56:59], v[152:155], v[16:19]
    s_cbranch_vccnz L_rompt_kernel_c17
L_rompt_kernel_c17r:
    ds_read_b128 v[44:47], v234 offset:45056
    v_mfma_f32_16x16x32_bf16 v[20:23], v[60:63], v[152:155], v[20:23]
    v_mfma_f32_16x16x32_bf16 v[24:27], v[64:67], v[152:155], v[24:27]
    s_waitcnt lgkmcnt(5)
    v_mfma_f32_16x16x32_bf16 v[8:11], v[68:71], v[156:159], v[8:11]
    ds_read_b128 v[48:51], v234 offset:46080
    ds_read_b128 v[52:55], v234 offset:47104
    v_mfma_f32_16x16x32_bf16 v[12:15], v[72:75], v[156:159], v[12:15]
    ds_read_b128 v[56:59], v234 offset:48128
    ds_read_b128 v[60:63], v234 offset:49152
    s_waitcnt vmcnt(10)
    v_max_u32 v6, v161, v163
    v_cmp_eq_u32 vcc, -1, v6
    v_mfma_f32_16x16x32_bf16 v[16:19], v[76:79], v[156:159], v[16:19]
    s_cbranch_vccnz L_rompt_kernel_c18
L_rompt_kernel_c18r:
    ds_read_b128 v[64:67], v234 offset:50176
    v_mfma_f32_16x16x32_bf16 v[20:23], v[80:83], v[156:159], v[20:23]
    v_mfma_f32_16x16x32_bf16 v[24:27], v[84:87], v[156:159], v[24:27]
    s_waitcnt lgkmcnt(5)
    v_mfma_f32_16x16x32_bf16 v[8:11], v[28:31], v[160:163], v[8:11]
    s_add_u32 m0, s15, 49152
    s_add_u32 s24, s85, 3145728
    v_mfma_f32_16x16x32_bf16 v[12:15], v[32:35], v[160:163], v[12:15]
    buffer_load_dwordx4 v220, s[44:47], s24 offen offset:0 lds
    buffer_load_dwordx4 v221, s[44:47], s24 offen offset:1024 lds
    s_waitcnt vmcnt(8)
    v_max_u32 v6, v165, v167
    v_cmp_eq_u32 vcc, -1, v6
    v_mfma_f32_16x16x32_bf16 v[16:19], v[36:39], v[160:163], v[16:19]
    s_cbranch_vccnz L_rompt_kernel_c19
L_rompt_kernel_c19r:
    buffer_load_dwordx4 v222, s[44:47], s24 offen offset:2048 lds
    v_mfma_f32_16x16x32_bf16 v[20:23], v[40:43], v[160:163], v[20:23]
    buffer_load_dwordx4 v223, s[44:47], s24 offen offset:3072 lds
    v_mfma_f32_16x16x32_bf16 v[24:27], v[44:47], v[160:163], v[24:27]
    s_waitcnt lgkmcnt(0)
    v_mfma_f32_16x16x32_bf16 v[8:11], v[48:51], v[164:167], v[8:11]
    ds_read_b64 v[168:169], v232 offset:0
    v_mfma_f32_16x16x32_bf16 v[12:15], v[52:55], v[164:167], v[12:15]
    ds_read_b64 v[170:171], v232 offset:32
    v_mfma_f32_16x16x32_bf16 v[16:19], v[56:59], v[164:167], v[16:19]
    ds_read_b64 v[172:173], v232 offset:64
    v_mfma_f32_16x16x32_bf16 v[20:23], v[60:63], v[164:167], v[20:23]
    ds_read_b64 v[174:175], v232 offset:96
    v_mfma_f32_16x16x32_bf16 v[24:27], v[64:67], v[164:167], v[24:27]
    ds_read_b64 v[176:177], v232 offset:128
    s_waitcnt lgkmcnt(0)
    v_lshlrev_b32 v88, 16, v168
    v_and_b32 v89, s56, v168
    v_lshlrev_b32 v90, 16, v169
    v_and_b32 v91, s56, v169
    v_lshlrev_b32 v92, 16, v170
    v_and_b32 v93, s56, v170
    v_lshlrev_b32 v94, 16, v171
    v_and_b32 v95, s56, v171
    v_lshlrev_b32 v96, 16, v172
    v_and_b32 v97, s56, v172
    v_lshlrev_b32 v98, 16, v173
    v_and_b32 v99, s56, v173
    v_lshlrev_b32 v100, 16, v174
    v_and_b32 v101, s56, v174
    v_lshlrev_b32 v102, 16, v175
    v_and_b32 v103, s56, v175
    v_lshlrev_b32 v104, 16, v176
    v_and_b32 v105, s56, v176
    v_lshlrev_b32 v106, 16, v177
    v_and_b32 v107, s56, v177
    v_pk_add_f32 v[8:9], v[8:9], v[88:89]
    v_pk_add_f32 v[10:11], v[10:11], v[90:91]
    v_pk_add_f32 v[12:13], v[12:13], v[92:93]
    v_pk_add_f32 v[14:15], v[14:15], v[94:95]
    v_pk_add_f32 v[16:17], v[16:17], v[96:97]
    v_pk_add_f32 v[18:19], v[18:19], v[98:99]
    v_pk_add_f32 v[20:21], v[20:21], v[100:101]
    v_pk_add_f32 v[22:23], v[22:23], v[102:103]
    v_pk_add_f32 v[24:25], v[24:25], v[104:105]
    v_pk_add_f32 v[26:27], v[26:27], v[106:107]
    v_pk_add_f32 v[28:29], v[8:9], v[10:11]
    v_pk_mul_f32 v[30:31], v[8:9], v[8:9]
    v_pk_fma_f32 v[30:31], v[10:11], v[10:11], v[30:31]
    v_pk_add_f32 v[28:29], v[28:29], v[12:13]
    v_pk_fma_f32 v[30:31], v[12:13], v[12:13], v[30:31]
    v_pk_add_f32 v[28:29], v[28:29], v[14:15]
    v_pk_fma_f32 v[30:31], v[14:15], v[14:15], v[30:31]
    v_pk_add_f32 v[28:29], v[28:29], v[16:17]
    v_pk_fma_f32 v[30:31], v[16:17], v[16:17], v[30:31]
    v_pk_add_f32 v[28:29], v[28:29], v[18:19]
    v_pk_fma_f32 v[30:31], v[18:19], v[18:19], v[30:31]
    v_pk_add_f32 v[28:29], v[28:29], v[20:21]
    v_pk_fma_f32 v[30:31], v[20:21], v[20:21], v[30:31]
    v_pk_add_f32 v[28:29], v[28:29], v[22:23]
    v_pk_fma_f32 v[30:31], v[22:23], v[22:23], v[30:31]
    v_pk_add_f32 v[28:29], v[28:29], v[24:25]
    v_pk_fma_f32 v[30:31], v[24:25], v[24:25], v[30:31]
    v_pk_add_f32 v[28:29], v[28:29], v[26:27]
    v_pk_fma_f32 v[30:31], v[26:27], v[26:27], v[30:31]
    v_add_f32 v32, v28, v29
    v_add_f32 v33, v30, v31
    s_nop 1
    v_permlane32_swap_b32 v32, v33
    s_nop 0
    v_add_f32 v32, v32, v33
    v_mov_b32 v33, v32
    s_nop 1
    v_permlane16_swap_b32 v32, v33
    s_nop 0
    v_add_f32 v32, v32, v33
    v_mov_b32 v33, v32
    s_nop 1
    v_permlane32_swap_b32 v32, v33
    s_nop 0
    v_and_b32 v33, 0x7fffffff, v33
    s_mov_b64 exec, 0xffff
    buffer_store_dwordx2 v[32:33], v238, s[8:11], 0 offen sc1
    s_mov_b64 exec, -1
    s_barrier
    v_cvt_pk_bf16_f32 v188, v8, v9
    v_cvt_pk_bf16_f32 v189, v10, v11
    v_cvt_pk_bf16_f32 v190, v12, v13
    v_cvt_pk_bf16_f32 v191, v14, v15
    v_cvt_pk_bf16_f32 v192, v16, v17
    v_cvt_pk_bf16_f32 v193, v18, v19
    v_cvt_pk_bf16_f32 v194, v20, v21
    v_cvt_pk_bf16_f32 v195, v22, v23
    v_cvt_pk_bf16_f32 v196, v24, v25
    v_cvt_pk_bf16_f32 v197, v26, v27
    s_add_u32 m0, s15, 0
    s_add_u32 s24, s86, 3145728
    buffer_load_dwordx4 v220, s[44:47], s24 offen offset:0 lds
    buffer_load_dwordx4 v221, s[44:47], s24 offen offset:1024 lds
    buffer_load_dwordx4 v222, s[44:47], s24 offen offset:2048 lds
    buffer_load_dwordx4 v223, s[44:47], s24 offen offset:3072 lds
    s_waitcnt vmcnt(13)
    ds_read_b64_tr_b16 a[112:113], v224 offset:16384
    ds_read_b64_tr_b16 a[114:115], v224 offset:16896
    ds_read_b64_tr_b16 a[116:117], v225 offset:16384
    ds_read_b64_tr_b16 a[118:119], v225 offset:16896
    ds_read_b64_tr_b16 a[120:121], v226 offset:16384
    ds_read_b64_tr_b16 a[122:123], v226 offset:16896
    ds_read_b64_tr_b16 a[124:125], v227 offset:16384
    ds_read_b64_tr_b16 a[126:127], v227 offset:16896
    s_waitcnt lgkmcnt(0)
    s_add_u32 m0, s15, 16384
    s_add_u32 s24, s90, 3145728
    buffer_load_dwordx4 v220, s[44:47], s24 offen offset:0 lds
    buffer_load_dwordx4 v221, s[44:47], s24 offen offset:1024 lds
    buffer_load_dwordx4 v222, s[44:47], s24 offen offset:2048 lds
    buffer_load_dwordx4 v223, s[44:47], s24 offen offset:3072 lds
    s_waitcnt vmcnt(13)
    ds_read_b64_tr_b16 a[128:129], v224 offset:32768
    ds_read_b64_tr_b16 a[130:131], v224 offset:33280
    ds_read_b64_tr_b16 a[132:133], v225 offset:32768
    ds_read_b64_tr_b16 a[134:135], v225 offset:33280
    ds_read_b64_tr_b16 a[136:137], v226 offset:32768
    ds_read_b64_tr_b16 a[138:139], v226 offset:33280
    ds_read_b64_tr_b16 a[140:141], v227 offset:32768
    ds_read_b64_tr_b16 a[142:143], v227 offset:33280
    s_waitcnt lgkmcnt(0)
    s_add_u32 m0, s15, 32768
    s_add_u32 s24, s84, 4718592
    buffer_load_dwordx4 v220, s[44:47], s24 offen offset:0 lds
    buffer_load_dwordx4 v221, s[44:47], s24 offen offset:1024 lds
    buffer_load_dwordx4 v222, s[44:47], s24 offen offset:2048 lds
    buffer_load_dwordx4 v223, s[44:47], s24 offen offset:3072 lds
    buffer_load_dwordx2 v[36:37], v239, s[8:11], 0 offen sc1
    buffer_load_dwordx2 v[38:39], v239, s[8:11], 0 offen offset:512 sc1
    s_waitcnt vmcnt(15)
    ds_read_b64_tr_b16 a[144:145], v224 offset:49152
    ds_read_b64_tr_b16 a[146:147], v224 offset:49664
    ds_read_b64_tr_b16 a[148:149], v225 offset:49152
    ds_read_b64_tr_b16 a[150:151], v225 offset:49664
    ds_read_b64_tr_b16 a[152:153], v226 offset:49152
    ds_read_b64_tr_b16 a[154:155], v226 offset:49664
    ds_read_b64_tr_b16 a[156:157], v227 offset:49152
    ds_read_b64_tr_b16 a[158:159], v227 offset:49664
    s_waitcnt lgkmcnt(0)
    s_add_u32 m0, s15, 49152
    s_add_u32 s24, s85, 4718592
    buffer_load_dwordx4 v220, s[44:47], s24 offen offset:0 lds
    buffer_load_dwordx4 v221, s[44:47], s24 offen offset:1024 lds
    buffer_load_dwordx4 v222, s[44:47], s24 offen offset:2048 lds
    buffer_load_dwordx4 v223, s[44:47], s24 offen offset:3072 lds
    s_waitcnt vmcnt(4)
    s_mov_b32 s23, 0x200000
L_rompt_kernel_sp:
    v_or_b32 v40, v37, v39
    v_cmp_gt_i32 vcc, 0, v40
    s_cbranch_vccz L_rompt_kernel_spx
    s_sub_u32 s23, s23, 1
    s_cbranch_scc1 L_rompt_kernel_spx
    buffer_load_dwordx2 v[36:37], v239, s[8:11], 0 offen sc1
    buffer_load_dwordx2 v[38:39], v239, s[8:11], 0 offen offset:512 sc1
    s_waitcnt vmcnt(0)
    s_branch L_rompt_kernel_sp
L_rompt_kernel_spx:
    s_lshl_b32 s24, s12, 7
    s_add_u32 s24, s24, 16833280
    s_cmp_eq_u32 s14, 0
    s_cselect_b32 s24, s24, 1073741824
    v_mul_u32_u24 v1, 1024, v0
    v_mov_b32 v2, 1
    s_mov_b64 exec, 255
    buffer_atomic_add v2, v1, s[8:11], s24 offen sc1
    s_mov_b64 exec, -1
    v_pk_add_f32 v[36:37], v[36:37], v[38:39]
    s_nop 1
    v_permlane32_swap_b32 v36, v37
    s_nop 0
    v_add_f32 v36, v36, v37
    v_mov_b32 v37, v36
    s_nop 1
    v_permlane16_swap_b32 v36, v37
    s_nop 0
    v_add_f32 v36, v36, v37
    v_mov_b32 v37, v36
    s_nop 1
    v_permlane32_swap_b32 v36, v37
    s_nop 0
    v_mul_f32 v36, 0x3acccccd, v36
    v_mul_f32 v37, 0x3acccccd, v37
    v_fma_f32 v37, -v36, v36, v37
    v_max_f32 v37, 0, v37
    v_add_f32 v38, 0x3727c5ac, v37
    v_rsq_f32 v38, v38
    s_nop 0
    v_mul_f32 v37, v37, v38
    v_mul_f32 v37, v37, v38
    v_add_f32 v37, 0x3727c5ac, v37
    v_rsq_f32 v37, v37
    s_nop 0
    v_mul_f32 v38, v37, v38
    v_mul_f32 v39, v36, v38
    v_sub_f32 v39, 0, v39
    v_pk_fma_f32 v[8:9], v[8:9], v[38:39], v[38:39] op_sel:[0,0,1] op_sel_hi:[1,0,1]
    v_pk_fma_f32 v[10:11], v[10:11], v[38:39], v[38:39] op_sel:[0,0,1] op_sel_hi:[1,0,1]
    v_cvt_pk_bf16_f32 v88, v8, v9
    v_cvt_pk_bf16_f32 v89, v10, v11
    ds_write_b64 v232, v[88:89] offset:0
    v_pk_fma_f32 v[12:13], v[12:13], v[38:39], v[38:39] op_sel:[0,0,1] op_sel_hi:[1,0,1]
    v_pk_fma_f32 v[14:15], v[14:15], v[38:39], v[38:39] op_sel:[0,0,1] op_sel_hi:[1,0,1]
    v_cvt_pk_bf16_f32 v90, v12, v13
    v_cvt_pk_bf16_f32 v91, v14, v15
    ds_write_b64 v232, v[90:91] offset:32
    v_pk_fma_f32 v[16:17], v[16:17], v[38:39], v[38:39] op_sel:[0,0,1] op_sel_hi:[1,0,1]
    v_pk_fma_f32 v[18:19], v[18:19], v[38:39], v[38:39] op_sel:[0,0,1] op_sel_hi:[1,0,1]
    v_cvt_pk_bf16_f32 v92, v16, v17
    v_cvt_pk_bf16_f32 v93, v18, v19
    ds_write_b64 v232, v[92:93] offset:64
    v_pk_fma_f32 v[20:21], v[20:21], v[38:39], v[38:39] op_sel:[0,0,1] op_sel_hi:[1,0,1]
    v_pk_fma_f32 v[22:23], v[22:23], v[38:39], v[38:39] op_sel:[0,0,1] op_sel_hi:[1,0,1]
    v_cvt_pk_bf16_f32 v94, v20, v21
    v_cvt_pk_bf16_f32 v95, v22, v23
    ds_write_b64 v232, v[94:95] offset:96
    v_pk_fma_f32 v[24:25], v[24:25], v[38:39], v[38:39] op_sel:[0,0,1] op_sel_hi:[1,0,1]
    v_pk_fma_f32 v[26:27], v[26:27], v[38:39], v[38:39] op_sel:[0,0,1] op_sel_hi:[1,0,1]
    v_cvt_pk_bf16_f32 v96, v24, v25
    v_cvt_pk_bf16_f32 v97, v26, v27
    ds_write_b64 v232, v[96:97] offset:128
    s_waitcnt lgkmcnt(0)
    ds_read_b64_tr_b16 v[8:9], v240 offset:0
    ds_read_b64_tr_b16 v[10:11], v240 offset:640
    ds_read_b64_tr_b16 v[12:13], v240 offset:64
    ds_read_b64_tr_b16 v[14:15], v240 offset:704
    ds_read_b64_tr_b16 v[16:17], v240 offset:128
    ds_read_b64_tr_b16 v[18:19], v240 offset:768
    s_waitcnt lgkmcnt(4)
    v_min_u32 v11, -2, v11
    buffer_store_dwordx4 v[8:11], v241, s[8:11], 0 offen offset:0 sc1
    s_waitcnt lgkmcnt(2)
    v_min_u32 v15, -2, v15
    buffer_store_dwordx4 v[12:15], v241, s[8:11], 0 offen offset:512 sc1
    s_waitcnt lgkmcnt(0)
    v_min_u32 v19, -2, v19
    s_mov_b32 exec_hi, 0
    buffer_store_dwordx4 v[16:19], v241, s[8:11], 0 offen offset:1024 sc1
    s_mov_b64 exec, -1
    s_add_u32 s21, s66, 0
    s_and_b32 s21, s21, 15
    s_mul_i32 s80, s21, 40960
    s_add_u32 s21, s66, 4
    s_and_b32 s21, s21, 15
    s_mul_i32 s81, s21, 40960
    s_add_u32 s21, s66, 8
    s_and_b32 s21, s21, 15
    s_mul_i32 s82, s21, 40960
    s_add_u32 s21, s66, 12
    s_and_b32 s21, s21, 15
    s_mul_i32 s83, s21, 40960
    ds_read_b64_tr_b16 a[160:161], v224 offset:0
    ds_read_b64_tr_b16 a[162:163], v224 offset:512
    ds_read_b64_tr_b16 a[164:165], v225 offset:0
    ds_read_b64_tr_b16 a[166:167], v225 offset:512
    ds_read_b64_tr_b16 a[168:169], v226 offset:0
    ds_read_b64_tr_b16 a[170:171], v226 offset:512
    ds_read_b64_tr_b16 a[172:173], v227 offset:0
    ds_read_b64_tr_b16 a[174:175], v227 offset:512
    s_waitcnt lgkmcnt(0)
    s_add_u32 m0, s15, 0
    s_add_u32 s24, s86, 4718592
    buffer_load_dwordx4 v220, s[44:47], s24 offen offset:0 lds
    buffer_load_dwordx4 v221, s[44:47], s24 offen offset:1024 lds
    buffer_load_dwordx4 v222, s[44:47], s24 offen offset:2048 lds
    buffer_load_dwordx4 v223, s[44:47], s24 offen offset:3072 lds
    ds_read_b64_tr_b16 a[176:177], v224 offset:16384
    ds_read_b64_tr_b16 a[178:179], v224 offset:16896
    ds_read_b64_tr_b16 a[180:181], v225 offset:16384
    ds_read_b64_tr_b16 a[182:183], v225 offset:16896
    ds_read_b64_tr_b16 a[184:185], v226 offset:16384
    ds_read_b64_tr_b16 a[186:187], v226 offset:16896
    ds_read_b64_tr_b16 a[188:189], v227 offset:16384
    ds_read_b64_tr_b16 a[190:191], v227 offset:16896
    s_waitcnt lgkmcnt(0)
    s_add_u32 m0, s15, 16384
    s_add_u32 s24, s90, 4718592
    buffer_load_dwordx4 v220, s[44:47], s24 offen offset:0 lds
    buffer_load_dwordx4 v221, s[44:47], s24 offen offset:1024 lds
    buffer_load_dwordx4 v222, s[44:47], s24 offen offset:2048 lds
    buffer_load_dwordx4 v223, s[44:47], s24 offen offset:3072 lds
    s_sub_u32 s22, s73, s72
    v_mul_u32_u24 v5, s22, v0
    v_add_lshl_u32 v5, v5, s72, 7
    s_mul_i32 s43, s16, 1024
    s_add_u32 s43, s43, 16833280
    s_cmp_eq_u32 s14, 1
    s_cselect_b32 s43, s43, 1073741824
    v_mov_b32 v4, 0
    s_cmp_ge_u32 s17, 30
    s_cselect_b32 s43, 1073741824, s43
    s_mov_b64 exec, 3
    buffer_atomic_add v4, v5, s[8:11], s43 offen sc0 sc1
    s_mov_b64 exec, -1
    ds_read_b64_tr_b16 a[192:193], v224 offset:32768
    ds_read_b64_tr_b16 a[194:195], v224 offset:33280
    ds_read_b64_tr_b16 a[196:197], v225 offset:32768
    ds_read_b64_tr_b16 a[198:199], v225 offset:33280
    ds_read_b64_tr_b16 a[200:201], v226 offset:32768
    ds_read_b64_tr_b16 a[202:203], v226 offset:33280
    ds_read_b64_tr_b16 a[204:205], v227 offset:32768
    ds_read_b64_tr_b16 a[206:207], v227 offset:33280
    s_waitcnt lgkmcnt(0)
    s_mov_b32 s44, s32
    s_mov_b32 s45, s33
    s_mov_b32 s46, 0x600000
    s_mov_b32 s47, 0x00020000
    v_lshrrev_b32 v3, 3, v0
    v_mul_u32_u24 v3, 4096, v3
    s_lshl_b32 s22, s20, 1
    v_add_u32 v3, s22, v3
    v_and_b32 v1, 7, v0
    v_lshlrev_b32 v2, 1, v251
    v_xor_b32 v1, v1, v2
    v_lshl_add_u32 v220, v1, 4, v3
    v_add_u32 v221, 31744, v220
    v_add_u32 v222, 63488, v220
    v_add_u32 v223, 95232, v220
    s_add_u32 s23, s18, 0
    s_and_b32 s23, s23, 15
    s_mul_i32 s84, s23, 131072
    s_add_u32 s23, s18, 4
    s_and_b32 s23, s23, 15
    s_mul_i32 s85, s23, 131072
    s_add_u32 s23, s18, 8
    s_and_b32 s23, s23, 15
    s_mul_i32 s86, s23, 131072
    s_add_u32 s23, s18, 12
    s_and_b32 s23, s23, 15
    s_mul_i32 s90, s23, 131072
    s_add_u32 m0, s15, 32768
    s_nop 0
    buffer_load_dwordx4 v220, s[44:47], s84 offen offset:0 lds
    buffer_load_dwordx4 v221, s[44:47], s84 offen offset:1024 lds
    buffer_load_dwordx4 v222, s[44:47], s84 offen offset:2048 lds
    buffer_load_dwordx4 v223, s[44:47], s84 offen offset:3072 lds
    s_waitcnt vmcnt(17)
    ds_read_b64_tr_b16 a[208:209], v224 offset:49152
    ds_read_b64_tr_b16 a[210:211], v224 offset:49664
    ds_read_b64_tr_b16 a[212:213], v225 offset:49152
    ds_read_b64_tr_b16 a[214:215], v225 offset:49664
    ds_read_b64_tr_b16 a[216:217], v226 offset:49152
    ds_read_b64_tr_b16 a[218:219], v226 offset:49664
    ds_read_b64_tr_b16 a[220:221], v227 offset:49152
    ds_read_b64_tr_b16 a[222:223], v227 offset:49664
    s_waitcnt lgkmcnt(0)
    s_add_u32 m0, s15, 49152
    s_nop 0
    buffer_load_dwordx4 v220, s[44:47], s85 offen offset:0 lds
    buffer_load_dwordx4 v221, s[44:47], s85 offen offset:1024 lds
    buffer_load_dwordx4 v222, s[44:47], s85 offen offset:2048 lds
    buffer_load_dwordx4 v223, s[44:47], s85 offen offset:3072 lds
    s_cmp_eq_u32 s43, 1073741824
    s_cbranch_scc1 L_rompt_kernel_p1x
    s_mov_b32 s23, 0x200000
    s_mov_b64 exec, 3
    s_waitcnt vmcnt(8)
L_rompt_kernel_p1:
    v_cmp_gt_u32 vcc, 32, v4
    s_cbranch_vccz L_rompt_kernel_p1y
    s_sub_u32 s23, s23, 1
    s_cbranch_scc1 L_rompt_kernel_p1y
    v_mov_b32 v4, 0
    buffer_atomic_add v4, v5, s[8:11], s43 offen sc0 sc1
    s_waitcnt vmcnt(0)
    s_branch L_rompt_kernel_p1
L_rompt_kernel_p1y:
    s_mov_b64 exec, -1
L_rompt_kernel_p1x:
    s_barrier
    buffer_load_dwordx4 v[88:91], v244, s[48:51], s80 offen sc1
    buffer_load_dwordx4 v[92:95], v244, s[48:51], s81 offen sc1
    buffer_load_dwordx4 v[96:99], v244, s[48:51], s82 offen sc1
    buffer_load_dwordx4 v[100:103], v244, s[48:51], s83 offen sc1
    s_add_u32 s23, s80, 655360
    buffer_load_dwordx4 v[104:107], v244, s[48:51], s23 offen sc1
    s_add_u32 s23, s81, 655360
    buffer_load_dwordx4 v[108:111], v244, s[48:51], s23 offen sc1
    s_add_u32 s23, s82, 655360
    buffer_load_dwordx4 v[112:115], v244, s[48:51], s23 offen sc1
    s_add_u32 s23, s83, 655360
    buffer_load_dwordx4 v[116:119], v244, s[48:51], s23 offen sc1
    s_add_u32 s23, s80, 1310720
    buffer_load_dwordx4 v[120:123], v244, s[48:51], s23 offen sc1
    s_add_u32 s23, s81, 1310720
    buffer_load_dwordx4 v[124:127], v244, s[48:51], s23 offen sc1
    s_add_u32 s23, s82, 1310720
    buffer_load_dwordx4 v[128:131], v244, s[48:51], s23 offen sc1
    s_add_u32 s23, s83, 1310720
    buffer_load_dwordx4 v[132:135], v244, s[48:51], s23 offen sc1
    s_add_u32 s23, s80, 1966080
    buffer_load_dwordx4 v[136:139], v244, s[48:51], s23 offen sc1
    s_add_u32 s23, s81, 1966080
    buffer_load_dwordx4 v[140:143], v244, s[48:51], s23 offen sc1
    s_waitcnt vmcnt(27)
    ds_read_b64_tr_b16 a[224:225], v224 offset:0
    ds_read_b64_tr_b16 a[226:227], v224 offset:512
    ds_read_b64_tr_b16 a[228:229], v225 offset:0
    ds_read_b64_tr_b16 a[230:231], v225 offset:512
    ds_read_b64_tr_b16 a[232:233], v226 offset:0
    ds_read_b64_tr_b16 a[234:235], v226 offset:512
    ds_read_b64_tr_b16 a[236:237], v227 offset:0
    ds_read_b64_tr_b16 a[238:239], v227 offset:512
    s_waitcnt vmcnt(23)
    ds_read_b64_tr_b16 a[240:241], v224 offset:16384
    ds_read_b64_tr_b16 a[242:243], v224 offset:16896
    ds_read_b64_tr_b16 a[244:245], v225 offset:16384
    ds_read_b64_tr_b16 a[246:247], v225 offset:16896
    ds_read_b64_tr_b16 a[248:249], v226 offset:16384
    ds_read_b64_tr_b16 a[250:251], v226 offset:16896
    ds_read_b64_tr_b16 a[252:253], v227 offset:16384
    ds_read_b64_tr_b16 a[254:255], v227 offset:16896
    v_lshrrev_b32 v3, 2, v0
    v_lshlrev_b32 v1, 7, v3
    v_bfe_u32 v3, v0, 3, 2
    v_lshl_add_u32 v1, v3, 5, v1
    v_and_b32 v3, 3, v0
    v_lshl_add_u32 v1, v3, 3, v1
    s_lshl_b32 s22, s38, 5
    v_xor_b32 v224, s22, v1
    v_add_u32 v224, s15, v224
    s_lshl_b32 s22, s39, 5
    v_xor_b32 v225, s22, v1
    v_add_u32 v225, s15, v225
    s_lshl_b32 s22, s40, 5
    v_xor_b32 v226, s22, v1
    v_add_u32 v226, s15, v226
    s_lshl_b32 s22, s41, 5
    v_xor_b32 v227, s22, v1
    v_add_u32 v227, s15, v227
    s_waitcnt lgkmcnt(0)
    s_waitcnt vmcnt(13)
    v_cmp_eq_u32 vcc, -1, v91
    s_cbranch_vccnz L_rompt_kernel_d0
L_rompt_kernel_d0r:
    v_mfma_f32_16x16x32_bf16 v[28:31], a[0:3], v[88:91], 0
    s_waitcnt vmcnt(12)
    v_cmp_eq_u32 vcc, -1, v95
    v_mfma_f32_16x16x32_bf16 v[32:35], a[4:7], v[88:91], 0
    s_cbranch_vccnz L_rompt_kernel_d1
L_rompt_kernel_d1r:
    s_add_u32 s23, s82, 1966080
    buffer_load_dwordx4 v[144:147], v244, s[48:51], s23 offen sc1
    v_mfma_f32_16x16x32_bf16 v[36:39], a[8:11], v[88:91], 0
    s_mov_b32 s58, 0xbdd2d3e8
    v_mov_b32 v7, 0xc0135761
    s_mov_b32 s61, 40960
    v_mfma_f32_16x16x32_bf16 v[40:43], a[12:15], v[88:91], 0
    v_lshlrev_b32 v172, 16, v210
    v_and_b32 v173, s56, v210
    v_lshlrev_b32 v174, 16, v211
    v_mfma_f32_16x16x32_bf16 v[28:31], a[16:19], v[92:95], v[28:31]
    s_waitcnt vmcnt(12)
    v_cmp_eq_u32 vcc, -1, v99
    v_mfma_f32_16x16x32_bf16 v[32:35], a[20:23], v[92:95], v[32:35]
    s_cbranch_vccnz L_rompt_kernel_d2
L_rompt_kernel_d2r:
    s_add_u32 s23, s83, 1966080
    buffer_load_dwordx4 v[88:91], v244, s[48:51], s23 offen sc1
    v_mfma_f32_16x16x32_bf16 v[36:39], a[24:27], v[92:95], v[36:39]
    v_and_b32 v175, s56, v211
    v_lshlrev_b32 v176, 16, v212
    v_and_b32 v177, s56, v212
    v_mfma_f32_16x16x32_bf16 v[40:43], a[28:31], v[92:95], v[40:43]
    v_lshlrev_b32 v178, 16, v213
    v_and_b32 v179, s56, v213
    v_lshlrev_b32 v180, 16, v214
    v_mfma_f32_16x16x32_bf16 v[28:31], a[32:35], v[96:99], v[28:31]
    s_waitcnt vmcnt(12)
    v_cmp_eq_u32 vcc, -1, v103
    v_mfma_f32_16x16x32_bf16 v[32:35], a[36:39], v[96:99], v[32:35]
    s_cbranch_vccnz L_rompt_kernel_d3
L_rompt_kernel_d3r:
    buffer_load_dwordx4 v[92:95], v245, s[48:51], s80 offen sc1
    v_and_b32 v181, s56, v214
    v_mfma_f32_16x16x32_bf16 v[36:39], a[40:43], v[96:99], v[36:39]
    v_lshlrev_b32 v182, 16, v215
    v_and_b32 v183, s56, v215
    v_lshlrev_b32 v184, 16, v216
    v_mfma_f32_16x16x32_bf16 v[40:43], a[44:47], v[96:99], v[40:43]
    v_and_b32 v185, s56, v216
    v_lshlrev_b32 v186, 16, v217
    v_mfma_f32_16x16x32_bf16 v[28:31], a[48:51], v[100:103], v[28:31]
    s_waitcnt vmcnt(9)
    v_max3_u32 v6, v107, v111, v115
    v_max_u32 v6, v6, v119
    v_cmp_eq_u32 vcc, -1, v6
    v_mfma_f32_16x16x32_bf16 v[32:35], a[52:55], v[100:103], v[32:35]
    s_cbranch_vccnz L_rompt_kernel_d4
L_rompt_kernel_d4r:
    v_mfma_f32_16x16x32_bf16 v[36:39], a[56:59], v[100:103], v[36:39]
    buffer_load_dwordx4 v[96:99], v245, s[48:51], s81 offen sc1
    v_mfma_f32_16x16x32_bf16 v[40:43], a[60:63], v[100:103], v[40:43]
    v_and_b32 v187, s56, v217
    v_mfma_f32_16x16x32_bf16 v[28:31], a[64:67], v[104:107], v[28:31]
    buffer_load_dwordx4 v[100:103], v245, s[48:51], s82 offen sc1
    v_mfma_f32_16x16x32_bf16 v[32:35], a[68:71], v[104:107], v[32:35]
    v_mfma_f32_16x16x32_bf16 v[36:39], a[72:75], v[104:107], v[36:39]
    v_mfma_f32_16x16x32_bf16 v[40:43], a[76:79], v[104:107], v[40:43]
    v_mfma_f32_16x16x32_bf16 v[28:31], a[80:83], v[108:111], v[28:31]
    buffer_load_dwordx4 v[104:107], v245, s[48:51], s83 offen sc1
    v_mfma_f32_16x16x32_bf16 v[32:35], a[84:87], v[108:111], v[32:35]
    v_mfma_f32_16x16x32_bf16 v[36:39], a[88:91], v[108:111], v[36:39]
    v_mfma_f32_16x16x32_bf16 v[40:43], a[92:95], v[108:111], v[40:43]
    v_mfma_f32_16x16x32_bf16 v[28:31], a[96:99], v[112:115], v[28:31]
    s_add_u32 s23, s80, 655360
    v_mfma_f32_16x16x32_bf16 v[32:35], a[100:103], v[112:115], v[32:35]
    v_mfma_f32_16x16x32_bf16 v[36:39], a[104:107], v[112:115], v[36:39]
    buffer_load_dwordx4 v[108:111], v245, s[48:51], s23 offen sc1
    v_mfma_f32_16x16x32_bf16 v[40:43], a[108:111], v[112:115], v[40:43]
    v_mfma_f32_16x16x32_bf16 v[28:31], a[112:115], v[116:119], v[28:31]
    s_waitcnt vmcnt(9)
    v_max3_u32 v6, v123, v127, v131
    v_max_u32 v6, v6, v135
    v_cmp_eq_u32 vcc, -1, v6
    v_mfma_f32_16x16x32_bf16 v[32:35], a[116:119], v[116:119], v[32:35]
    s_cbranch_vccnz L_rompt_kernel_d8
L_rompt_kernel_d8r:
    v_mfma_f32_16x16x32_bf16 v[36:39], a[120:123], v[116:119], v[36:39]
    s_add_u32 s23, s81, 655360
    v_mfma_f32_16x16x32_bf16 v[40:43], a[124:127], v[116:119], v[40:43]
    buffer_load_dwordx4 v[112:115], v245, s[48:51], s23 offen sc1
    v_mfma_f32_16x16x32_bf16 v[28:31], a[128:131], v[120:123], v[28:31]
    s_add_u32 s23, s82, 655360
    v_mfma_f32_16x16x32_bf16 v[32:35], a[132:135], v[120:123], v[32:35]
    v_mfma_f32_16x16x32_bf16 v[36:39], a[136:139], v[120:123], v[36:39]
    buffer_load_dwordx4 v[116:119], v245, s[48:51], s23 offen sc1
    v_mfma_f32_16x16x32_bf16 v[40:43], a[140:143], v[120:123], v[40:43]
    v_mfma_f32_16x16x32_bf16 v[28:31], a[144:147], v[124:127], v[28:31]
    s_add_u32 s23, s83, 655360
    v_mfma_f32_16x16x32_bf16 v[32:35], a[148:151], v[124:127], v[32:35]
    v_mfma_f32_16x16x32_bf16 v[36:39], a[152:155], v[124:127], v[36:39]
    buffer_load_dwordx4 v[120:123], v245, s[48:51], s23 offen sc1
    v_mfma_f32_16x16x32_bf16 v[40:43], a[156:159], v[124:127], v[40:43]
    v_mfma_f32_16x16x32_bf16 v[28:31], a[160:163], v[128:131], v[28:31]
    s_add_u32 s23, s80, 1310720
    v_mfma_f32_16x16x32_bf16 v[32:35], a[164:167], v[128:131], v[32:35]
    v_mfma_f32_16x16x32_bf16 v[36:39], a[168:171], v[128:131], v[36:39]
    buffer_load_dwordx4 v[124:127], v245, s[48:51], s23 offen sc1
    v_mfma_f32_16x16x32_bf16 v[40:43], a[172:175], v[128:131], v[40:43]
    v_mfma_f32_16x16x32_bf16 v[28:31], a[176:179], v[132:135], v[28:31]
    s_waitcnt vmcnt(9)
    v_max3_u32 v6, v139, v143, v147
    v_max_u32 v6, v6, v91
    v_cmp_eq_u32 vcc, -1, v6
    v_mfma_f32_16x16x32_bf16 v[32:35], a[180:183], v[132:135], v[32:35]
    s_cbranch_vccnz L_rompt_kernel_d12
L_rompt_kernel_d12r:
    v_mfma_f32_16x16x32_bf16 v[36:39], a[184:187], v[132:135], v[36:39]
    s_add_u32 s23, s81, 1310720
    v_mfma_f32_16x16x32_bf16 v[40:43], a[188:191], v[132:135], v[40:43]
    buffer_load_dwordx4 v[128:131], v245, s[48:51], s23 offen sc1
    v_mfma_f32_16x16x32_bf16 v[28:31], a[192:195], v[136:139], v[28:31]
    s_add_u32 s23, s82, 1310720
    v_mfma_f32_16x16x32_bf16 v[32:35], a[196:199], v[136:139], v[32:35]
    v_mfma_f32_16x16x32_bf16 v[36:39], a[200:203], v[136:139], v[36:39]
    buffer_load_dwordx4 v[132:135], v245, s[48:51], s23 offen sc1
    v_mfma_f32_16x16x32_bf16 v[40:43], a[204:207], v[136:139], v[40:43]
    v_mfma_f32_16x16x32_bf16 v[28:31], a[208:211], v[140:143], v[28:31]
    s_add_u32 s23, s83, 1310720
    v_mfma_f32_16x16x32_bf16 v[32:35], a[212:215], v[140:143], v[32:35]
    v_mfma_f32_16x16x32_bf16 v[36:39], a[216:219], v[140:143], v[36:39]
    buffer_load_dwordx4 v[136:139], v245, s[48:51], s23 offen sc1
    v_mfma_f32_16x16x32_bf16 v[40:43], a[220:223], v[140:143], v[40:43]
    v_mfma_f32_16x16x32_bf16 v[28:31], a[224:227], v[144:147], v[28:31]
    s_add_u32 s23, s80, 1966080
    v_mfma_f32_16x16x32_bf16 v[32:35], a[228:231], v[144:147], v[32:35]
    v_mfma_f32_16x16x32_bf16 v[36:39], a[232:235], v[144:147], v[36:39]
    buffer_load_dwordx4 v[140:143], v245, s[48:51], s23 offen sc1
    v_mfma_f32_16x16x32_bf16 v[40:43], a[236:239], v[144:147], v[40:43]
    v_mfma_f32_16x16x32_bf16 v[28:31], a[240:243], v[88:91], v[28:31]
    s_waitcnt vmcnt(9)
    v_max3_u32 v6, v95, v99, v103
    v_max_u32 v6, v6, v107
    v_cmp_eq_u32 vcc, -1, v6
    v_mfma_f32_16x16x32_bf16 v[32:35], a[244:247], v[88:91], v[32:35]
    s_cbranch_vccnz L_rompt_kernel_d16
L_rompt_kernel_d16r:
    v_mfma_f32_16x16x32_bf16 v[36:39], a[248:251], v[88:91], v[36:39]
    s_add_u32 s23, s81, 1966080
    v_mfma_f32_16x16x32_bf16 v[40:43], a[252:255], v[88:91], v[40:43]
    buffer_load_dwordx4 v[144:147], v245, s[48:51], s23 offen sc1
    v_mfma_f32_16x16x32_bf16 v[48:51], a[0:3], v[92:95], 0
    s_add_u32 s23, s82, 1966080
    v_mfma_f32_16x16x32_bf16 v[52:55], a[4:7], v[92:95], 0
    v_mfma_f32_16x16x32_bf16 v[56:59], a[8:11], v[92:95], 0
    buffer_load_dwordx4 v[88:91], v245, s[48:51], s23 offen sc1
    v_mfma_f32_16x16x32_bf16 v[60:63], a[12:15], v[92:95], 0
    v_mfma_f32_16x16x32_bf16 v[48:51], a[16:19], v[96:99], v[48:51]
    s_add_u32 s23, s83, 1966080
    v_mfma_f32_16x16x32_bf16 v[52:55], a[20:23], v[96:99], v[52:55]
    v_mfma_f32_16x16x32_bf16 v[56:59], a[24:27], v[96:99], v[56:59]
    buffer_load_dwordx4 v[92:95], v245, s[48:51], s23 offen sc1
    v_mfma_f32_16x16x32_bf16 v[60:63], a[28:31], v[96:99], v[60:63]
    v_mfma_f32_16x16x32_bf16 v[48:51], a[32:35], v[100:103], v[48:51]
    buffer_load_dwordx4 v[96:99], v246, s[48:51], s80 offen sc1
    v_mfma_f32_16x16x32_bf16 v[52:55], a[36:39], v[100:103], v[52:55]
    v_mfma_f32_16x16x32_bf16 v[56:59], a[40:43], v[100:103], v[56:59]
    ds_write_b128 v228, v[28:31] offset:0
    v_mfma_f32_16x16x32_bf16 v[60:63], a[44:47], v[100:103], v[60:63]
    v_mfma_f32_16x16x32_bf16 v[48:51], a[48:51], v[104:107], v[48:51]
    s_waitcnt vmcnt(9)
    v_max3_u32 v6, v111, v115, v119
    v_max_u32 v6, v6, v123
    v_cmp_eq_u32 vcc, -1, v6
    v_mfma_f32_16x16x32_bf16 v[52:55], a[52:55], v[104:107], v[52:55]
    s_cbranch_vccnz L_rompt_kernel_d20
L_rompt_kernel_d20r:
    v_mfma_f32_16x16x32_bf16 v[56:59], a[56:59], v[104:107], v[56:59]
    buffer_load_dwordx4 v[100:103], v246, s[48:51], s81 offen sc1
    v_mfma_f32_16x16x32_bf16 v[60:63], a[60:63], v[104:107], v[60:63]
    ds_write_b128 v228, v[32:35] offset:1024
    v_mfma_f32_16x16x32_bf16 v[48:51], a[64:67], v[108:111], v[48:51]
    buffer_load_dwordx4 v[104:107], v246, s[48:51], s82 offen sc1
    v_mfma_f32_16x16x32_bf16 v[52:55], a[68:71], v[108:111], v[52:55]
    v_mfma_f32_16x16x32_bf16 v[56:59], a[72:75], v[108:111], v[56:59]
    ds_write_b128 v228, v[36:39] offset:2048
    v_mfma_f32_16x16x32_bf16 v[60:63], a[76:79], v[108:111], v[60:63]
    v_mfma_f32_16x16x32_bf16 v[48:51], a[80:83], v[112:115], v[48:51]
    buffer_load_dwordx4 v[108:111], v246, s[48:51], s83 offen sc1
    v_mfma_f32_16x16x32_bf16 v[52:55], a[84:87], v[112:115], v[52:55]
    v_mfma_f32_16x16x32_bf16 v[56:59], a[88:91], v[112:115], v[56:59]
    ds_write_b128 v228, v[40:43] offset:3072
    v_mfma_f32_16x16x32_bf16 v[60:63], a[92:95], v[112:115], v[60:63]
    v_mfma_f32_16x16x32_bf16 v[48:51], a[96:99], v[116:119], v[48:51]
    s_add_u32 s23, s80, 655360
    v_mfma_f32_16x16x32_bf16 v[52:55], a[100:103], v[116:119], v[52:55]
    v_mfma_f32_16x16x32_bf16 v[56:59], a[104:107], v[116:119], v[56:59]
    buffer_load_dwordx4 v[112:115], v246, s[48:51], s23 offen sc1
    v_mfma_f32_16x16x32_bf16 v[60:63], a[108:111], v[116:119], v[60:63]
    v_mfma_f32_16x16x32_bf16 v[48:51], a[112:115], v[120:123], v[48:51]
    s_waitcnt vmcnt(9)
    v_max3_u32 v6, v127, v131, v135
    v_max_u32 v6, v6, v139
    v_cmp_eq_u32 vcc, -1, v6
    v_mfma_f32_16x16x32_bf16 v[52:55], a[116:119], v[120:123], v[52:55]
    s_cbranch_vccnz L_rompt_kernel_d24
L_rompt_kernel_d24r:
    v_mfma_f32_16x16x32_bf16 v[56:59], a[120:123], v[120:123], v[56:59]
    s_add_u32 s23, s81, 655360
    v_mfma_f32_16x16x32_bf16 v[60:63], a[124:127], v[120:123], v[60:63]
    buffer_load_dwordx4 v[116:119], v246, s[48:51], s23 offen sc1
    v_mfma_f32_16x16x32_bf16 v[48:51], a[128:131], v[124:127], v[48:51]
    s_add_u32 s23, s82, 655360
    v_mfma_f32_16x16x32_bf16 v[52:55], a[132:135], v[124:127], v[52:55]
    v_mfma_f32_16x16x32_bf16 v[56:59], a[136:139], v[124:127], v[56:59]
    buffer_load_dwordx4 v[120:123], v246, s[48:51], s23 offen sc1
    v_mfma_f32_16x16x32_bf16 v[60:63], a[140:143], v[124:127], v[60:63]
    v_mfma_f32_16x16x32_bf16 v[48:51], a[144:147], v[128:131], v[48:51]
    s_add_u32 s23, s83, 655360
    v_mfma_f32_16x16x32_bf16 v[52:55], a[148:151], v[128:131], v[52:55]
    v_mfma_f32_16x16x32_bf16 v[56:59], a[152:155], v[128:131], v[56:59]
    buffer_load_dwordx4 v[124:127], v246, s[48:51], s23 offen sc1
    v_mfma_f32_16x16x32_bf16 v[60:63], a[156:159], v[128:131], v[60:63]
    v_mfma_f32_16x16x32_bf16 v[48:51], a[160:163], v[132:135], v[48:51]
    s_add_u32 s23, s80, 1310720
    v_mfma_f32_16x16x32_bf16 v[52:55], a[164:167], v[132:135], v[52:55]
    v_mfma_f32_16x16x32_bf16 v[56:59], a[168:171], v[132:135], v[56:59]
    buffer_load_dwordx4 v[128:131], v246, s[48:51], s23 offen sc1
    v_mfma_f32_16x16x32_bf16 v[60:63], a[172:175], v[132:135], v[60:63]
    v_mfma_f32_16x16x32_bf16 v[48:51], a[176:179], v[136:139], v[48:51]
    s_waitcnt vmcnt(9)
    v_max3_u32 v6, v143, v147, v91
    v_max_u32 v6, v6, v95
    v_cmp_eq_u32 vcc, -1, v6
    v_mfma_f32_16x16x32_bf16 v[52:55], a[180:183], v[136:139], v[52:55]
    s_cbranch_vccnz L_rompt_kernel_d28
L_rompt_kernel_d28r:
    v_mfma_f32_16x16x32_bf16 v[56:59], a[184:187], v[136:139], v[56:59]
    s_add_u32 s23, s81, 1310720
    v_mfma_f32_16x16x32_bf16 v[60:63], a[188:191], v[136:139], v[60:63]
    buffer_load_dwordx4 v[132:135], v246, s[48:51], s23 offen sc1
    v_mfma_f32_16x16x32_bf16 v[48:51], a[192:195], v[140:143], v[48:51]
    s_add_u32 s23, s82, 1310720
    v_mfma_f32_16x16x32_bf16 v[52:55], a[196:199], v[140:143], v[52:55]
    v_mfma_f32_16x16x32_bf16 v[56:59], a[200:203], v[140:143], v[56:59]
    buffer_load_dwordx4 v[136:139], v246, s[48:51], s23 offen sc1
    v_mfma_f32_16x16x32_bf16 v[60:63], a[204:207], v[140:143], v[60:63]
    v_mfma_f32_16x16x32_bf16 v[48:51], a[208:211], v[144:147], v[48:51]
    s_add_u32 s23, s83, 1310720
    v_mfma_f32_16x16x32_bf16 v[52:55], a[212:215], v[144:147], v[52:55]
    v_mfma_f32_16x16x32_bf16 v[56:59], a[216:219], v[144:147], v[56:59]
    buffer_load_dwordx4 v[140:143], v246, s[48:51], s23 offen sc1
    v_mfma_f32_16x16x32_bf16 v[60:63], a[220:223], v[144:147], v[60:63]
    v_mfma_f32_16x16x32_bf16 v[48:51], a[224:227], v[88:91], v[48:51]
    s_add_u32 s23, s80, 1966080
    v_mfma_f32_16x16x32_bf16 v[52:55], a[228:231], v[88:91], v[52:55]
    v_mfma_f32_16x16x32_bf16 v[56:59], a[232:235], v[88:91], v[56:59]
    buffer_load_dwordx4 v[144:147], v246, s[48:51], s23 offen sc1
    v_mfma_f32_16x16x32_bf16 v[60:63], a[236:239], v[88:91], v[60:63]
    v_mfma_f32_16x16x32_bf16 v[48:51], a[240:243], v[92:95], v[48:51]
    s_waitcnt vmcnt(9)
    v_max3_u32 v6, v99, v103, v107
    v_max_u32 v6, v6, v111
    v_cmp_eq_u32 vcc, -1, v6
    v_mfma_f32_16x16x32_bf16 v[52:55], a[244:247], v[92:95], v[52:55]
    s_cbranch_vccnz L_rompt_kernel_d32
L_rompt_kernel_d32r:
    v_mfma_f32_16x16x32_bf16 v[56:59], a[248:251], v[92:95], v[56:59]
    s_add_u32 s23, s81, 1966080
    v_mfma_f32_16x16x32_bf16 v[60:63], a[252:255], v[92:95], v[60:63]
    buffer_load_dwordx4 v[88:91], v246, s[48:51], s23 offen sc1
    v_mfma_f32_16x16x32_bf16 v[68:71], a[0:3], v[96:99], 0
    s_add_u32 s23, s82, 1966080
    v_mfma_f32_16x16x32_bf16 v[72:75], a[4:7], v[96:99], 0
    v_mfma_f32_16x16x32_bf16 v[76:79], a[8:11], v[96:99], 0
    buffer_load_dwordx4 v[92:95], v246, s[48:51], s23 offen sc1
    v_mfma_f32_16x16x32_bf16 v[80:83], a[12:15], v[96:99], 0
    v_mfma_f32_16x16x32_bf16 v[68:71], a[16:19], v[100:103], v[68:71]
    s_add_u32 s23, s83, 1966080
    v_mfma_f32_16x16x32_bf16 v[72:75], a[20:23], v[100:103], v[72:75]
    v_mfma_f32_16x16x32_bf16 v[76:79], a[24:27], v[100:103], v[76:79]
    buffer_load_dwordx4 v[96:99], v246, s[48:51], s23 offen sc1
    v_mfma_f32_16x16x32_bf16 v[80:83], a[28:31], v[100:103], v[80:83]
    v_mfma_f32_16x16x32_bf16 v[68:71], a[32:35], v[104:107], v[68:71]
    buffer_load_dwordx4 v[100:103], v243, s[48:51], s80 offen sc1
    v_mfma_f32_16x16x32_bf16 v[72:75], a[36:39], v[104:107], v[72:75]
    v_mfma_f32_16x16x32_bf16 v[76:79], a[40:43], v[104:107], v[76:79]
    ds_write_b128 v229, v[48:51] offset:0
    v_mfma_f32_16x16x32_bf16 v[80:83], a[44:47], v[104:107], v[80:83]
    v_mfma_f32_16x16x32_bf16 v[68:71], a[48:51], v[108:111], v[68:71]
    s_waitcnt vmcnt(9)
    v_max3_u32 v6, v115, v119, v123
    v_max_u32 v6, v6, v127
    v_cmp_eq_u32 vcc, -1, v6
    v_mfma_f32_16x16x32_bf16 v[72:75], a[52:55], v[108:111], v[72:75]
    s_cbranch_vccnz L_rompt_kernel_d36
L_rompt_kernel_d36r:
    v_mfma_f32_16x16x32_bf16 v[76:79], a[56:59], v[108:111], v[76:79]
    buffer_load_dwordx4 v[104:107], v243, s[48:51], s81 offen sc1
    v_mfma_f32_16x16x32_bf16 v[80:83], a[60:63], v[108:111], v[80:83]
    ds_write_b128 v229, v[52:55] offset:1024
    v_mfma_f32_16x16x32_bf16 v[68:71], a[64:67], v[112:115], v[68:71]
    buffer_load_dwordx4 v[108:111], v243, s[48:51], s82 offen sc1
    v_mfma_f32_16x16x32_bf16 v[72:75], a[68:71], v[112:115], v[72:75]
    v_mfma_f32_16x16x32_bf16 v[76:79], a[72:75], v[112:115], v[76:79]
    ds_write_b128 v229, v[56:59] offset:2048
    v_mfma_f32_16x16x32_bf16 v[80:83], a[76:79], v[112:115], v[80:83]
    v_mfma_f32_16x16x32_bf16 v[68:71], a[80:83], v[116:119], v[68:71]
    buffer_load_dwordx4 v[112:115], v243, s[48:51], s83 offen sc1
    v_mfma_f32_16x16x32_bf16 v[72:75], a[84:87], v[116:119], v[72:75]
    v_mfma_f32_16x16x32_bf16 v[76:79], a[88:91], v[116:119], v[76:79]
    ds_write_b128 v229, v[60:63] offset:3072
    v_mfma_f32_16x16x32_bf16 v[80:83], a[92:95], v[116:119], v[80:83]
    v_mfma_f32_16x16x32_bf16 v[68:71], a[96:99], v[120:123], v[68:71]
    s_add_u32 s23, s80, 655360
    v_mfma_f32_16x16x32_bf16 v[72:75], a[100:103], v[120:123], v[72:75]
    v_mfma_f32_16x16x32_bf16 v[76:79], a[104:107], v[120:123], v[76:79]
    buffer_load_dwordx4 v[116:119], v243, s[48:51], s23 offen sc1
    v_mfma_f32_16x16x32_bf16 v[80:83], a[108:111], v[120:123], v[80:83]
    v_mfma_f32_16x16x32_bf16 v[68:71], a[112:115], v[124:127], v[68:71]
    s_waitcnt vmcnt(9)
    v_max3_u32 v6, v131, v135, v139
    v_max_u32 v6, v6, v143
    v_cmp_eq_u32 vcc, -1, v6
    v_mfma_f32_16x16x32_bf16 v[72:75], a[116:119], v[124:127], v[72:75]
    s_cbranch_vccnz L_rompt_kernel_d40
L_rompt_kernel_d40r:
    v_mfma_f32_16x16x32_bf16 v[76:79], a[120:123], v[124:127], v[76:79]
    s_add_u32 s23, s81, 655360
    v_mfma_f32_16x16x32_bf16 v[80:83], a[124:127], v[124:127], v[80:83]
    buffer_load_dwordx4 v[120:123], v243, s[48:51], s23 offen sc1
    v_mfma_f32_16x16x32_bf16 v[68:71], a[128:131], v[128:131], v[68:71]
    s_add_u32 s23, s82, 655360
    v_mfma_f32_16x16x32_bf16 v[72:75], a[132:135], v[128:131], v[72:75]
    v_mfma_f32_16x16x32_bf16 v[76:79], a[136:139], v[128:131], v[76:79]
    buffer_load_dwordx4 v[124:127], v243, s[48:51], s23 offen sc1
    v_mfma_f32_16x16x32_bf16 v[80:83], a[140:143], v[128:131], v[80:83]
    v_mfma_f32_16x16x32_bf16 v[68:71], a[144:147], v[132:135], v[68:71]
    s_add_u32 s23, s83, 655360
    v_mfma_f32_16x16x32_bf16 v[72:75], a[148:151], v[132:135], v[72:75]
    v_mfma_f32_16x16x32_bf16 v[76:79], a[152:155], v[132:135], v[76:79]
    buffer_load_dwordx4 v[128:131], v243, s[48:51], s23 offen sc1
    v_mfma_f32_16x16x32_bf16 v[80:83], a[156:159], v[132:135], v[80:83]
    v_mfma_f32_16x16x32_bf16 v[68:71], a[160:163], v[136:139], v[68:71]
    s_add_u32 s23, s80, 1310720
    v_mfma_f32_16x16x32_bf16 v[72:75], a[164:167], v[136:139], v[72:75]
    v_mfma_f32_16x16x32_bf16 v[76:79], a[168:171], v[136:139], v[76:79]
    buffer_load_dwordx4 v[132:135], v243, s[48:51], s23 offen sc1
    v_mfma_f32_16x16x32_bf16 v[80:83], a[172:175], v[136:139], v[80:83]
    v_mfma_f32_16x16x32_bf16 v[68:71], a[176:179], v[140:143], v[68:71]
    s_waitcnt vmcnt(9)
    v_max3_u32 v6, v147, v91, v95
    v_max_u32 v6, v6, v99
    v_cmp_eq_u32 vcc, -1, v6
    v_mfma_f32_16x16x32_bf16 v[72:75], a[180:183], v[140:143], v[72:75]
    s_cbranch_vccnz L_rompt_kernel_d44
L_rompt_kernel_d44r:
    v_mfma_f32_16x16x32_bf16 v[76:79], a[184:187], v[140:143], v[76:79]
    s_add_u32 s23, s81, 1310720
    v_mfma_f32_16x16x32_bf16 v[80:83], a[188:191], v[140:143], v[80:83]
    buffer_load_dwordx4 v[136:139], v243, s[48:51], s23 offen sc1
    v_mfma_f32_16x16x32_bf16 v[68:71], a[192:195], v[144:147], v[68:71]
    s_add_u32 s23, s82, 1310720
    v_mfma_f32_16x16x32_bf16 v[72:75], a[196:199], v[144:147], v[72:75]
    v_mfma_f32_16x16x32_bf16 v[76:79], a[200:203], v[144:147], v[76:79]
    buffer_load_dwordx4 v[140:143], v243, s[48:51], s23 offen sc1
    v_mfma_f32_16x16x32_bf16 v[80:83], a[204:207], v[144:147], v[80:83]
    v_mfma_f32_16x16x32_bf16 v[68:71], a[208:211], v[88:91], v[68:71]
    s_add_u32 s23, s83, 1310720
    v_mfma_f32_16x16x32_bf16 v[72:75], a[212:215], v[88:91], v[72:75]
    v_mfma_f32_16x16x32_bf16 v[76:79], a[216:219], v[88:91], v[76:79]
    buffer_load_dwordx4 v[144:147], v243, s[48:51], s23 offen sc1
    v_mfma_f32_16x16x32_bf16 v[80:83], a[220:223], v[88:91], v[80:83]
    v_mfma_f32_16x16x32_bf16 v[68:71], a[224:227], v[92:95], v[68:71]
    s_add_u32 s23, s80, 1966080
    v_mfma_f32_16x16x32_bf16 v[72:75], a[228:231], v[92:95], v[72:75]
    v_mfma_f32_16x16x32_bf16 v[76:79], a[232:235], v[92:95], v[76:79]
    buffer_load_dwordx4 v[88:91], v243, s[48:51], s23 offen sc1
    v_mfma_f32_16x16x32_bf16 v[80:83], a[236:239], v[92:95], v[80:83]
    v_mfma_f32_16x16x32_bf16 v[68:71], a[240:243], v[96:99], v[68:71]
    s_waitcnt vmcnt(9)
    v_max3_u32 v6, v103, v107, v111
    v_max_u32 v6, v6, v115
    v_cmp_eq_u32 vcc, -1, v6
    v_mfma_f32_16x16x32_bf16 v[72:75], a[244:247], v[96:99], v[72:75]
    s_cbranch_vccnz L_rompt_kernel_d48
L_rompt_kernel_d48r:
    v_mfma_f32_16x16x32_bf16 v[76:79], a[248:251], v[96:99], v[76:79]
    s_add_u32 s23, s81, 1966080
    v_mfma_f32_16x16x32_bf16 v[80:83], a[252:255], v[96:99], v[80:83]
    buffer_load_dwordx4 v[92:95], v243, s[48:51], s23 offen sc1
    v_mfma_f32_16x16x32_bf16 v[8:11], a[0:3], v[100:103], 0
    s_add_u32 s23, s82, 1966080
    v_mfma_f32_16x16x32_bf16 v[12:15], a[4:7], v[100:103], 0
    v_mfma_f32_16x16x32_bf16 v[16:19], a[8:11], v[100:103], 0
    buffer_load_dwordx4 v[96:99], v243, s[48:51], s23 offen sc1
    v_mfma_f32_16x16x32_bf16 v[20:23], a[12:15], v[100:103], 0
    v_mfma_f32_16x16x32_bf16 v[8:11], a[16:19], v[104:107], v[8:11]
    s_add_u32 s23, s83, 1966080
    buffer_load_dwordx4 v[100:103], v243, s[48:51], s23 offen sc1
    ds_read_b64_tr_b16 a[0:1], v224 offset:32768
    v_mfma_f32_16x16x32_bf16 v[12:15], a[20:23], v[104:107], v[12:15]
    ds_read_b64_tr_b16 a[2:3], v224 offset:34816
    ds_read_b64_tr_b16 a[4:5], v225 offset:32768
    v_mfma_f32_16x16x32_bf16 v[16:19], a[24:27], v[104:107], v[16:19]
    ds_read_b64_tr_b16 a[6:7], v225 offset:34816
    ds_read_b64_tr_b16 a[8:9], v226 offset:32768
    ds_read_b64_tr_b16 a[10:11], v226 offset:34816
    v_mfma_f32_16x16x32_bf16 v[20:23], a[28:31], v[104:107], v[20:23]
    ds_read_b64_tr_b16 a[12:13], v227 offset:32768
    ds_read_b64_tr_b16 a[14:15], v227 offset:34816
    v_mfma_f32_16x16x32_bf16 v[8:11], a[32:35], v[108:111], v[8:11]
    ds_write_b128 v230, v[68:71] offset:0
    ds_read_b64_tr_b16 a[16:17], v224 offset:49152
    ds_read_b64_tr_b16 a[18:19], v224 offset:51200
    v_mfma_f32_16x16x32_bf16 v[12:15], a[36:39], v[108:111], v[12:15]
    ds_read_b64_tr_b16 a[20:21], v225 offset:49152
    ds_read_b64_tr_b16 a[22:23], v225 offset:51200
    v_mfma_f32_16x16x32_bf16 v[16:19], a[40:43], v[108:111], v[16:19]
    ds_read_b64_tr_b16 a[24:25], v226 offset:49152
    ds_read_b64_tr_b16 a[26:27], v226 offset:51200
    v_mfma_f32_16x16x32_bf16 v[20:23], a[44:47], v[108:111], v[20:23]
    ds_read_b64_tr_b16 a[28:29], v227 offset:49152
    ds_read_b64_tr_b16 a[30:31], v227 offset:51200
    v_mfma_f32_16x16x32_bf16 v[8:11], a[48:51], v[112:115], v[8:11]
    s_waitcnt vmcnt(8)
    v_max3_u32 v6, v119, v123, v127
    v_max_u32 v6, v6, v131
    v_cmp_eq_u32 vcc, -1, v6
    v_mfma_f32_16x16x32_bf16 v[12:15], a[52:55], v[112:115], v[12:15]
    s_cbranch_vccnz L_rompt_kernel_d52
L_rompt_kernel_d52r:
    v_mfma_f32_16x16x32_bf16 v[16:19], a[56:59], v[112:115], v[16:19]
    ds_write_b128 v230, v[72:75] offset:1024
    v_mfma_f32_16x16x32_bf16 v[20:23], a[60:63], v[112:115], v[20:23]
    v_mfma_f32_16x16x32_bf16 v[8:11], a[64:67], v[116:119], v[8:11]
    ds_write_b128 v230, v[76:79] offset:2048
    v_mfma_f32_16x16x32_bf16 v[12:15], a[68:71], v[116:119], v[12:15]
    v_mfma_f32_16x16x32_bf16 v[16:19], a[72:75], v[116:119], v[16:19]
    v_mfma_f32_16x16x32_bf16 v[20:23], a[76:79], v[116:119], v[20:23]
    v_mfma_f32_16x16x32_bf16 v[8:11], a[80:83], v[120:123], v[8:11]
    ds_write_b128 v230, v[80:83] offset:3072
    v_mfma_f32_16x16x32_bf16 v[12:15], a[84:87], v[120:123], v[12:15]
    v_mfma_f32_16x16x32_bf16 v[16:19], a[88:91], v[120:123], v[16:19]
    v_mfma_f32_16x16x32_bf16 v[20:23], a[92:95], v[120:123], v[20:23]
    v_mfma_f32_16x16x32_bf16 v[8:11], a[96:99], v[124:127], v[8:11]
    v_mfma_f32_16x16x32_bf16 v[12:15], a[100:103], v[124:127], v[12:15]
    v_mfma_f32_16x16x32_bf16 v[16:19], a[104:107], v[124:127], v[16:19]
    v_mfma_f32_16x16x32_bf16 v[20:23], a[108:111], v[124:127], v[20:23]
    s_waitcnt lgkmcnt(0)
    s_barrier
    v_mfma_f32_16x16x32_bf16 v[8:11], a[112:115], v[128:131], v[8:11]
    s_waitcnt vmcnt(4)
    v_max3_u32 v6, v135, v139, v143
    v_max_u32 v6, v6, v147
    v_cmp_eq_u32 vcc, -1, v6
    v_mfma_f32_16x16x32_bf16 v[12:15], a[116:119], v[128:131], v[12:15]
    s_cbranch_vccnz L_rompt_kernel_d56
L_rompt_kernel_d56r:
    ds_read_b128 v[28:31], v231 offset:0
    ds_read_b128 v[32:35], v231 offset:1024
    ds_read_b128 v[36:39], v231 offset:2048
    ds_read_b128 v[40:43], v231 offset:3072
    ds_read_b128 v[48:51], v231 offset:5120
    v_mfma_f32_16x16x32_bf16 v[16:19], a[120:123], v[128:131], v[16:19]
    ds_read_b128 v[52:55], v231 offset:6144
    ds_read_b128 v[56:59], v231 offset:7168
    ds_read_b128 v[60:63], v231 offset:8192
    ds_read_b128 v[68:71], v231 offset:10240
    s_add_u32 m0, s15, 0
    v_mfma_f32_16x16x32_bf16 v[20:23], a[124:127], v[128:131], v[20:23]
    s_nop 0
    buffer_load_dwordx4 v220, s[44:47], s86 offen offset:0 lds
    buffer_load_dwordx4 v221, s[44:47], s86 offen offset:1024 lds
    buffer_load_dwordx4 v222, s[44:47], s86 offen offset:2048 lds
    buffer_load_dwordx4 v223, s[44:47], s86 offen offset:3072 lds
    v_mfma_f32_16x16x32_bf16 v[8:11], a[128:131], v[132:135], v[8:11]
    ds_read_b128 v[72:75], v231 offset:11264
    ds_read_b128 v[76:79], v231 offset:12288
    ds_read_b128 v[80:83], v231 offset:13312
    v_mfma_f32_16x16x32_bf16 v[12:15], a[132:135], v[132:135], v[12:15]
    s_waitcnt lgkmcnt(8)
    v_add_f32 v172, v172, v28
    v_mfma_f32_16x16x32_bf16 v[16:19], a[136:139], v[132:135], v[16:19]
    v_add_f32 v173, v173, v29
    v_add_f32 v174, v174, v30
    v_mfma_f32_16x16x32_bf16 v[20:23], a[140:143], v[132:135], v[20:23]
    v_add_f32 v175, v175, v31
    v_add_f32 v176, v176, v32
    v_mfma_f32_16x16x32_bf16 v[8:11], a[144:147], v[136:139], v[8:11]
    v_add_f32 v177, v177, v33
    v_add_f32 v178, v178, v34
    v_add_f32 v179, v179, v35
    v_add_f32 v180, v180, v36
    v_mfma_f32_16x16x32_bf16 v[12:15], a[148:151], v[136:139], v[12:15]
    v_add_f32 v181, v181, v37
    v_add_f32 v182, v182, v38
    v_add_f32 v183, v183, v39
    v_add_f32 v184, v184, v40
    v_mfma_f32_16x16x32_bf16 v[16:19], a[152:155], v[136:139], v[16:19]
    v_add_f32 v185, v185, v41
    s_add_u32 m0, s15, 16384
    s_nop 0
    buffer_load_dwordx4 v220, s[44:47], s90 offen offset:0 lds
    v_mfma_f32_16x16x32_bf16 v[20:23], a[156:159], v[136:139], v[20:23]
    buffer_load_dwordx4 v221, s[44:47], s90 offen offset:1024 lds
    buffer_load_dwordx4 v222, s[44:47], s90 offen offset:2048 lds
    buffer_load_dwordx4 v223, s[44:47], s90 offen offset:3072 lds
    v_mfma_f32_16x16x32_bf16 v[8:11], a[160:163], v[140:143], v[8:11]
    v_add_f32 v186, v186, v42
    v_add_f32 v187, v187, v43
    s_waitcnt lgkmcnt(4)
    v_mfma_f32_16x16x32_bf16 v[12:15], a[164:167], v[140:143], v[12:15]
    v_add_f32 v172, v172, v48
    v_add_f32 v173, v173, v49
    v_mfma_f32_16x16x32_bf16 v[16:19], a[168:171], v[140:143], v[16:19]
    v_add_f32 v174, v174, v50
    v_add_f32 v175, v175, v51
    v_mfma_f32_16x16x32_bf16 v[20:23], a[172:175], v[140:143], v[20:23]
    v_add_f32 v176, v176, v52
    v_add_f32 v177, v177, v53
    v_mfma_f32_16x16x32_bf16 v[8:11], a[176:179], v[144:147], v[8:11]
    s_waitcnt vmcnt(8)
    v_max3_u32 v6, v91, v95, v99
    v_max_u32 v6, v6, v103
    v_cmp_eq_u32 vcc, -1, v6
    v_mfma_f32_16x16x32_bf16 v[12:15], a[180:183], v[144:147], v[12:15]
    s_cbranch_vccnz L_rompt_kernel_d60
L_rompt_kernel_d60r:
    v_add_f32 v178, v178, v54
    v_add_f32 v179, v179, v55
    v_add_f32 v180, v180, v56
    v_add_f32 v181, v181, v57
    v_add_f32 v182, v182, v58
    v_mfma_f32_16x16x32_bf16 v[16:19], a[184:187], v[144:147], v[16:19]
    v_add_f32 v183, v183, v59
    v_add_f32 v184, v184, v60
    v_add_f32 v185, v185, v61
    v_add_f32 v186, v186, v62
    s_add_u32 m0, s15, 32768
    v_mfma_f32_16x16x32_bf16 v[20:23], a[188:191], v[144:147], v[20:23]
    s_add_u32 s24, s84, 2097152
    buffer_load_dwordx4 v220, s[44:47], s24 offen offset:0 lds
    buffer_load_dwordx4 v221, s[44:47], s24 offen offset:1024 lds
    buffer_load_dwordx4 v222, s[44:47], s24 offen offset:2048 lds
    buffer_load_dwordx4 v223, s[44:47], s24 offen offset:3072 lds
    v_mfma_f32_16x16x32_bf16 v[8:11], a[192:195], v[88:91], v[8:11]
    v_add_f32 v187, v187, v63
    s_waitcnt lgkmcnt(0)
    v_add_f32 v172, v172, v68
    v_mfma_f32_16x16x32_bf16 v[12:15], a[196:199], v[88:91], v[12:15]
    v_add_f32 v173, v173, v69
    v_add_f32 v174, v174, v70
    v_mfma_f32_16x16x32_bf16 v[16:19], a[200:203], v[88:91], v[16:19]
    v_add_f32 v175, v175, v71
    v_add_f32 v176, v176, v72
    v_mfma_f32_16x16x32_bf16 v[20:23], a[204:207], v[88:91], v[20:23]
    v_add_f32 v177, v177, v73
    v_add_f32 v178, v178, v74
    v_mfma_f32_16x16x32_bf16 v[8:11], a[208:211], v[92:95], v[8:11]
    v_add_f32 v179, v179, v75
    v_add_f32 v180, v180, v76
    v_add_f32 v181, v181, v77
    v_add_f32 v182, v182, v78
    v_mfma_f32_16x16x32_bf16 v[12:15], a[212:215], v[92:95], v[12:15]
    v_add_f32 v183, v183, v79
    v_add_f32 v184, v184, v80
    v_add_f32 v185, v185, v81
    v_add_f32 v186, v186, v82
    v_mfma_f32_16x16x32_bf16 v[16:19], a[216:219], v[92:95], v[16:19]
    v_add_f32 v187, v187, v83
    s_add_u32 m0, s15, 49152
    s_add_u32 s24, s85, 2097152
    buffer_load_dwordx4 v220, s[44:47], s24 offen offset:0 lds
    v_mfma_f32_16x16x32_bf16 v[20:23], a[220:223], v[92:95], v[20:23]
    buffer_load_dwordx4 v221, s[44:47], s24 offen offset:1024 lds
    buffer_load_dwordx4 v222, s[44:47], s24 offen offset:2048 lds
    buffer_load_dwordx4 v223, s[44:47], s24 offen offset:3072 lds
    v_mfma_f32_16x16x32_bf16 v[8:11], a[224:227], v[96:99], v[8:11]
    v_mfma_f32_16x16x32_bf16 v[12:15], a[228:231], v[96:99], v[12:15]
    v_mfma_f32_16x16x32_bf16 v[16:19], a[232:235], v[96:99], v[16:19]
    v_mfma_f32_16x16x32_bf16 v[20:23], a[236:239], v[96:99], v[20:23]
    v_mfma_f32_16x16x32_bf16 v[8:11], a[240:243], v[100:103], v[8:11]
    v_mfma_f32_16x16x32_bf16 v[12:15], a[244:247], v[100:103], v[12:15]
    v_mfma_f32_16x16x32_bf16 v[16:19], a[248:251], v[100:103], v[16:19]
    v_mfma_f32_16x16x32_bf16 v[20:23], a[252:255], v[100:103], v[20:23]
    s_lshl_b32 s24, s70, 7
    s_add_u32 s24, s24, 16841472
    s_cmp_eq_u32 s14, 0
    s_cselect_b32 s24, s24, 1073741824
    v_mul_u32_u24 v1, 1280, v0
    v_mov_b32 v2, 1
    s_mov_b64 exec, 255
    buffer_atomic_add v2, v1, s[48:51], s24 offen sc1
    s_mov_b64 exec, -1
    s_nop 7
    v_pk_add_f32 v[8:9], v[8:9], v[172:173]
    v_pk_add_f32 v[10:11], v[10:11], v[174:175]
    v_pk_add_f32 v[12:13], v[12:13], v[176:177]
    v_pk_add_f32 v[14:15], v[14:15], v[178:179]
    v_pk_mul_f32 v[28:29], v[8:9], v[8:9]
    v_pk_mul_f32 v[30:31], v[10:11], v[10:11]
    v_pk_mul_f32 v[32:33], v[12:13], v[12:13]
    v_pk_mul_f32 v[34:35], v[14:15], v[14:15]
    v_fma_f32 v28, v28, s58, v7
    v_fma_f32 v29, v29, s58, v7
    v_fma_f32 v30, v30, s58, v7
    v_fma_f32 v31, v31, s58, v7
    v_fma_f32 v32, v32, s58, v7
    v_fma_f32 v33, v33, s58, v7
    v_fma_f32 v34, v34, s58, v7
    v_fma_f32 v35, v35, s58, v7
    v_pk_mul_f32 v[28:29], v[28:29], v[8:9]
    v_pk_mul_f32 v[30:31], v[30:31], v[10:11]
    v_pk_mul_f32 v[32:33], v[32:33], v[12:13]
    v_pk_mul_f32 v[34:35], v[34:35], v[14:15]
    v_exp_f32 v28, v28
    v_exp_f32 v29, v29
    v_exp_f32 v30, v30
    v_exp_f32 v31, v31
    v_exp_f32 v32, v32
    v_exp_f32 v33, v33
    v_exp_f32 v34, v34
    v_exp_f32 v35, v35
    v_pk_add_f32 v[28:29], v[28:29], 1.0 op_sel_hi:[1,0]
    v_pk_add_f32 v[30:31], v[30:31], 1.0 op_sel_hi:[1,0]
    v_pk_add_f32 v[32:33], v[32:33], 1.0 op_sel_hi:[1,0]
    v_pk_add_f32 v[34:35], v[34:35], 1.0 op_sel_hi:[1,0]
    v_rcp_f32 v28, v28
    v_rcp_f32 v29, v29
    v_rcp_f32 v30, v30
    v_rcp_f32 v31, v31
    v_rcp_f32 v32, v32
    v_rcp_f32 v33, v33
    v_rcp_f32 v34, v34
    v_rcp_f32 v35, v35
    s_nop 0
    v_pk_mul_f32 v[8:9], v[8:9], v[28:29]
    v_pk_mul_f32 v[10:11], v[10:11], v[30:31]
    v_pk_mul_f32 v[12:13], v[12:13], v[32:33]
    v_pk_mul_f32 v[14:15], v[14:15], v[34:35]
    v_cvt_pk_bf16_f32 v48, v8, v9
    v_cvt_pk_bf16_f32 v49, v10, v11
    v_cvt_pk_bf16_f32 v50, v12, v13
    v_cvt_pk_bf16_f32 v51, v14, v15
    v_min_u32 v51, -2, v51
    buffer_store_dwordx4 v[48:51], v242, s[48:51], 0 offen sc1
    v_pk_add_f32 v[16:17], v[16:17], v[180:181]
    v_pk_add_f32 v[18:19], v[18:19], v[182:183]
    v_pk_add_f32 v[20:21], v[20:21], v[184:185]
    v_pk_add_f32 v[22:23], v[22:23], v[186:187]
    v_pk_mul_f32 v[36:37], v[16:17], v[16:17]
    v_pk_mul_f32 v[38:39], v[18:19], v[18:19]
    v_pk_mul_f32 v[40:41], v[20:21], v[20:21]
    v_pk_mul_f32 v[42:43], v[22:23], v[22:23]
    v_fma_f32 v36, v36, s58, v7
    v_fma_f32 v37, v37, s58, v7
    v_fma_f32 v38, v38, s58, v7
    v_fma_f32 v39, v39, s58, v7
    v_fma_f32 v40, v40, s58, v7
    v_fma_f32 v41, v41, s58, v7
    v_fma_f32 v42, v42, s58, v7
    v_fma_f32 v43, v43, s58, v7
    v_pk_mul_f32 v[36:37], v[36:37], v[16:17]
    v_pk_mul_f32 v[38:39], v[38:39], v[18:19]
    v_pk_mul_f32 v[40:41], v[40:41], v[20:21]
    v_pk_mul_f32 v[42:43], v[42:43], v[22:23]
    v_exp_f32 v36, v36
    v_exp_f32 v37, v37
    v_exp_f32 v38, v38
    v_exp_f32 v39, v39
    v_exp_f32 v40, v40
    v_exp_f32 v41, v41
    v_exp_f32 v42, v42
    v_exp_f32 v43, v43
    v_pk_add_f32 v[36:37], v[36:37], 1.0 op_sel_hi:[1,0]
    v_pk_add_f32 v[38:39], v[38:39], 1.0 op_sel_hi:[1,0]
    v_pk_add_f32 v[40:41], v[40:41], 1.0 op_sel_hi:[1,0]
    v_pk_add_f32 v[42:43], v[42:43], 1.0 op_sel_hi:[1,0]
    v_rcp_f32 v36, v36
    v_rcp_f32 v37, v37
    v_rcp_f32 v38, v38
    v_rcp_f32 v39, v39
    v_rcp_f32 v40, v40
    v_rcp_f32 v41, v41
    v_rcp_f32 v42, v42
    v_rcp_f32 v43, v43
    s_nop 0
    v_pk_mul_f32 v[16:17], v[16:17], v[36:37]
    v_pk_mul_f32 v[18:19], v[18:19], v[38:39]
    v_pk_mul_f32 v[20:21], v[20:21], v[40:41]
    v_pk_mul_f32 v[22:23], v[22:23], v[42:43]
    v_cvt_pk_bf16_f32 v52, v16, v17
    v_cvt_pk_bf16_f32 v53, v18, v19
    v_cvt_pk_bf16_f32 v54, v20, v21
    v_cvt_pk_bf16_f32 v55, v22, v23
    v_min_u32 v55, -2, v55
    buffer_store_dwordx4 v[52:55], v242, s[48:51], s61 offen sc1
    s_add_u32 s21, s18, 0
    s_and_b32 s21, s21, 15
    s_mul_i32 s80, s21, 40960
    s_add_u32 s21, s18, 4
    s_and_b32 s21, s21, 15
    s_mul_i32 s81, s21, 40960
    s_add_u32 s21, s18, 8
    s_and_b32 s21, s21, 15
    s_mul_i32 s82, s21, 40960
    s_add_u32 s21, s18, 12
    s_and_b32 s21, s21, 15
    s_mul_i32 s83, s21, 40960
    s_waitcnt vmcnt(15)
    ds_read_b64_tr_b16 a[32:33], v224 offset:0
    ds_read_b64_tr_b16 a[34:35], v224 offset:2048
    ds_read_b64_tr_b16 a[36:37], v225 offset:0
    ds_read_b64_tr_b16 a[38:39], v225 offset:2048
    ds_read_b64_tr_b16 a[40:41], v226 offset:0
    ds_read_b64_tr_b16 a[42:43], v226 offset:2048
    ds_read_b64_tr_b16 a[44:45], v227 offset:0
    ds_read_b64_tr_b16 a[46:47], v227 offset:2048
    s_waitcnt lgkmcnt(0)
    s_add_u32 m0, s15, 0
    s_add_u32 s24, s86, 2097152
    buffer_load_dwordx4 v220, s[44:47], s24 offen offset:0 lds
    buffer_load_dwordx4 v221, s[44:47], s24 offen offset:1024 lds
    buffer_load_dwordx4 v222, s[44:47], s24 offen offset:2048 lds
    buffer_load_dwordx4 v223, s[44:47], s24 offen offset:3072 lds
    s_waitcnt vmcnt(15)
    ds_read_b64_tr_b16 a[48:49], v224 offset:16384
    ds_read_b64_tr_b16 a[50:51], v224 offset:18432
    ds_read_b64_tr_b16 a[52:53], v225 offset:16384
    ds_read_b64_tr_b16 a[54:55], v225 offset:18432
    ds_read_b64_tr_b16 a[56:57], v226 offset:16384
    ds_read_b64_tr_b16 a[58:59], v226 offset:18432
    ds_read_b64_tr_b16 a[60:61], v227 offset:16384
    ds_read_b64_tr_b16 a[62:63], v227 offset:18432
    s_waitcnt lgkmcnt(0)
    s_add_u32 m0, s15, 16384
    s_add_u32 s24, s90, 2097152
    buffer_load_dwordx4 v220, s[44:47], s24 offen offset:0 lds
    buffer_load_dwordx4 v221, s[44:47], s24 offen offset:1024 lds
    buffer_load_dwordx4 v222, s[44:47], s24 offen offset:2048 lds
    buffer_load_dwordx4 v223, s[44:47], s24 offen offset:3072 lds
    s_sub_u32 s22, s75, s74
    v_mul_u32_u24 v5, s22, v0
    v_add_lshl_u32 v5, v5, s74, 7
    s_mul_i32 s43, s16, 1280
    s_add_u32 s43, s43, 16841472
    s_cmp_eq_u32 s14, 1
    s_cselect_b32 s43, s43, 1073741824
    v_mov_b32 v4, 0
    s_mov_b64 exec, 3
    buffer_atomic_add v4, v5, s[8:11], s43 offen sc0 sc1
    s_mov_b64 exec, -1
    s_waitcnt vmcnt(16)
    ds_read_b64_tr_b16 a[64:65], v224 offset:32768
    ds_read_b64_tr_b16 a[66:67], v224 offset:34816
    ds_read_b64_tr_b16 a[68:69], v225 offset:32768
    ds_read_b64_tr_b16 a[70:71], v225 offset:34816
    ds_read_b64_tr_b16 a[72:73], v226 offset:32768
    ds_read_b64_tr_b16 a[74:75], v226 offset:34816
    ds_read_b64_tr_b16 a[76:77], v227 offset:32768
    ds_read_b64_tr_b16 a[78:79], v227 offset:34816
    s_waitcnt lgkmcnt(0)
    s_add_u32 m0, s15, 32768
    s_add_u32 s24, s84, 4194304
    buffer_load_dwordx4 v220, s[44:47], s24 offen offset:0 lds
    buffer_load_dwordx4 v221, s[44:47], s24 offen offset:1024 lds
    buffer_load_dwordx4 v222, s[44:47], s24 offen offset:2048 lds
    buffer_load_dwordx4 v223, s[44:47], s24 offen offset:3072 lds
    s_waitcnt vmcnt(16)
    ds_read_b64_tr_b16 a[80:81], v224 offset:49152
    ds_read_b64_tr_b16 a[82:83], v224 offset:51200
    ds_read_b64_tr_b16 a[84:85], v225 offset:49152
    ds_read_b64_tr_b16 a[86:87], v225 offset:51200
    ds_read_b64_tr_b16 a[88:89], v226 offset:49152
    ds_read_b64_tr_b16 a[90:91], v226 offset:51200
    ds_read_b64_tr_b16 a[92:93], v227 offset:49152
    ds_read_b64_tr_b16 a[94:95], v227 offset:51200
    s_waitcnt lgkmcnt(0)
    s_add_u32 m0, s15, 49152
    s_add_u32 s24, s85, 4194304
    buffer_load_dwordx4 v220, s[44:47], s24 offen offset:0 lds
    buffer_load_dwordx4 v221, s[44:47], s24 offen offset:1024 lds
    buffer_load_dwordx4 v222, s[44:47], s24 offen offset:2048 lds
    buffer_load_dwordx4 v223, s[44:47], s24 offen offset:3072 lds
    s_waitcnt vmcnt(13)
    ds_read_b64_tr_b16 a[96:97], v224 offset:0
    ds_read_b64_tr_b16 a[98:99], v224 offset:2048
    ds_read_b64_tr_b16 a[100:101], v225 offset:0
    ds_read_b64_tr_b16 a[102:103], v225 offset:2048
    ds_read_b64_tr_b16 a[104:105], v226 offset:0
    ds_read_b64_tr_b16 a[106:107], v226 offset:2048
    ds_read_b64_tr_b16 a[108:109], v227 offset:0
    ds_read_b64_tr_b16 a[110:111], v227 offset:2048
    s_waitcnt lgkmcnt(0)
    s_add_u32 m0, s15, 0
    s_add_u32 s24, s86, 4194304
    buffer_load_dwordx4 v220, s[44:47], s24 offen offset:0 lds
    buffer_load_dwordx4 v221, s[44:47], s24 offen offset:1024 lds
    buffer_load_dwordx4 v222, s[44:47], s24 offen offset:2048 lds
    buffer_load_dwordx4 v223, s[44:47], s24 offen offset:3072 lds
    s_waitcnt vmcnt(13)
    ds_read_b64_tr_b16 a[112:113], v224 offset:16384
    ds_read_b64_tr_b16 a[114:115], v224 offset:18432
    ds_read_b64_tr_b16 a[116:117], v225 offset:16384
    ds_read_b64_tr_b16 a[118:119], v225 offset:18432
    ds_read_b64_tr_b16 a[120:121], v226 offset:16384
    ds_read_b64_tr_b16 a[122:123], v226 offset:18432
    ds_read_b64_tr_b16 a[124:125], v227 offset:16384
    ds_read_b64_tr_b16 a[126:127], v227 offset:18432
    s_waitcnt lgkmcnt(0)
    s_add_u32 m0, s15, 16384
    s_add_u32 s24, s90, 4194304
    buffer_load_dwordx4 v220, s[44:47], s24 offen offset:0 lds
    buffer_load_dwordx4 v221, s[44:47], s24 offen offset:1024 lds
    buffer_load_dwordx4 v222, s[44:47], s24 offen offset:2048 lds
    buffer_load_dwordx4 v223, s[44:47], s24 offen offset:3072 lds
    s_waitcnt vmcnt(12)
    ds_read_b64_tr_b16 a[128:129], v224 offset:32768
    ds_read_b64_tr_b16 a[130:131], v224 offset:34816
    ds_read_b64_tr_b16 a[132:133], v225 offset:32768
    ds_read_b64_tr_b16 a[134:135], v225 offset:34816
    ds_read_b64_tr_b16 a[136:137], v226 offset:32768
    ds_read_b64_tr_b16 a[138:139], v226 offset:34816
    ds_read_b64_tr_b16 a[140:141], v227 offset:32768
    ds_read_b64_tr_b16 a[142:143], v227 offset:34816
    s_waitcnt vmcnt(8)
    ds_read_b64_tr_b16 a[144:145], v224 offset:49152
    ds_read_b64_tr_b16 a[146:147], v224 offset:51200
    ds_read_b64_tr_b16 a[148:149], v225 offset:49152
    ds_read_b64_tr_b16 a[150:151], v225 offset:51200
    ds_read_b64_tr_b16 a[152:153], v226 offset:49152
    ds_read_b64_tr_b16 a[154:155], v226 offset:51200
    ds_read_b64_tr_b16 a[156:157], v227 offset:49152
    ds_read_b64_tr_b16 a[158:159], v227 offset:51200
    s_cmp_eq_u32 s43, 1073741824
    s_cbranch_scc1 L_rompt_kernel_p2x
    s_mov_b32 s23, 0x200000
    s_mov_b64 exec, 3
L_rompt_kernel_p2:
    v_cmp_gt_u32 vcc, 24, v4
    s_cbranch_vccz L_rompt_kernel_p2y
    s_sub_u32 s23, s23, 1
    s_cbranch_scc1 L_rompt_kernel_p2y
    v_mov_b32 v4, 0
    buffer_atomic_add v4, v5, s[8:11], s43 offen sc0 sc1
    s_waitcnt vmcnt(0)
    s_branch L_rompt_kernel_p2
L_rompt_kernel_p2y:
    s_mov_b64 exec, -1
L_rompt_kernel_p2x:
    s_barrier
    buffer_load_dwordx4 v[88:91], v235, s[8:11], s80 offen offset:0 sc1
    buffer_load_dwordx4 v[92:95], v235, s[8:11], s81 offen offset:0 sc1
    buffer_load_dwordx4 v[96:99], v235, s[8:11], s82 offen offset:0 sc1
    buffer_load_dwordx4 v[100:103], v235, s[8:11], s83 offen offset:0 sc1
    s_add_u32 s23, s80, 655360
    buffer_load_dwordx4 v[104:107], v235, s[8:11], s23 offen offset:0 sc1
    s_add_u32 s23, s81, 655360
    buffer_load_dwordx4 v[108:111], v235, s[8:11], s23 offen offset:0 sc1
    s_add_u32 s23, s82, 655360
    buffer_load_dwordx4 v[112:115], v235, s[8:11], s23 offen offset:0 sc1
    s_add_u32 s23, s83, 655360
    buffer_load_dwordx4 v[116:119], v235, s[8:11], s23 offen offset:0 sc1
    s_add_u32 s23, s80, 1310720
    buffer_load_dwordx4 v[120:123], v235, s[8:11], s23 offen offset:0 sc1
    s_add_u32 s23, s81, 1310720
    buffer_load_dwordx4 v[124:127], v235, s[8:11], s23 offen offset:0 sc1
    s_add_u32 s23, s82, 1310720
    buffer_load_dwordx4 v[128:131], v235, s[8:11], s23 offen offset:0 sc1
    s_add_u32 s23, s83, 1310720
    buffer_load_dwordx4 v[132:135], v235, s[8:11], s23 offen offset:0 sc1
    buffer_load_dwordx4 v[136:139], v235, s[8:11], s80 offen offset:256 sc1
    buffer_load_dwordx4 v[140:143], v235, s[8:11], s81 offen offset:256 sc1
    s_waitcnt vmcnt(18)
    ds_read_b64_tr_b16 a[160:161], v224 offset:0
    ds_read_b64_tr_b16 a[162:163], v224 offset:2048
    ds_read_b64_tr_b16 a[164:165], v225 offset:0
    ds_read_b64_tr_b16 a[166:167], v225 offset:2048
    ds_read_b64_tr_b16 a[168:169], v226 offset:0
    ds_read_b64_tr_b16 a[170:171], v226 offset:2048
    ds_read_b64_tr_b16 a[172:173], v227 offset:0
    ds_read_b64_tr_b16 a[174:175], v227 offset:2048
    s_waitcnt vmcnt(14)
    ds_read_b64_tr_b16 a[176:177], v224 offset:16384
    ds_read_b64_tr_b16 a[178:179], v224 offset:18432
    ds_read_b64_tr_b16 a[180:181], v225 offset:16384
    ds_read_b64_tr_b16 a[182:183], v225 offset:18432
    ds_read_b64_tr_b16 a[184:185], v226 offset:16384
    ds_read_b64_tr_b16 a[186:187], v226 offset:18432
    ds_read_b64_tr_b16 a[188:189], v227 offset:16384
    ds_read_b64_tr_b16 a[190:191], v227 offset:18432
    s_waitcnt lgkmcnt(0)
    s_waitcnt vmcnt(13)
    v_cmp_eq_u32 vcc, -1, v91
    s_cbranch_vccnz L_rompt_kernel_e0
L_rompt_kernel_e0r:
    v_mfma_f32_16x16x32_bf16 v[28:31], v[88:91], a[4:7], 0
    s_waitcnt vmcnt(12)
    v_cmp_eq_u32 vcc, -1, v95
    v_mfma_f32_16x16x32_bf16 v[48:51], v[88:91], a[8:11], 0
    s_cbranch_vccnz L_rompt_kernel_e1
L_rompt_kernel_e1r:
    buffer_load_dwordx4 v[144:147], v235, s[8:11], s82 offen offset:256 sc1
    s_mov_b32 s52, s36
    v_mfma_f32_16x16x32_bf16 v[68:71], v[88:91], a[12:15], 0
    s_mov_b32 s53, s37
    s_mov_b32 s54, 0x280000
    s_mov_b32 s55, 0x00020000
    v_mfma_f32_16x16x32_bf16 v[8:11], v[88:91], a[0:3], 0
    v_lshlrev_b32 v218, 16, v218
    v_add_u32 v3, s42, v233
    v_mfma_f32_16x16x32_bf16 v[28:31], v[92:95], a[20:23], v[28:31]
    s_waitcnt vmcnt(12)
    v_cmp_eq_u32 vcc, -1, v99
    v_mfma_f32_16x16x32_bf16 v[48:51], v[92:95], a[24:27], v[48:51]
    s_cbranch_vccnz L_rompt_kernel_e2
L_rompt_kernel_e2r:
    buffer_load_dwordx4 v[88:91], v235, s[8:11], s83 offen offset:256 sc1
    v_lshlrev_b32 v168, 16, v188
    v_mfma_f32_16x16x32_bf16 v[68:71], v[92:95], a[28:31], v[68:71]
    v_and_b32 v169, s56, v188
    v_add_f32 v168, v168, v218
    v_add_f32 v169, v169, v218
    v_mfma_f32_16x16x32_bf16 v[8:11], v[92:95], a[16:19], v[8:11]
    v_lshlrev_b32 v170, 16, v189
    v_and_b32 v171, s56, v189
    v_mfma_f32_16x16x32_bf16 v[28:31], v[96:99], a[36:39], v[28:31]
    s_waitcnt vmcnt(12)
    v_cmp_eq_u32 vcc, -1, v103
    v_mfma_f32_16x16x32_bf16 v[48:51], v[96:99], a[40:43], v[48:51]
    s_cbranch_vccnz L_rompt_kernel_e3
L_rompt_kernel_e3r:
    s_add_u32 s23, s80, 655360
    buffer_load_dwordx4 v[92:95], v235, s[8:11], s23 offen offset:256 sc1
    v_mfma_f32_16x16x32_bf16 v[68:71], v[96:99], a[44:47], v[68:71]
    v_add_f32 v170, v170, v218
    v_add_f32 v171, v171, v218
    v_lshlrev_b32 v172, 16, v190
    v_mfma_f32_16x16x32_bf16 v[8:11], v[96:99], a[32:35], v[8:11]
    v_and_b32 v173, s56, v190
    v_add_f32 v172, v172, v218
    v_add_f32 v173, v173, v218
    v_mfma_f32_16x16x32_bf16 v[28:31], v[100:103], a[52:55], v[28:31]
    s_waitcnt vmcnt(9)
    v_max3_u32 v6, v107, v111, v115
    v_max_u32 v6, v6, v119
    v_cmp_eq_u32 vcc, -1, v6
    v_mfma_f32_16x16x32_bf16 v[48:51], v[100:103], a[56:59], v[48:51]
    s_cbranch_vccnz L_rompt_kernel_e4
L_rompt_kernel_e4r:
    s_add_u32 s23, s81, 655360
    buffer_load_dwordx4 v[96:99], v235, s[8:11], s23 offen offset:256 sc1
    v_mfma_f32_16x16x32_bf16 v[68:71], v[100:103], a[60:63], v[68:71]
    v_lshlrev_b32 v174, 16, v191
    v_and_b32 v175, s56, v191
    v_add_f32 v174, v174, v218
    v_mfma_f32_16x16x32_bf16 v[8:11], v[100:103], a[48:51], v[8:11]
    v_add_f32 v175, v175, v218
    v_lshlrev_b32 v176, 16, v192
    v_and_b32 v177, s56, v192
    v_mfma_f32_16x16x32_bf16 v[28:31], v[104:107], a[68:71], v[28:31]
    s_add_u32 s23, s82, 655360
    buffer_load_dwordx4 v[100:103], v235, s[8:11], s23 offen offset:256 sc1
    v_mfma_f32_16x16x32_bf16 v[48:51], v[104:107], a[72:75], v[48:51]
    v_add_f32 v176, v176, v218
    v_add_f32 v177, v177, v218
    v_mfma_f32_16x16x32_bf16 v[68:71], v[104:107], a[76:79], v[68:71]
    v_lshlrev_b32 v178, 16, v193
    v_and_b32 v179, s56, v193
    v_mfma_f32_16x16x32_bf16 v[8:11], v[104:107], a[64:67], v[8:11]
    v_add_f32 v178, v178, v218
    v_add_f32 v179, v179, v218
    v_mfma_f32_16x16x32_bf16 v[28:31], v[108:111], a[84:87], v[28:31]
    s_add_u32 s23, s83, 655360
    buffer_load_dwordx4 v[104:107], v235, s[8:11], s23 offen offset:256 sc1
    v_mfma_f32_16x16x32_bf16 v[48:51], v[108:111], a[88:91], v[48:51]
    v_lshlrev_b32 v180, 16, v194
    v_and_b32 v181, s56, v194
    v_mfma_f32_16x16x32_bf16 v[68:71], v[108:111], a[92:95], v[68:71]
    v_add_f32 v180, v180, v218
    v_add_f32 v181, v181, v218
    v_mfma_f32_16x16x32_bf16 v[8:11], v[108:111], a[80:83], v[8:11]
    v_lshlrev_b32 v182, 16, v195
    v_and_b32 v183, s56, v195
    v_mfma_f32_16x16x32_bf16 v[28:31], v[112:115], a[100:103], v[28:31]
    s_add_u32 s23, s80, 1310720
    buffer_load_dwordx4 v[108:111], v235, s[8:11], s23 offen offset:256 sc1
    v_mfma_f32_16x16x32_bf16 v[48:51], v[112:115], a[104:107], v[48:51]
    v_add_f32 v182, v182, v218
    v_add_f32 v183, v183, v218
    v_mfma_f32_16x16x32_bf16 v[68:71], v[112:115], a[108:111], v[68:71]
    v_lshlrev_b32 v184, 16, v196
    v_and_b32 v185, s56, v196
    v_mfma_f32_16x16x32_bf16 v[8:11], v[112:115], a[96:99], v[8:11]
    v_add_f32 v184, v184, v218
    v_add_f32 v185, v185, v218
    v_mfma_f32_16x16x32_bf16 v[28:31], v[116:119], a[116:119], v[28:31]
    s_waitcnt vmcnt(9)
    v_max3_u32 v6, v123, v127, v131
    v_max_u32 v6, v6, v135
    v_cmp_eq_u32 vcc, -1, v6
    v_mfma_f32_16x16x32_bf16 v[48:51], v[116:119], a[120:123], v[48:51]
    s_cbranch_vccnz L_rompt_kernel_e8
L_rompt_kernel_e8r:
    s_add_u32 s23, s81, 1310720
    buffer_load_dwordx4 v[112:115], v235, s[8:11], s23 offen offset:256 sc1
    v_mfma_f32_16x16x32_bf16 v[68:71], v[116:119], a[124:127], v[68:71]
    v_lshlrev_b32 v186, 16, v197
    v_and_b32 v187, s56, v197
    v_mfma_f32_16x16x32_bf16 v[8:11], v[116:119], a[112:115], v[8:11]
    v_add_f32 v186, v186, v218
    v_add_f32 v187, v187, v218
    v_mfma_f32_16x16x32_bf16 v[28:31], v[120:123], a[132:135], v[28:31]
    s_add_u32 s23, s82, 1310720
    v_mfma_f32_16x16x32_bf16 v[48:51], v[120:123], a[136:139], v[48:51]
    v_mfma_f32_16x16x32_bf16 v[68:71], v[120:123], a[140:143], v[68:71]
    buffer_load_dwordx4 v[116:119], v235, s[8:11], s23 offen offset:256 sc1
    v_mfma_f32_16x16x32_bf16 v[8:11], v[120:123], a[128:131], v[8:11]
    v_mfma_f32_16x16x32_bf16 v[28:31], v[124:127], a[148:151], v[28:31]
    s_add_u32 s23, s83, 1310720
    v_mfma_f32_16x16x32_bf16 v[48:51], v[124:127], a[152:155], v[48:51]
    v_mfma_f32_16x16x32_bf16 v[68:71], v[124:127], a[156:159], v[68:71]
    buffer_load_dwordx4 v[120:123], v235, s[8:11], s23 offen offset:256 sc1
    v_mfma_f32_16x16x32_bf16 v[8:11], v[124:127], a[144:147], v[8:11]
    v_mfma_f32_16x16x32_bf16 v[28:31], v[128:131], a[164:167], v[28:31]
    buffer_load_dwordx4 v[124:127], v235, s[8:11], s80 offen offset:512 sc1
    v_mfma_f32_16x16x32_bf16 v[48:51], v[128:131], a[168:171], v[48:51]
    v_mfma_f32_16x16x32_bf16 v[68:71], v[128:131], a[172:175], v[68:71]
    v_mfma_f32_16x16x32_bf16 v[8:11], v[128:131], a[160:163], v[8:11]
    v_mfma_f32_16x16x32_bf16 v[28:31], v[132:135], a[180:183], v[28:31]
    s_waitcnt vmcnt(9)
    v_max3_u32 v6, v139, v143, v147
    v_max_u32 v6, v6, v91
    v_cmp_eq_u32 vcc, -1, v6
    v_mfma_f32_16x16x32_bf16 v[48:51], v[132:135], a[184:187], v[48:51]
    s_cbranch_vccnz L_rompt_kernel_e12
L_rompt_kernel_e12r:
    v_mfma_f32_16x16x32_bf16 v[68:71], v[132:135], a[188:191], v[68:71]
    buffer_load_dwordx4 v[128:131], v235, s[8:11], s81 offen offset:512 sc1
    v_mfma_f32_16x16x32_bf16 v[8:11], v[132:135], a[176:179], v[8:11]
    v_mfma_f32_16x16x32_bf16 v[32:35], v[136:139], a[4:7], 0
    buffer_load_dwordx4 v[132:135], v235, s[8:11], s82 offen offset:512 sc1
    v_mfma_f32_16x16x32_bf16 v[52:55], v[136:139], a[8:11], 0
    v_mfma_f32_16x16x32_bf16 v[72:75], v[136:139], a[12:15], 0
    v_mfma_f32_16x16x32_bf16 v[12:15], v[136:139], a[0:3], 0
    v_mfma_f32_16x16x32_bf16 v[32:35], v[140:143], a[20:23], v[32:35]
    buffer_load_dwordx4 v[136:139], v235, s[8:11], s83 offen offset:512 sc1
    v_mfma_f32_16x16x32_bf16 v[52:55], v[140:143], a[24:27], v[52:55]
    v_mfma_f32_16x16x32_bf16 v[72:75], v[140:143], a[28:31], v[72:75]
    v_mfma_f32_16x16x32_bf16 v[12:15], v[140:143], a[16:19], v[12:15]
    v_mfma_f32_16x16x32_bf16 v[32:35], v[144:147], a[36:39], v[32:35]
    s_add_u32 s23, s80, 655360
    buffer_load_dwordx4 v[140:143], v235, s[8:11], s23 offen offset:512 sc1
    ds_write_b128 v228, v[28:31] offset:0
    v_mfma_f32_16x16x32_bf16 v[52:55], v[144:147], a[40:43], v[52:55]
    ds_write_b128 v229, v[48:51] offset:0
    ds_write_b128 v230, v[68:71] offset:0
    v_mfma_f32_16x16x32_bf16 v[72:75], v[144:147], a[44:47], v[72:75]
    v_add_f32 v168, v168, v8
    v_add_f32 v169, v169, v9
    v_mfma_f32_16x16x32_bf16 v[12:15], v[144:147], a[32:35], v[12:15]
    v_add_f32 v170, v170, v10
    v_add_f32 v171, v171, v11
    v_mfma_f32_16x16x32_bf16 v[32:35], v[88:91], a[52:55], v[32:35]
    s_waitcnt vmcnt(9)
    v_max3_u32 v6, v95, v99, v103
    v_max_u32 v6, v6, v107
    v_cmp_eq_u32 vcc, -1, v6
    v_mfma_f32_16x16x32_bf16 v[52:55], v[88:91], a[56:59], v[52:55]
    s_cbranch_vccnz L_rompt_kernel_e16
L_rompt_kernel_e16r:
    v_mfma_f32_16x16x32_bf16 v[72:75], v[88:91], a[60:63], v[72:75]
    s_add_u32 s23, s81, 655360
    v_mfma_f32_16x16x32_bf16 v[12:15], v[88:91], a[48:51], v[12:15]
    buffer_load_dwordx4 v[144:147], v235, s[8:11], s23 offen offset:512 sc1
    v_mfma_f32_16x16x32_bf16 v[32:35], v[92:95], a[68:71], v[32:35]
    s_add_u32 s23, s82, 655360
    v_mfma_f32_16x16x32_bf16 v[52:55], v[92:95], a[72:75], v[52:55]
    v_mfma_f32_16x16x32_bf16 v[72:75], v[92:95], a[76:79], v[72:75]
    buffer_load_dwordx4 v[88:91], v235, s[8:11], s23 offen offset:512 sc1
    v_mfma_f32_16x16x32_bf16 v[12:15], v[92:95], a[64:67], v[12:15]
    v_mfma_f32_16x16x32_bf16 v[32:35], v[96:99], a[84:87], v[32:35]
    s_add_u32 s23, s83, 655360
    v_mfma_f32_16x16x32_bf16 v[52:55], v[96:99], a[88:91], v[52:55]
    v_mfma_f32_16x16x32_bf16 v[72:75], v[96:99], a[92:95], v[72:75]
    buffer_load_dwordx4 v[92:95], v235, s[8:11], s23 offen offset:512 sc1
    v_mfma_f32_16x16x32_bf16 v[12:15], v[96:99], a[80:83], v[12:15]
    v_mfma_f32_16x16x32_bf16 v[32:35], v[100:103], a[100:103], v[32:35]
    s_add_u32 s23, s80, 1310720
    v_mfma_f32_16x16x32_bf16 v[52:55], v[100:103], a[104:107], v[52:55]
    v_mfma_f32_16x16x32_bf16 v[72:75], v[100:103], a[108:111], v[72:75]
    buffer_load_dwordx4 v[96:99], v235, s[8:11], s23 offen offset:512 sc1
    v_mfma_f32_16x16x32_bf16 v[12:15], v[100:103], a[96:99], v[12:15]
    v_mfma_f32_16x16x32_bf16 v[32:35], v[104:107], a[116:119], v[32:35]
    s_waitcnt vmcnt(9)
    v_max3_u32 v6, v111, v115, v119
    v_max_u32 v6, v6, v123
    v_cmp_eq_u32 vcc, -1, v6
    v_mfma_f32_16x16x32_bf16 v[52:55], v[104:107], a[120:123], v[52:55]
    s_cbranch_vccnz L_rompt_kernel_e20
L_rompt_kernel_e20r:
    v_mfma_f32_16x16x32_bf16 v[72:75], v[104:107], a[124:127], v[72:75]
    s_add_u32 s23, s81, 1310720
    v_mfma_f32_16x16x32_bf16 v[12:15], v[104:107], a[112:115], v[12:15]
    buffer_load_dwordx4 v[100:103], v235, s[8:11], s23 offen offset:512 sc1
    v_mfma_f32_16x16x32_bf16 v[32:35], v[108:111], a[132:135], v[32:35]
    s_add_u32 s23, s82, 1310720
    v_mfma_f32_16x16x32_bf16 v[52:55], v[108:111], a[136:139], v[52:55]
    v_mfma_f32_16x16x32_bf16 v[72:75], v[108:111], a[140:143], v[72:75]
    buffer_load_dwordx4 v[104:107], v235, s[8:11], s23 offen offset:512 sc1
    v_mfma_f32_16x16x32_bf16 v[12:15], v[108:111], a[128:131], v[12:15]
    v_mfma_f32_16x16x32_bf16 v[32:35], v[112:115], a[148:151], v[32:35]
    s_add_u32 s23, s83, 1310720
    v_mfma_f32_16x16x32_bf16 v[52:55], v[112:115], a[152:155], v[52:55]
    v_mfma_f32_16x16x32_bf16 v[72:75], v[112:115], a[156:159], v[72:75]
    buffer_load_dwordx4 v[108:111], v235, s[8:11], s23 offen offset:512 sc1
    v_mfma_f32_16x16x32_bf16 v[12:15], v[112:115], a[144:147], v[12:15]
    v_mfma_f32_16x16x32_bf16 v[32:35], v[116:119], a[164:167], v[32:35]
    buffer_load_dwordx4 v[112:115], v235, s[8:11], s80 offen offset:768 sc1
    v_mfma_f32_16x16x32_bf16 v[52:55], v[116:119], a[168:171], v[52:55]
    v_mfma_f32_16x16x32_bf16 v[72:75], v[116:119], a[172:175], v[72:75]
    v_mfma_f32_16x16x32_bf16 v[12:15], v[116:119], a[160:163], v[12:15]
    v_mfma_f32_16x16x32_bf16 v[32:35], v[120:123], a[180:183], v[32:35]
    s_waitcnt vmcnt(9)
    v_max3_u32 v6, v127, v131, v135
    v_max_u32 v6, v6, v139
    v_cmp_eq_u32 vcc, -1, v6
    v_mfma_f32_16x16x32_bf16 v[52:55], v[120:123], a[184:187], v[52:55]
    s_cbranch_vccnz L_rompt_kernel_e24
L_rompt_kernel_e24r:
    v_mfma_f32_16x16x32_bf16 v[72:75], v[120:123], a[188:191], v[72:75]
    buffer_load_dwordx4 v[116:119], v235, s[8:11], s81 offen offset:768 sc1
    v_mfma_f32_16x16x32_bf16 v[12:15], v[120:123], a[176:179], v[12:15]
    v_mfma_f32_16x16x32_bf16 v[36:39], v[124:127], a[4:7], 0
    buffer_load_dwordx4 v[120:123], v235, s[8:11], s82 offen offset:768 sc1
    v_mfma_f32_16x16x32_bf16 v[56:59], v[124:127], a[8:11], 0
    v_mfma_f32_16x16x32_bf16 v[76:79], v[124:127], a[12:15], 0
    v_mfma_f32_16x16x32_bf16 v[16:19], v[124:127], a[0:3], 0
    v_mfma_f32_16x16x32_bf16 v[36:39], v[128:131], a[20:23], v[36:39]
    buffer_load_dwordx4 v[124:127], v235, s[8:11], s83 offen offset:768 sc1
    v_mfma_f32_16x16x32_bf16 v[56:59], v[128:131], a[24:27], v[56:59]
    v_mfma_f32_16x16x32_bf16 v[76:79], v[128:131], a[28:31], v[76:79]
    v_mfma_f32_16x16x32_bf16 v[16:19], v[128:131], a[16:19], v[16:19]
    v_mfma_f32_16x16x32_bf16 v[36:39], v[132:135], a[36:39], v[36:39]
    s_add_u32 s23, s80, 655360
    buffer_load_dwordx4 v[128:131], v235, s[8:11], s23 offen offset:768 sc1
    ds_write_b128 v228, v[32:35] offset:1024
    v_mfma_f32_16x16x32_bf16 v[56:59], v[132:135], a[40:43], v[56:59]
    ds_write_b128 v229, v[52:55] offset:1024
    ds_write_b128 v230, v[72:75] offset:1024
    v_mfma_f32_16x16x32_bf16 v[76:79], v[132:135], a[44:47], v[76:79]
    v_add_f32 v172, v172, v12
    v_add_f32 v173, v173, v13
    v_mfma_f32_16x16x32_bf16 v[16:19], v[132:135], a[32:35], v[16:19]
    v_add_f32 v174, v174, v14
    v_add_f32 v175, v175, v15
    v_mfma_f32_16x16x32_bf16 v[36:39], v[136:139], a[52:55], v[36:39]
    s_waitcnt vmcnt(9)
    v_max3_u32 v6, v143, v147, v91
    v_max_u32 v6, v6, v95
    v_cmp_eq_u32 vcc, -1, v6
    v_mfma_f32_16x16x32_bf16 v[56:59], v[136:139], a[56:59], v[56:59]
    s_cbranch_vccnz L_rompt_kernel_e28
L_rompt_kernel_e28r:
    v_mfma_f32_16x16x32_bf16 v[76:79], v[136:139], a[60:63], v[76:79]
    s_add_u32 s23, s81, 655360
    v_mfma_f32_16x16x32_bf16 v[16:19], v[136:139], a[48:51], v[16:19]
    buffer_load_dwordx4 v[132:135], v235, s[8:11], s23 offen offset:768 sc1
    v_mfma_f32_16x16x32_bf16 v[36:39], v[140:143], a[68:71], v[36:39]
    s_add_u32 s23, s82, 655360
    v_mfma_f32_16x16x32_bf16 v[56:59], v[140:143], a[72:75], v[56:59]
    v_mfma_f32_16x16x32_bf16 v[76:79], v[140:143], a[76:79], v[76:79]
    buffer_load_dwordx4 v[136:139], v235, s[8:11], s23 offen offset:768 sc1
    v_mfma_f32_16x16x32_bf16 v[16:19], v[140:143], a[64:67], v[16:19]
    v_mfma_f32_16x16x32_bf16 v[36:39], v[144:147], a[84:87], v[36:39]
    s_add_u32 s23, s83, 655360
    v_mfma_f32_16x16x32_bf16 v[56:59], v[144:147], a[88:91], v[56:59]
    v_mfma_f32_16x16x32_bf16 v[76:79], v[144:147], a[92:95], v[76:79]
    buffer_load_dwordx4 v[140:143], v235, s[8:11], s23 offen offset:768 sc1
    v_mfma_f32_16x16x32_bf16 v[16:19], v[144:147], a[80:83], v[16:19]
    v_mfma_f32_16x16x32_bf16 v[36:39], v[88:91], a[100:103], v[36:39]
    s_add_u32 s23, s80, 1310720
    v_mfma_f32_16x16x32_bf16 v[56:59], v[88:91], a[104:107], v[56:59]
    v_mfma_f32_16x16x32_bf16 v[76:79], v[88:91], a[108:111], v[76:79]
    buffer_load_dwordx4 v[144:147], v235, s[8:11], s23 offen offset:768 sc1
    v_mfma_f32_16x16x32_bf16 v[16:19], v[88:91], a[96:99], v[16:19]
    v_mfma_f32_16x16x32_bf16 v[36:39], v[92:95], a[116:119], v[36:39]
    s_waitcnt vmcnt(9)
    v_max3_u32 v6, v99, v103, v107
    v_max_u32 v6, v6, v111
    v_cmp_eq_u32 vcc, -1, v6
    v_mfma_f32_16x16x32_bf16 v[56:59], v[92:95], a[120:123], v[56:59]
    s_cbranch_vccnz L_rompt_kernel_e32
L_rompt_kernel_e32r:
    v_mfma_f32_16x16x32_bf16 v[76:79], v[92:95], a[124:127], v[76:79]
    s_add_u32 s23, s81, 1310720
    v_mfma_f32_16x16x32_bf16 v[16:19], v[92:95], a[112:115], v[16:19]
    buffer_load_dwordx4 v[88:91], v235, s[8:11], s23 offen offset:768 sc1
    v_mfma_f32_16x16x32_bf16 v[36:39], v[96:99], a[132:135], v[36:39]
    s_add_u32 s23, s82, 1310720
    v_mfma_f32_16x16x32_bf16 v[56:59], v[96:99], a[136:139], v[56:59]
    v_mfma_f32_16x16x32_bf16 v[76:79], v[96:99], a[140:143], v[76:79]
    buffer_load_dwordx4 v[92:95], v235, s[8:11], s23 offen offset:768 sc1
    v_mfma_f32_16x16x32_bf16 v[16:19], v[96:99], a[128:131], v[16:19]
    v_mfma_f32_16x16x32_bf16 v[36:39], v[100:103], a[148:151], v[36:39]
    s_add_u32 s23, s83, 1310720
    v_mfma_f32_16x16x32_bf16 v[56:59], v[100:103], a[152:155], v[56:59]
    v_mfma_f32_16x16x32_bf16 v[76:79], v[100:103], a[156:159], v[76:79]
    buffer_load_dwordx4 v[96:99], v235, s[8:11], s23 offen offset:768 sc1
    v_mfma_f32_16x16x32_bf16 v[16:19], v[100:103], a[144:147], v[16:19]
    v_mfma_f32_16x16x32_bf16 v[36:39], v[104:107], a[164:167], v[36:39]
    buffer_load_dwordx4 v[100:103], v235, s[8:11], s80 offen offset:1024 sc1
    v_mfma_f32_16x16x32_bf16 v[56:59], v[104:107], a[168:171], v[56:59]
    v_mfma_f32_16x16x32_bf16 v[76:79], v[104:107], a[172:175], v[76:79]
    v_mfma_f32_16x16x32_bf16 v[16:19], v[104:107], a[160:163], v[16:19]
    v_mfma_f32_16x16x32_bf16 v[36:39], v[108:111], a[180:183], v[36:39]
    s_waitcnt vmcnt(9)
    v_max3_u32 v6, v115, v119, v123
    v_max_u32 v6, v6, v127
    v_cmp_eq_u32 vcc, -1, v6
    v_mfma_f32_16x16x32_bf16 v[56:59], v[108:111], a[184:187], v[56:59]
    s_cbranch_vccnz L_rompt_kernel_e36
L_rompt_kernel_e36r:
    v_mfma_f32_16x16x32_bf16 v[76:79], v[108:111], a[188:191], v[76:79]
    buffer_load_dwordx4 v[104:107], v235, s[8:11], s81 offen offset:1024 sc1
    v_mfma_f32_16x16x32_bf16 v[16:19], v[108:111], a[176:179], v[16:19]
    v_mfma_f32_16x16x32_bf16 v[40:43], v[112:115], a[4:7], 0
    buffer_load_dwordx4 v[108:111], v235, s[8:11], s82 offen offset:1024 sc1
    v_mfma_f32_16x16x32_bf16 v[60:63], v[112:115], a[8:11], 0
    v_mfma_f32_16x16x32_bf16 v[80:83], v[112:115], a[12:15], 0
    v_mfma_f32_16x16x32_bf16 v[20:23], v[112:115], a[0:3], 0
    v_mfma_f32_16x16x32_bf16 v[40:43], v[116:119], a[20:23], v[40:43]
    buffer_load_dwordx4 v[112:115], v235, s[8:11], s83 offen offset:1024 sc1
    v_mfma_f32_16x16x32_bf16 v[60:63], v[116:119], a[24:27], v[60:63]
    v_mfma_f32_16x16x32_bf16 v[80:83], v[116:119], a[28:31], v[80:83]
    v_mfma_f32_16x16x32_bf16 v[20:23], v[116:119], a[16:19], v[20:23]
    v_mfma_f32_16x16x32_bf16 v[40:43], v[120:123], a[36:39], v[40:43]
    s_add_u32 s23, s80, 655360
    buffer_load_dwordx4 v[116:119], v235, s[8:11], s23 offen offset:1024 sc1
    ds_write_b128 v228, v[36:39] offset:2048
    v_mfma_f32_16x16x32_bf16 v[60:63], v[120:123], a[40:43], v[60:63]
    ds_write_b128 v229, v[56:59] offset:2048
    ds_write_b128 v230, v[76:79] offset:2048
    v_mfma_f32_16x16x32_bf16 v[80:83], v[120:123], a[44:47], v[80:83]
    v_add_f32 v176, v176, v16
    v_add_f32 v177, v177, v17
    v_mfma_f32_16x16x32_bf16 v[20:23], v[120:123], a[32:35], v[20:23]
    v_add_f32 v178, v178, v18
    v_add_f32 v179, v179, v19
    v_mfma_f32_16x16x32_bf16 v[40:43], v[124:127], a[52:55], v[40:43]
    s_waitcnt vmcnt(9)
    v_max3_u32 v6, v131, v135, v139
    v_max_u32 v6, v6, v143
    v_cmp_eq_u32 vcc, -1, v6
    v_mfma_f32_16x16x32_bf16 v[60:63], v[124:127], a[56:59], v[60:63]
    s_cbranch_vccnz L_rompt_kernel_e40
L_rompt_kernel_e40r:
    v_mfma_f32_16x16x32_bf16 v[80:83], v[124:127], a[60:63], v[80:83]
    s_add_u32 s23, s81, 655360
    v_mfma_f32_16x16x32_bf16 v[20:23], v[124:127], a[48:51], v[20:23]
    buffer_load_dwordx4 v[120:123], v235, s[8:11], s23 offen offset:1024 sc1
    v_mfma_f32_16x16x32_bf16 v[40:43], v[128:131], a[68:71], v[40:43]
    s_add_u32 s23, s82, 655360
    v_mfma_f32_16x16x32_bf16 v[60:63], v[128:131], a[72:75], v[60:63]
    v_mfma_f32_16x16x32_bf16 v[80:83], v[128:131], a[76:79], v[80:83]
    buffer_load_dwordx4 v[124:127], v235, s[8:11], s23 offen offset:1024 sc1
    v_mfma_f32_16x16x32_bf16 v[20:23], v[128:131], a[64:67], v[20:23]
    v_mfma_f32_16x16x32_bf16 v[40:43], v[132:135], a[84:87], v[40:43]
    s_add_u32 s23, s83, 655360
    v_mfma_f32_16x16x32_bf16 v[60:63], v[132:135], a[88:91], v[60:63]
    v_mfma_f32_16x16x32_bf16 v[80:83], v[132:135], a[92:95], v[80:83]
    buffer_load_dwordx4 v[128:131], v235, s[8:11], s23 offen offset:1024 sc1
    v_mfma_f32_16x16x32_bf16 v[20:23], v[132:135], a[80:83], v[20:23]
    v_mfma_f32_16x16x32_bf16 v[40:43], v[136:139], a[100:103], v[40:43]
    s_add_u32 s23, s80, 1310720
    v_mfma_f32_16x16x32_bf16 v[60:63], v[136:139], a[104:107], v[60:63]
    v_mfma_f32_16x16x32_bf16 v[80:83], v[136:139], a[108:111], v[80:83]
    buffer_load_dwordx4 v[132:135], v235, s[8:11], s23 offen offset:1024 sc1
    v_mfma_f32_16x16x32_bf16 v[20:23], v[136:139], a[96:99], v[20:23]
    v_mfma_f32_16x16x32_bf16 v[40:43], v[140:143], a[116:119], v[40:43]
    s_waitcnt vmcnt(9)
    v_max3_u32 v6, v147, v91, v95
    v_max_u32 v6, v6, v99
    v_cmp_eq_u32 vcc, -1, v6
    v_mfma_f32_16x16x32_bf16 v[60:63], v[140:143], a[120:123], v[60:63]
    s_cbranch_vccnz L_rompt_kernel_e44
L_rompt_kernel_e44r:
    v_mfma_f32_16x16x32_bf16 v[80:83], v[140:143], a[124:127], v[80:83]
    s_add_u32 s23, s81, 1310720
    v_mfma_f32_16x16x32_bf16 v[20:23], v[140:143], a[112:115], v[20:23]
    buffer_load_dwordx4 v[136:139], v235, s[8:11], s23 offen offset:1024 sc1
    v_mfma_f32_16x16x32_bf16 v[40:43], v[144:147], a[132:135], v[40:43]
    s_add_u32 s23, s82, 1310720
    v_mfma_f32_16x16x32_bf16 v[60:63], v[144:147], a[136:139], v[60:63]
    v_mfma_f32_16x16x32_bf16 v[80:83], v[144:147], a[140:143], v[80:83]
    buffer_load_dwordx4 v[140:143], v235, s[8:11], s23 offen offset:1024 sc1
    v_mfma_f32_16x16x32_bf16 v[20:23], v[144:147], a[128:131], v[20:23]
    v_mfma_f32_16x16x32_bf16 v[40:43], v[88:91], a[148:151], v[40:43]
    s_add_u32 s23, s83, 1310720
    v_mfma_f32_16x16x32_bf16 v[60:63], v[88:91], a[152:155], v[60:63]
    v_mfma_f32_16x16x32_bf16 v[80:83], v[88:91], a[156:159], v[80:83]
    buffer_load_dwordx4 v[144:147], v235, s[8:11], s23 offen offset:1024 sc1
    v_mfma_f32_16x16x32_bf16 v[20:23], v[88:91], a[144:147], v[20:23]
    v_mfma_f32_16x16x32_bf16 v[40:43], v[92:95], a[164:167], v[40:43]
    v_mfma_f32_16x16x32_bf16 v[60:63], v[92:95], a[168:171], v[60:63]
    v_mfma_f32_16x16x32_bf16 v[80:83], v[92:95], a[172:175], v[80:83]
    v_mfma_f32_16x16x32_bf16 v[20:23], v[92:95], a[160:163], v[20:23]
    v_mfma_f32_16x16x32_bf16 v[40:43], v[96:99], a[180:183], v[40:43]
    s_waitcnt vmcnt(8)
    v_max3_u32 v6, v103, v107, v111
    v_max_u32 v6, v6, v115
    v_cmp_eq_u32 vcc, -1, v6
    v_mfma_f32_16x16x32_bf16 v[60:63], v[96:99], a[184:187], v[60:63]
    s_cbranch_vccnz L_rompt_kernel_e48
L_rompt_kernel_e48r:
    v_mfma_f32_16x16x32_bf16 v[80:83], v[96:99], a[188:191], v[80:83]
    v_mfma_f32_16x16x32_bf16 v[20:23], v[96:99], a[176:179], v[20:23]
    v_mfma_f32_16x16x32_bf16 v[44:47], v[100:103], a[4:7], 0
    v_mfma_f32_16x16x32_bf16 v[64:67], v[100:103], a[8:11], 0
    v_mfma_f32_16x16x32_bf16 v[84:87], v[100:103], a[12:15], 0
    v_mfma_f32_16x16x32_bf16 v[24:27], v[100:103], a[0:3], 0
    v_mfma_f32_16x16x32_bf16 v[44:47], v[104:107], a[20:23], v[44:47]
    v_mfma_f32_16x16x32_bf16 v[64:67], v[104:107], a[24:27], v[64:67]
    v_mfma_f32_16x16x32_bf16 v[84:87], v[104:107], a[28:31], v[84:87]
    v_mfma_f32_16x16x32_bf16 v[24:27], v[104:107], a[16:19], v[24:27]
    v_mfma_f32_16x16x32_bf16 v[44:47], v[108:111], a[36:39], v[44:47]
    ds_write_b128 v228, v[40:43] offset:3072
    ds_write_b128 v229, v[60:63] offset:3072
    v_mfma_f32_16x16x32_bf16 v[64:67], v[108:111], a[40:43], v[64:67]
    ds_write_b128 v230, v[80:83] offset:3072
    v_add_f32 v180, v180, v20
    v_mfma_f32_16x16x32_bf16 v[84:87], v[108:111], a[44:47], v[84:87]
    v_add_f32 v181, v181, v21
    v_add_f32 v182, v182, v22
    v_mfma_f32_16x16x32_bf16 v[24:27], v[108:111], a[32:35], v[24:27]
    v_add_f32 v183, v183, v23
    v_mfma_f32_16x16x32_bf16 v[44:47], v[112:115], a[52:55], v[44:47]
    s_waitcnt vmcnt(4)
    v_max3_u32 v6, v119, v123, v127
    v_max_u32 v6, v6, v131
    v_cmp_eq_u32 vcc, -1, v6
    v_mfma_f32_16x16x32_bf16 v[64:67], v[112:115], a[56:59], v[64:67]
    s_cbranch_vccnz L_rompt_kernel_e52
L_rompt_kernel_e52r:
    v_mfma_f32_16x16x32_bf16 v[84:87], v[112:115], a[60:63], v[84:87]
    v_mfma_f32_16x16x32_bf16 v[24:27], v[112:115], a[48:51], v[24:27]
    s_waitcnt lgkmcnt(0)
    s_barrier
    v_mfma_f32_16x16x32_bf16 v[44:47], v[116:119], a[68:71], v[44:47]
    ds_read_b128 v[28:31], v231 offset:0
    ds_read_b128 v[48:51], v231 offset:5120
    ds_read_b128 v[68:71], v231 offset:10240
    v_mfma_f32_16x16x32_bf16 v[64:67], v[116:119], a[72:75], v[64:67]
    ds_read_b128 v[32:35], v231 offset:1024
    ds_read_b128 v[52:55], v231 offset:6144
    v_mfma_f32_16x16x32_bf16 v[84:87], v[116:119], a[76:79], v[84:87]
    ds_read_b128 v[72:75], v231 offset:11264
    ds_read_b128 v[36:39], v231 offset:2048
    ds_read_b128 v[56:59], v231 offset:7168
    v_mfma_f32_16x16x32_bf16 v[24:27], v[116:119], a[64:67], v[24:27]
    ds_read_b128 v[76:79], v231 offset:12288
    ds_read_b128 v[40:43], v231 offset:3072
    v_mfma_f32_16x16x32_bf16 v[44:47], v[120:123], a[84:87], v[44:47]
    ds_read_b128 v[60:63], v231 offset:8192
    ds_read_b128 v[80:83], v231 offset:13312
    s_waitcnt lgkmcnt(9)
    v_mfma_f32_16x16x32_bf16 v[64:67], v[120:123], a[88:91], v[64:67]
    v_add_f32 v168, v168, v28
    v_add_f32 v169, v169, v29
    v_mfma_f32_16x16x32_bf16 v[84:87], v[120:123], a[92:95], v[84:87]
    v_add_f32 v170, v170, v30
    v_add_f32 v171, v171, v31
    v_add_f32 v168, v168, v48
    v_mfma_f32_16x16x32_bf16 v[24:27], v[120:123], a[80:83], v[24:27]
    v_add_f32 v169, v169, v49
    v_add_f32 v170, v170, v50
    v_mfma_f32_16x16x32_bf16 v[44:47], v[124:127], a[100:103], v[44:47]
    v_add_f32 v171, v171, v51
    v_add_f32 v168, v168, v68
    v_add_f32 v169, v169, v69
    v_mfma_f32_16x16x32_bf16 v[64:67], v[124:127], a[104:107], v[64:67]
    v_add_f32 v170, v170, v70
    v_add_f32 v171, v171, v71
    v_mfma_f32_16x16x32_bf16 v[84:87], v[124:127], a[108:111], v[84:87]
    s_waitcnt lgkmcnt(6)
    v_add_f32 v172, v172, v32
    v_add_f32 v173, v173, v33
    v_mfma_f32_16x16x32_bf16 v[24:27], v[124:127], a[96:99], v[24:27]
    v_add_f32 v174, v174, v34
    v_add_f32 v175, v175, v35
    v_mfma_f32_16x16x32_bf16 v[44:47], v[128:131], a[116:119], v[44:47]
    s_waitcnt vmcnt(0)
    v_max3_u32 v6, v135, v139, v143
    v_max_u32 v6, v6, v147
    v_cmp_eq_u32 vcc, -1, v6
    v_mfma_f32_16x16x32_bf16 v[64:67], v[128:131], a[120:123], v[64:67]
    s_cbranch_vccnz L_rompt_kernel_e56
L_rompt_kernel_e56r:
    v_add_f32 v172, v172, v52
    v_add_f32 v173, v173, v53
    v_add_f32 v174, v174, v54
    v_mfma_f32_16x16x32_bf16 v[84:87], v[128:131], a[124:127], v[84:87]
    v_add_f32 v175, v175, v55
    v_add_f32 v172, v172, v72
    v_add_f32 v173, v173, v73
    v_add_f32 v174, v174, v74
    v_mfma_f32_16x16x32_bf16 v[24:27], v[128:131], a[112:115], v[24:27]
    v_add_f32 v175, v175, v75
    s_waitcnt lgkmcnt(3)
    v_add_f32 v176, v176, v36
    v_mfma_f32_16x16x32_bf16 v[44:47], v[132:135], a[132:135], v[44:47]
    v_add_f32 v177, v177, v37
    v_add_f32 v178, v178, v38
    v_add_f32 v179, v179, v39
    v_mfma_f32_16x16x32_bf16 v[64:67], v[132:135], a[136:139], v[64:67]
    v_add_f32 v176, v176, v56
    v_add_f32 v177, v177, v57
    v_mfma_f32_16x16x32_bf16 v[84:87], v[132:135], a[140:143], v[84:87]
    v_add_f32 v178, v178, v58
    v_add_f32 v179, v179, v59
    v_add_f32 v176, v176, v76
    v_mfma_f32_16x16x32_bf16 v[24:27], v[132:135], a[128:131], v[24:27]
    v_add_f32 v177, v177, v77
    v_add_f32 v178, v178, v78
    v_mfma_f32_16x16x32_bf16 v[44:47], v[136:139], a[148:151], v[44:47]
    v_add_f32 v179, v179, v79
    s_waitcnt lgkmcnt(0)
    v_add_f32 v180, v180, v40
    v_mfma_f32_16x16x32_bf16 v[64:67], v[136:139], a[152:155], v[64:67]
    v_add_f32 v181, v181, v41
    v_add_f32 v182, v182, v42
    v_mfma_f32_16x16x32_bf16 v[84:87], v[136:139], a[156:159], v[84:87]
    v_add_f32 v183, v183, v43
    v_add_f32 v180, v180, v60
    v_add_f32 v181, v181, v61
    v_mfma_f32_16x16x32_bf16 v[24:27], v[136:139], a[144:147], v[24:27]
    v_add_f32 v182, v182, v62
    v_add_f32 v183, v183, v63
    v_mfma_f32_16x16x32_bf16 v[44:47], v[140:143], a[164:167], v[44:47]
    v_add_f32 v180, v180, v80
    v_add_f32 v181, v181, v81
    v_add_f32 v182, v182, v82
    v_mfma_f32_16x16x32_bf16 v[64:67], v[140:143], a[168:171], v[64:67]
    v_add_f32 v183, v183, v83
    v_cvt_pk_bf16_f32 v188, v168, v169
    v_mfma_f32_16x16x32_bf16 v[84:87], v[140:143], a[172:175], v[84:87]
    v_cvt_pk_bf16_f32 v189, v170, v171
    ds_write_b64 v232, v[188:189] offset:0
    v_cvt_pk_bf16_f32 v190, v172, v173
    v_mfma_f32_16x16x32_bf16 v[24:27], v[140:143], a[160:163], v[24:27]
    v_cvt_pk_bf16_f32 v191, v174, v175
    ds_write_b64 v232, v[190:191] offset:32
    v_mfma_f32_16x16x32_bf16 v[44:47], v[144:147], a[180:183], v[44:47]
    v_cvt_pk_bf16_f32 v192, v176, v177
    v_cvt_pk_bf16_f32 v193, v178, v179
    v_mfma_f32_16x16x32_bf16 v[64:67], v[144:147], a[184:187], v[64:67]
    ds_write_b64 v232, v[192:193] offset:64
    v_mfma_f32_16x16x32_bf16 v[84:87], v[144:147], a[188:191], v[84:87]
    v_cvt_pk_bf16_f32 v194, v180, v181
    v_cvt_pk_bf16_f32 v195, v182, v183
    v_mfma_f32_16x16x32_bf16 v[24:27], v[144:147], a[176:179], v[24:27]
    ds_write_b64 v232, v[194:195] offset:96
    s_nop 4
    ds_write_b128 v228, v[44:47] offset:4096
    ds_write_b128 v229, v[64:67] offset:4096
    ds_write_b128 v230, v[84:87] offset:4096
    v_pk_add_f32 v[184:185], v[184:185], v[24:25]
    v_pk_add_f32 v[186:187], v[186:187], v[26:27]
    s_waitcnt lgkmcnt(0)
    s_barrier
    ds_read_b128 v[44:47], v231 offset:4096
    ds_read_b128 v[64:67], v231 offset:9216
    ds_read_b128 v[84:87], v231 offset:14336
    s_waitcnt lgkmcnt(2)
    v_pk_add_f32 v[184:185], v[184:185], v[44:45]
    v_pk_add_f32 v[186:187], v[186:187], v[46:47]
    s_waitcnt lgkmcnt(1)
    v_pk_add_f32 v[184:185], v[184:185], v[64:65]
    v_pk_add_f32 v[186:187], v[186:187], v[66:67]
    s_waitcnt lgkmcnt(0)
    v_pk_add_f32 v[184:185], v[184:185], v[84:85]
    v_pk_add_f32 v[186:187], v[186:187], v[86:87]
    v_cvt_pk_bf16_f32 v196, v184, v185
    v_cvt_pk_bf16_f32 v197, v186, v187
    ds_write_b64 v232, v[196:197] offset:128
    s_waitcnt lgkmcnt(0)
    ds_read_b128 v[8:11], v3 offset:0
    ds_read_b128 v[12:15], v3 offset:1024
    ds_read_b128 v[16:19], v3 offset:2048
    s_waitcnt lgkmcnt(2)
    buffer_store_dwordx4 v[8:11], v247, s[52:55], s57 offen
    s_waitcnt lgkmcnt(1)
    buffer_store_dwordx4 v[12:15], v248, s[52:55], s57 offen
    s_waitcnt lgkmcnt(0)
    s_mov_b32 exec_hi, 0
    buffer_store_dwordx4 v[16:19], v249, s[52:55], s57 offen
L_rompt_kernel_end:
    s_endpgm
L_rompt_kernel_redo:
    s_waitcnt vmcnt(0) lgkmcnt(0)
    s_barrier
    s_mov_b32 s25, -1
    s_mov_b64 exec, s[26:27]
    v_mov_b32 v128, 0
    v_mov_b32 v130, 0
    v_mov_b32 v132, 0
    v_mov_b32 v134, 0
    s_mov_b64 exec, -1
    v_mov_b32 v206, 0xff800000
    v_mov_b32 v207, 0xff800000
    v_mov_b32 v208, 0xff800000
    v_mov_b32 v209, 0xff800000
    s_mov_b32 s21, 0
L_rompt_kernel_mx:
    buffer_load_dwordx4 v[148:151], v192, s[8:11], s21 offen
    buffer_load_dwordx2 v[158:159], v193, s[8:11], s21 offen
    s_waitcnt vmcnt(0)
    v_mfma_f32_32x32x16_bf16 v[72:87], v[148:151], v[112:115], 0
    v_mfma_f32_32x32x8_bf16 v[72:87], v[158:159], v[128:129], v[72:87]
    s_nop 15
    v_max3_f32 v206, v206, v72, v73
    v_max3_f32 v206, v206, v74, v75
    v_max3_f32 v206, v206, v76, v77
    v_max3_f32 v206, v206, v78, v79
    v_max3_f32 v206, v206, v80, v81
    v_max3_f32 v206, v206, v82, v83
    v_max3_f32 v206, v206, v84, v85
    v_max3_f32 v206, v206, v86, v87
    v_mfma_f32_32x32x16_bf16 v[88:103], v[148:151], v[116:119], 0
    v_mfma_f32_32x32x8_bf16 v[88:103], v[158:159], v[130:131], v[88:103]
    s_nop 15
    v_max3_f32 v207, v207, v88, v89
    v_max3_f32 v207, v207, v90, v91
    v_max3_f32 v207, v207, v92, v93
    v_max3_f32 v207, v207, v94, v95
    v_max3_f32 v207, v207, v96, v97
    v_max3_f32 v207, v207, v98, v99
    v_max3_f32 v207, v207, v100, v101
    v_max3_f32 v207, v207, v102, v103
    v_mfma_f32_32x32x16_bf16 v[72:87], v[148:151], v[120:123], 0
    v_mfma_f32_32x32x8_bf16 v[72:87], v[158:159], v[132:133], v[72:87]
    s_nop 15
    v_max3_f32 v208, v208, v72, v73
    v_max3_f32 v208, v208, v74, v75
    v_max3_f32 v208, v208, v76, v77
    v_max3_f32 v208, v208, v78, v79
    v_max3_f32 v208, v208, v80, v81
    v_max3_f32 v208, v208, v82, v83
    v_max3_f32 v208, v208, v84, v85
    v_max3_f32 v208, v208, v86, v87
    v_mfma_f32_32x32x16_bf16 v[88:103], v[148:151], v[124:127], 0
    v_mfma_f32_32x32x8_bf16 v[88:103], v[158:159], v[134:135], v[88:103]
    s_nop 15
    v_max3_f32 v209, v209, v88, v89
    v_max3_f32 v209, v209, v90, v91
    v_max3_f32 v209, v209, v92, v93
    v_max3_f32 v209, v209, v94, v95
    v_max3_f32 v209, v209, v96, v97
    v_max3_f32 v209, v209, v98, v99
    v_max3_f32 v209, v209, v100, v101
    v_max3_f32 v209, v209, v102, v103
    s_add_u32 s21, s21, 512
    s_cmp_lt_u32 s21, 32768
    s_cbranch_scc1 L_rompt_kernel_mx
    v_mov_b32 v3, v206
    s_nop 1
    v_permlane32_swap_b32 v206, v3
    s_nop 1
    v_max_f32 v206, v206, v3
    v_mov_b32 v3, v207
    s_nop 1
    v_permlane32_swap_b32 v207, v3
    s_nop 1
    v_max_f32 v207, v207, v3
    v_mov_b32 v3, v208
    s_nop 1
    v_permlane32_swap_b32 v208, v3
    s_nop 1
    v_max_f32 v208, v208, v3
    v_mov_b32 v3, v209
    s_nop 1
    v_permlane32_swap_b32 v209, v3
    s_nop 1
    v_max_f32 v209, v209, v3
    s_lshl_b32 s21, s62, 14
    s_mul_i32 s22, s62, 1327104
    buffer_load_dwordx4 v[136:139], v192, s[8:11], s21 offen offset:0
    buffer_load_dwordx2 v[152:153], v193, s[8:11], s21 offen offset:0
    buffer_load_dwordx4 v[160:163], v198, s[8:11], s22 offen
    buffer_load_dwordx4 v[164:167], v199, s[8:11], s22 offen
    buffer_load_dwordx4 v[140:143], v192, s[8:11], s21 offen offset:512
    buffer_load_dwordx2 v[154:155], v193, s[8:11], s21 offen offset:512
    buffer_load_dwordx4 v[168:171], v200, s[8:11], s22 offen
    buffer_load_dwordx4 v[172:175], v201, s[8:11], s22 offen
    buffer_load_dwordx4 v[144:147], v192, s[8:11], s21 offen offset:1024
    buffer_load_dwordx2 v[156:157], v193, s[8:11], s21 offen offset:1024
    buffer_load_dwordx4 v[176:179], v202, s[8:11], s22 offen
    buffer_load_dwordx4 v[180:183], v203, s[8:11], s22 offen
    s_branch L_rompt_kernel_setm
L_rompt_kernel_side1:
    s_mov_b32 s3, 1
    s_load_dwordx2 s[84:85], s[0:1], 16
    s_lshl_b32 s81, s78, 2
    s_add_u32 s81, s81, s14
    v_lshrrev_b32 v1, 3, v0
    v_mul_u32_u24 v1, 1280, v1
    v_and_b32 v2, 7, v0
    v_lshl_add_u32 v120, v2, 4, v1
    v_bfe_u32 v9, v0, 3, 2
    v_lshrrev_b32 v10, 5, v0
    v_mul_u32_u24 v10, 20, v10
    v_add3_u32 v9, v9, v10, 16
    v_mul_u32_u24 v9, 1280, v9
    v_lshl_add_u32 v9, v2, 4, v9
    s_lshl_b32 s90, s14, 14
    s_waitcnt lgkmcnt(0)
    s_mov_b32 s44, s6
    s_mov_b32 s45, s7
    s_mov_b32 s46, 0x280000
    s_mov_b32 s47, 0x00020000
    s_mov_b32 s8, s4
    s_mov_b32 s9, s5
    s_mov_b32 s10, 0x101db00
    s_mov_b32 s11, 0x00020000
    s_mov_b32 s86, 819200
    s_mov_b32 s87, 0x00020000
    v_lshlrev_b32 v121, 4, v0
    s_mov_b32 s24, 0x3f803f80
    v_mov_b32 v100, -1
    v_mov_b32 v101, -1
    v_mov_b32 v102, -1
    v_mov_b32 v103, -1
    v_mov_b32 v104, 0
    v_mov_b32 v105, 0
    v_mov_b32 v106, 0
    v_mov_b32 v107, 0
    v_mov_b32 v108, s24
    v_mov_b32 v109, 0
    v_mov_b32 v110, s24
    v_mov_b32 v111, 0
    v_mov_b32 v112, s24
    v_mov_b32 v113, s24
    v_mov_b32 v114, s24
    v_mov_b32 v115, s24
    s_lshl_b32 s21, s81, 11
    s_add_u32 s22, s21, 16571136
    buffer_store_dwordx4 v[100:103], v121, s[8:11], s22 offen offset:0 sc1
    buffer_store_dwordx4 v[100:103], v121, s[8:11], s22 offen offset:1024 sc1
    s_add_u32 s22, s21, 16702208
    buffer_store_dwordx4 v[100:103], v121, s[8:11], s22 offen offset:0 sc1
    buffer_store_dwordx4 v[100:103], v121, s[8:11], s22 offen offset:1024 sc1
    s_lshl_b32 s21, s81, 11
    s_add_u32 s21, s21, 16308992
    buffer_store_dwordx4 v[100:103], v121, s[8:11], s21 offen offset:0 sc1
    buffer_store_dwordx4 v[100:103], v121, s[8:11], s21 offen offset:1024 sc1
    s_lshl_b32 s21, s81, 10
    s_add_u32 s21, s21, 16833280
    buffer_store_dwordx4 v[104:107], v121, s[8:11], s21 offen sc1
    s_lshl_b32 s21, s81, 9
    s_add_u32 s21, s21, 5365760
    s_mov_b32 exec_hi, 0
    buffer_store_dwordx4 v[108:111], v121, s[8:11], s21 offen sc1
    v_lshrrev_b32 v1, 3, v0
    v_mul_u32_u24 v1, 10240, v1
    v_add_u32 v1, v1, v121
    s_mul_i32 s21, s81, 41472
    s_add_u32 s21, s21, 5409536
    buffer_store_dwordx4 v[112:115], v1, s[8:11], s21 offen sc1
    s_mov_b64 exec, -1
    s_mov_b32 s54, 256
    s_mov_b32 s55, 0x00020000
    buffer_load_dwordx4 v[176:179], v188, s[44:47], s43 offen offset:0
    buffer_load_dwordx4 v[180:183], v188, s[44:47], s43 offen offset:512
    buffer_load_dwordx4 v[184:187], v189, s[44:47], s43 offen offset:1024
    s_cmp_lg_u32 s14, 0
    s_waitcnt vmcnt(3)
    s_barrier
    s_cbranch_scc1 L_rompt_kernel_par
    v_mov_b32 v170, 1
    s_mov_b64 exec, 1
    buffer_atomic_add v170, off, s[52:55], 0 sc1
    s_mov_b64 exec, -1
    s_branch L_rompt_kernel_par
L_rompt_kernel_side2:
    v_bfe_u32 v13, v0, 2, 2
    v_lshlrev_b32 v13, 7, v13
    v_lshl_add_u32 v13, v251, 5, v13
    v_and_b32 v14, 3, v0
    v_lshl_add_u32 v13, v14, 3, v13
    v_add_u32 v13, s90, v13
    s_waitcnt vmcnt(0)
    s_call_b64 s[92:93], L_rompt_kernel_sub
    s_mov_b32 exec_lo, 15
    s_mov_b32 exec_hi, 15
    buffer_store_dwordx4 v[176:179], v180, s[8:11], s91 offen sc1
    s_mov_b64 exec, -1
    v_lshlrev_b32 v8, 7, v0
    s_mov_b32 s24, s30
    s_mov_b32 s25, s31
    s_mov_b32 s26, 0xc00
    s_mov_b32 s27, 0x00020000
    buffer_load_dword v191, v8, s[24:27], 0 offen
    s_mov_b32 s24, s34
    s_mov_b32 s25, s35
    s_mov_b32 s26, 0x1000
    s_mov_b32 s27, 0x00020000
    buffer_load_dword v191, v8, s[24:27], 0 offen
    s_add_u32 s80, s81, 0
    s_mul_hi_u32 s82, s80, 429496730
    s_mul_i32 s83, s82, 10
    s_sub_u32 s83, s80, s83
    s_mul_i32 s21, s82, 102400
    s_sub_u32 s22, s82, 8
    s_mul_i32 s22, s22, 409600
    s_cmp_ge_u32 s82, 8
    s_cselect_b32 s21, s22, s21
    s_mov_b32 s23, 10240
    s_mov_b32 s24, 15360
    s_cselect_b32 s23, 51200, s23
    s_cselect_b32 s24, 51200, s24
    s_cselect_b64 vcc, -1, 0
    v_cndmask_b32 v8, v120, v9, vcc
    s_lshl_b32 s22, s83, 7
    s_add_u32 s21, s21, s22
    s_add_u32 m0, s90, 0
    s_nop 0
    buffer_load_dwordx4 v8, s[84:87], s21 offen lds
    s_add_u32 s21, s21, s23
    s_add_u32 m0, s90, 1024
    s_nop 0
    buffer_load_dwordx4 v8, s[84:87], s21 offen lds
    s_add_u32 s21, s21, s24
    s_add_u32 m0, s90, 2048
    s_nop 0
    buffer_load_dwordx4 v8, s[84:87], s21 offen lds
    s_add_u32 s21, s21, s23
    s_add_u32 m0, s90, 3072
    s_nop 0
    buffer_load_dwordx4 v8, s[84:87], s21 offen lds
    s_add_u32 s21, s21, s24
    s_add_u32 m0, s90, 4096
    s_nop 0
    buffer_load_dwordx4 v8, s[84:87], s21 offen lds
    s_add_u32 s21, s21, s23
    s_add_u32 m0, s90, 5120
    s_nop 0
    buffer_load_dwordx4 v8, s[84:87], s21 offen lds
    s_add_u32 s21, s21, s24
    s_add_u32 m0, s90, 6144
    s_nop 0
    buffer_load_dwordx4 v8, s[84:87], s21 offen lds
    s_add_u32 s21, s21, s23
    s_add_u32 m0, s90, 7168
    s_nop 0
    buffer_load_dwordx4 v8, s[84:87], s21 offen lds
    s_add_u32 s21, s21, s24
    s_lshl_b32 s22, s83, 2
    v_lshrrev_b32 v12, 4, v0
    v_add_u32 v12, s22, v12
    v_mul_u32_u24 v10, 52, v12
    v_lshrrev_b32 v10, 8, v10
    s_mov_b32 s22, 97280
    v_mul_lo_u32 v10, v10, s22
    v_lshl_add_u32 v10, v12, 10, v10
    v_and_b32 v12, 15, v0
    v_lshl_add_u32 v122, v12, 4, v10
    s_mul_i32 s22, s82, 10240
    s_add_u32 s22, s22, 15489792
    s_cmp_lt_u32 s80, 100
    s_cselect_b32 s22, s22, 1073741824
    v_add_u32 v122, s22, v122
    s_add_u32 s80, s81, 64
    s_mul_hi_u32 s82, s80, 429496730
    s_mul_i32 s83, s82, 10
    s_sub_u32 s83, s80, s83
    s_mul_i32 s21, s82, 102400
    s_sub_u32 s22, s82, 8
    s_mul_i32 s22, s22, 409600
    s_cmp_ge_u32 s82, 8
    s_cselect_b32 s21, s22, s21
    s_mov_b32 s23, 10240
    s_mov_b32 s24, 15360
    s_cselect_b32 s23, 51200, s23
    s_cselect_b32 s24, 51200, s24
    s_cselect_b64 vcc, -1, 0
    v_cndmask_b32 v8, v120, v9, vcc
    s_lshl_b32 s22, s83, 7
    s_add_u32 s21, s21, s22
    s_add_u32 m0, s90, 8192
    s_nop 0
    buffer_load_dwordx4 v8, s[84:87], s21 offen lds
    s_add_u32 s21, s21, s23
    s_add_u32 m0, s90, 9216
    s_nop 0
    buffer_load_dwordx4 v8, s[84:87], s21 offen lds
    s_add_u32 s21, s21, s24
    s_add_u32 m0, s90, 10240
    s_nop 0
    buffer_load_dwordx4 v8, s[84:87], s21 offen lds
    s_add_u32 s21, s21, s23
    s_add_u32 m0, s90, 11264
    s_nop 0
    buffer_load_dwordx4 v8, s[84:87], s21 offen lds
    s_add_u32 s21, s21, s24
    s_add_u32 m0, s90, 12288
    s_nop 0
    buffer_load_dwordx4 v8, s[84:87], s21 offen lds
    s_add_u32 s21, s21, s23
    s_add_u32 m0, s90, 13312
    s_nop 0
    buffer_load_dwordx4 v8, s[84:87], s21 offen lds
    s_add_u32 s21, s21, s24
    s_add_u32 m0, s90, 14336
    s_nop 0
    buffer_load_dwordx4 v8, s[84:87], s21 offen lds
    s_add_u32 s21, s21, s23
    s_add_u32 m0, s90, 15360
    s_nop 0
    buffer_load_dwordx4 v8, s[84:87], s21 offen lds
    s_add_u32 s21, s21, s24
    s_lshl_b32 s22, s83, 2
    v_lshrrev_b32 v12, 4, v0
    v_add_u32 v12, s22, v12
    v_mul_u32_u24 v10, 52, v12
    v_lshrrev_b32 v10, 8, v10
    s_mov_b32 s22, 97280
    v_mul_lo_u32 v10, v10, s22
    v_lshl_add_u32 v10, v12, 10, v10
    v_and_b32 v12, 15, v0
    v_lshl_add_u32 v123, v12, 4, v10
    s_mul_i32 s22, s82, 10240
    s_add_u32 s22, s22, 15489792
    s_cmp_lt_u32 s80, 100
    s_cselect_b32 s22, s22, 1073741824
    v_add_u32 v123, s22, v123
    s_call_b64 s[92:93], L_rompt_kernel_spin
    ds_read_b64_tr_b16 v[20:21], v13 offset:0
    ds_read_b64_tr_b16 v[22:23], v13 offset:512
    ds_read_b64_tr_b16 v[24:25], v13 offset:1024
    ds_read_b64_tr_b16 v[26:27], v13 offset:1536
    ds_read_b64_tr_b16 v[28:29], v13 offset:2048
    ds_read_b64_tr_b16 v[30:31], v13 offset:2560
    ds_read_b64_tr_b16 v[32:33], v13 offset:3072
    ds_read_b64_tr_b16 v[34:35], v13 offset:3584
    ds_read_b64_tr_b16 v[36:37], v13 offset:4096
    ds_read_b64_tr_b16 v[38:39], v13 offset:4608
    ds_read_b64_tr_b16 v[40:41], v13 offset:5120
    ds_read_b64_tr_b16 v[42:43], v13 offset:5632
    ds_read_b64_tr_b16 v[44:45], v13 offset:6144
    ds_read_b64_tr_b16 v[46:47], v13 offset:6656
    ds_read_b64_tr_b16 v[48:49], v13 offset:7168
    ds_read_b64_tr_b16 v[50:51], v13 offset:7680
    ds_read_b64_tr_b16 v[52:53], v13 offset:8192
    ds_read_b64_tr_b16 v[54:55], v13 offset:8704
    ds_read_b64_tr_b16 v[56:57], v13 offset:9216
    ds_read_b64_tr_b16 v[58:59], v13 offset:9728
    ds_read_b64_tr_b16 v[60:61], v13 offset:10240
    ds_read_b64_tr_b16 v[62:63], v13 offset:10752
    ds_read_b64_tr_b16 v[64:65], v13 offset:11264
    ds_read_b64_tr_b16 v[66:67], v13 offset:11776
    ds_read_b64_tr_b16 v[68:69], v13 offset:12288
    ds_read_b64_tr_b16 v[70:71], v13 offset:12800
    ds_read_b64_tr_b16 v[72:73], v13 offset:13312
    ds_read_b64_tr_b16 v[74:75], v13 offset:13824
    ds_read_b64_tr_b16 v[76:77], v13 offset:14336
    ds_read_b64_tr_b16 v[78:79], v13 offset:14848
    ds_read_b64_tr_b16 v[80:81], v13 offset:15360
    ds_read_b64_tr_b16 v[82:83], v13 offset:15872
    s_mov_b32 s24, s30
    s_mov_b32 s25, s31
    s_mov_b32 s26, 0xc00
    s_mov_b32 s27, 0x00020000
    s_lshl_b32 s23, s64, 1
    v_lshlrev_b32 v3, 3, v251
    buffer_load_dwordx2 v[210:211], v3, s[24:27], s23 offen offset:0
    buffer_load_dwordx2 v[212:213], v3, s[24:27], s23 offen offset:32
    buffer_load_dwordx2 v[214:215], v3, s[24:27], s23 offen offset:64
    buffer_load_dwordx2 v[216:217], v3, s[24:27], s23 offen offset:96
    s_mov_b32 s24, s34
    s_mov_b32 s25, s35
    s_mov_b32 s26, 0x1000
    s_mov_b32 s27, 0x00020000
    v_lshlrev_b32 v3, 1, v250
    s_lshl_b32 s23, s63, 1
    buffer_load_ushort v218, v3, s[24:27], s23 offen
    s_mov_b32 s21, 5120
    s_waitcnt lgkmcnt(0)
    buffer_store_dwordx4 v[20:23], v122, s[8:11], 0 offen offset:0 sc1
    buffer_store_dwordx4 v[24:27], v122, s[8:11], 0 offen offset:256 sc1
    buffer_store_dwordx4 v[28:31], v122, s[8:11], 0 offen offset:512 sc1
    buffer_store_dwordx4 v[32:35], v122, s[8:11], 0 offen offset:768 sc1
    buffer_store_dwordx4 v[36:39], v122, s[8:11], s21 offen offset:0 sc1
    buffer_store_dwordx4 v[40:43], v122, s[8:11], s21 offen offset:256 sc1
    buffer_store_dwordx4 v[44:47], v122, s[8:11], s21 offen offset:512 sc1
    buffer_store_dwordx4 v[48:51], v122, s[8:11], s21 offen offset:768 sc1
    buffer_store_dwordx4 v[52:55], v123, s[8:11], 0 offen offset:0 sc1
    buffer_store_dwordx4 v[56:59], v123, s[8:11], 0 offen offset:256 sc1
    buffer_store_dwordx4 v[60:63], v123, s[8:11], 0 offen offset:512 sc1
    buffer_store_dwordx4 v[64:67], v123, s[8:11], 0 offen offset:768 sc1
    buffer_store_dwordx4 v[68:71], v123, s[8:11], s21 offen offset:0 sc1
    buffer_store_dwordx4 v[72:75], v123, s[8:11], s21 offen offset:256 sc1
    buffer_store_dwordx4 v[76:79], v123, s[8:11], s21 offen offset:512 sc1
    buffer_store_dwordx4 v[80:83], v123, s[8:11], s21 offen offset:768 sc1
    s_mov_b32 s21, 0
    s_mov_b32 s22, 32
    s_mov_b32 s23, 3
    s_branch L_rompt_kernel_asig
L_rompt_kernel_codeend:
L_rompt_kernel_c0:
    s_mov_b32 s91, 0
    buffer_load_dwordx4 v[88:91], v236, s[8:11], s91 offen sc1
    s_sub_u32 s87, s87, 1
    s_cmp_lt_i32 s87, 0
    s_waitcnt vmcnt(0)
    s_cbranch_scc1 L_rompt_kernel_c0r
    v_cmp_eq_u32 vcc, -1, v91
    s_cbranch_vccnz L_rompt_kernel_c0
    s_branch L_rompt_kernel_c0r
L_rompt_kernel_c1:
    s_mov_b32 s91, 134144
    buffer_load_dwordx4 v[92:95], v236, s[8:11], s91 offen sc1
    s_sub_u32 s87, s87, 1
    s_cmp_lt_i32 s87, 0
    s_waitcnt vmcnt(0)
    s_cbranch_scc1 L_rompt_kernel_c1r
    v_cmp_eq_u32 vcc, -1, v95
    s_cbranch_vccnz L_rompt_kernel_c1
    s_branch L_rompt_kernel_c1r
L_rompt_kernel_c2:
    s_mov_b32 s91, 268288
    buffer_load_dwordx4 v[96:99], v236, s[8:11], s91 offen sc1
    s_sub_u32 s87, s87, 1
    s_cmp_lt_i32 s87, 0
    s_waitcnt vmcnt(0)
    s_cbranch_scc1 L_rompt_kernel_c2r
    v_cmp_eq_u32 vcc, -1, v99
    s_cbranch_vccnz L_rompt_kernel_c2
    s_branch L_rompt_kernel_c2r
L_rompt_kernel_c3:
    s_mov_b32 s91, 402432
    buffer_load_dwordx4 v[100:103], v236, s[8:11], s91 offen sc1
    s_sub_u32 s87, s87, 1
    s_cmp_lt_i32 s87, 0
    s_waitcnt vmcnt(0)
    s_cbranch_scc1 L_rompt_kernel_c3r
    v_cmp_eq_u32 vcc, -1, v103
    s_cbranch_vccnz L_rompt_kernel_c3
    s_branch L_rompt_kernel_c3r
L_rompt_kernel_c4:
    s_mov_b32 s91, 536576
    buffer_load_dwordx4 v[104:107], v236, s[8:11], s91 offen sc1
    s_sub_u32 s87, s87, 1
    s_cmp_lt_i32 s87, 0
    s_waitcnt vmcnt(0)
    s_cbranch_scc1 L_rompt_kernel_c4r
    v_cmp_eq_u32 vcc, -1, v107
    s_cbranch_vccnz L_rompt_kernel_c4
    s_branch L_rompt_kernel_c4r
L_rompt_kernel_c5:
    s_mov_b32 s91, 670720
    buffer_load_dwordx4 v[108:111], v236, s[8:11], s91 offen sc1
    s_sub_u32 s87, s87, 1
    s_cmp_lt_i32 s87, 0
    s_waitcnt vmcnt(0)
    s_cbranch_scc1 L_rompt_kernel_c5r
    v_cmp_eq_u32 vcc, -1, v111
    s_cbranch_vccnz L_rompt_kernel_c5
    s_branch L_rompt_kernel_c5r
L_rompt_kernel_c6:
    s_mov_b32 s91, 804864
    buffer_load_dwordx4 v[112:115], v236, s[8:11], s91 offen sc1
    s_sub_u32 s87, s87, 1
    s_cmp_lt_i32 s87, 0
    s_waitcnt vmcnt(0)
    s_cbranch_scc1 L_rompt_kernel_c6r
    v_cmp_eq_u32 vcc, -1, v115
    s_cbranch_vccnz L_rompt_kernel_c6
    s_branch L_rompt_kernel_c6r
L_rompt_kernel_c7:
    s_mov_b32 s91, 939008
    buffer_load_dwordx4 v[116:119], v236, s[8:11], s91 offen sc1
    s_sub_u32 s87, s87, 1
    s_cmp_lt_i32 s87, 0
    s_waitcnt vmcnt(0)
    s_cbranch_scc1 L_rompt_kernel_c7r
    v_cmp_eq_u32 vcc, -1, v119
    s_cbranch_vccnz L_rompt_kernel_c7
    s_branch L_rompt_kernel_c7r
L_rompt_kernel_c8:
    s_mov_b32 s91, 1073152
    buffer_load_dwordx4 v[120:123], v236, s[8:11], s91 offen sc1
    s_sub_u32 s87, s87, 1
    s_cmp_lt_i32 s87, 0
    s_waitcnt vmcnt(0)
    s_cbranch_scc1 L_rompt_kernel_c8r
    v_cmp_eq_u32 vcc, -1, v123
    s_cbranch_vccnz L_rompt_kernel_c8
    s_branch L_rompt_kernel_c8r
L_rompt_kernel_c9:
    s_mov_b32 s91, 1207296
    buffer_load_dwordx4 v[124:127], v236, s[8:11], s91 offen sc1
    s_sub_u32 s87, s87, 1
    s_cmp_lt_i32 s87, 0
    s_waitcnt vmcnt(0)
    s_cbranch_scc1 L_rompt_kernel_c9r
    v_cmp_eq_u32 vcc, -1, v127
    s_cbranch_vccnz L_rompt_kernel_c9
    s_branch L_rompt_kernel_c9r
L_rompt_kernel_c10:
    s_mov_b32 s91, 1341440
    buffer_load_dwordx4 v[128:131], v236, s[8:11], s91 offen sc1
    s_sub_u32 s87, s87, 1
    s_cmp_lt_i32 s87, 0
    s_waitcnt vmcnt(0)
    s_cbranch_scc1 L_rompt_kernel_c10r
    v_cmp_eq_u32 vcc, -1, v131
    s_cbranch_vccnz L_rompt_kernel_c10
    s_branch L_rompt_kernel_c10r
L_rompt_kernel_c11:
    s_mov_b32 s91, 1475584
    buffer_load_dwordx4 v[132:135], v236, s[8:11], s91 offen sc1
    s_sub_u32 s87, s87, 1
    s_cmp_lt_i32 s87, 0
    s_waitcnt vmcnt(0)
    s_cbranch_scc1 L_rompt_kernel_c11r
    v_cmp_eq_u32 vcc, -1, v135
    s_cbranch_vccnz L_rompt_kernel_c11
    s_branch L_rompt_kernel_c11r
L_rompt_kernel_c12:
    s_mov_b32 s91, 1609728
    buffer_load_dwordx4 v[136:139], v236, s[8:11], s91 offen sc1
    s_sub_u32 s87, s87, 1
    s_cmp_lt_i32 s87, 0
    s_waitcnt vmcnt(0)
    s_cbranch_scc1 L_rompt_kernel_c12r
    v_cmp_eq_u32 vcc, -1, v139
    s_cbranch_vccnz L_rompt_kernel_c12
    s_branch L_rompt_kernel_c12r
L_rompt_kernel_c13:
    s_mov_b32 s91, 1743872
    buffer_load_dwordx4 v[140:143], v236, s[8:11], s91 offen sc1
    s_sub_u32 s87, s87, 1
    s_cmp_lt_i32 s87, 0
    s_waitcnt vmcnt(0)
    s_cbranch_scc1 L_rompt_kernel_c13r
    v_cmp_eq_u32 vcc, -1, v143
    s_cbranch_vccnz L_rompt_kernel_c13
    s_branch L_rompt_kernel_c13r
L_rompt_kernel_c14:
    s_mov_b32 s91, 1878016
    buffer_load_dwordx4 v[144:147], v236, s[8:11], s91 offen sc1
    s_sub_u32 s87, s87, 1
    s_cmp_lt_i32 s87, 0
    s_waitcnt vmcnt(0)
    s_cbranch_scc1 L_rompt_kernel_c14r
    v_cmp_eq_u32 vcc, -1, v147
    s_cbranch_vccnz L_rompt_kernel_c14
    s_branch L_rompt_kernel_c14r
L_rompt_kernel_c15:
    s_mov_b32 s91, 2012160
    buffer_load_dwordx4 v[148:151], v236, s[8:11], s91 offen sc1
    s_sub_u32 s87, s87, 1
    s_cmp_lt_i32 s87, 0
    s_waitcnt vmcnt(0)
    s_cbranch_scc1 L_rompt_kernel_c15r
    v_cmp_eq_u32 vcc, -1, v151
    s_cbranch_vccnz L_rompt_kernel_c15
    s_branch L_rompt_kernel_c15r
L_rompt_kernel_c16:
    s_mov_b32 s91, 0
    buffer_load_dwordx2 v[152:153], v237, s[8:11], s91 offen sc1
    s_mov_b32 s91, 16384
    buffer_load_dwordx2 v[154:155], v237, s[8:11], s91 offen sc1
    s_sub_u32 s87, s87, 1
    s_cmp_lt_i32 s87, 0
    s_waitcnt vmcnt(0)
    s_cbranch_scc1 L_rompt_kernel_c16r
    v_max_u32 v6, v153, v155
    v_cmp_eq_u32 vcc, -1, v6
    s_cbranch_vccnz L_rompt_kernel_c16
    s_branch L_rompt_kernel_c16r
L_rompt_kernel_c17:
    s_mov_b32 s91, 131072
    buffer_load_dwordx2 v[156:157], v237, s[8:11], s91 offen sc1
    s_mov_b32 s91, 147456
    buffer_load_dwordx2 v[158:159], v237, s[8:11], s91 offen sc1
    s_sub_u32 s87, s87, 1
    s_cmp_lt_i32 s87, 0
    s_waitcnt vmcnt(0)
    s_cbranch_scc1 L_rompt_kernel_c17r
    v_max_u32 v6, v157, v159
    v_cmp_eq_u32 vcc, -1, v6
    s_cbranch_vccnz L_rompt_kernel_c17
    s_branch L_rompt_kernel_c17r
L_rompt_kernel_c18:
    s_mov_b32 s91, 262144
    buffer_load_dwordx2 v[160:161], v237, s[8:11], s91 offen sc1
    s_mov_b32 s91, 278528
    buffer_load_dwordx2 v[162:163], v237, s[8:11], s91 offen sc1
    s_sub_u32 s87, s87, 1
    s_cmp_lt_i32 s87, 0
    s_waitcnt vmcnt(0)
    s_cbranch_scc1 L_rompt_kernel_c18r
    v_max_u32 v6, v161, v163
    v_cmp_eq_u32 vcc, -1, v6
    s_cbranch_vccnz L_rompt_kernel_c18
    s_branch L_rompt_kernel_c18r
L_rompt_kernel_c19:
    s_mov_b32 s91, 393216
    buffer_load_dwordx2 v[164:165], v237, s[8:11], s91 offen sc1
    s_mov_b32 s91, 409600
    buffer_load_dwordx2 v[166:167], v237, s[8:11], s91 offen sc1
    s_sub_u32 s87, s87, 1
    s_cmp_lt_i32 s87, 0
    s_waitcnt vmcnt(0)
    s_cbranch_scc1 L_rompt_kernel_c19r
    v_max_u32 v6, v165, v167
    v_cmp_eq_u32 vcc, -1, v6
    s_cbranch_vccnz L_rompt_kernel_c19
    s_branch L_rompt_kernel_c19r
L_rompt_kernel_d0:
    buffer_load_dwordx4 v[88:91], v244, s[48:51], s80 offen sc1
    s_sub_u32 s87, s87, 1
    s_cmp_lt_i32 s87, 0
    s_waitcnt vmcnt(0)
    s_cbranch_scc1 L_rompt_kernel_d0r
    v_cmp_eq_u32 vcc, -1, v91
    s_cbranch_vccnz L_rompt_kernel_d0
    s_branch L_rompt_kernel_d0r
L_rompt_kernel_d1:
    buffer_load_dwordx4 v[92:95], v244, s[48:51], s81 offen sc1
    s_sub_u32 s87, s87, 1
    s_cmp_lt_i32 s87, 0
    s_waitcnt vmcnt(0)
    s_cbranch_scc1 L_rompt_kernel_d1r
    v_cmp_eq_u32 vcc, -1, v95
    s_cbranch_vccnz L_rompt_kernel_d1
    s_branch L_rompt_kernel_d1r
L_rompt_kernel_d2:
    buffer_load_dwordx4 v[96:99], v244, s[48:51], s82 offen sc1
    s_sub_u32 s87, s87, 1
    s_cmp_lt_i32 s87, 0
    s_waitcnt vmcnt(0)
    s_cbranch_scc1 L_rompt_kernel_d2r
    v_cmp_eq_u32 vcc, -1, v99
    s_cbranch_vccnz L_rompt_kernel_d2
    s_branch L_rompt_kernel_d2r
L_rompt_kernel_d3:
    buffer_load_dwordx4 v[100:103], v244, s[48:51], s83 offen sc1
    s_sub_u32 s87, s87, 1
    s_cmp_lt_i32 s87, 0
    s_waitcnt vmcnt(0)
    s_cbranch_scc1 L_rompt_kernel_d3r
    v_cmp_eq_u32 vcc, -1, v103
    s_cbranch_vccnz L_rompt_kernel_d3
    s_branch L_rompt_kernel_d3r
L_rompt_kernel_d4:
    s_add_u32 s91, s80, 655360
    buffer_load_dwordx4 v[104:107], v244, s[48:51], s91 offen sc1
    s_add_u32 s91, s81, 655360
    buffer_load_dwordx4 v[108:111], v244, s[48:51], s91 offen sc1
    s_add_u32 s91, s82, 655360
    buffer_load_dwordx4 v[112:115], v244, s[48:51], s91 offen sc1
    s_add_u32 s91, s83, 655360
    buffer_load_dwordx4 v[116:119], v244, s[48:51], s91 offen sc1
    s_sub_u32 s87, s87, 1
    s_cmp_lt_i32 s87, 0
    s_waitcnt vmcnt(0)
    s_cbranch_scc1 L_rompt_kernel_d4r
    v_max3_u32 v6, v107, v111, v115
    v_max_u32 v6, v6, v119
    v_cmp_eq_u32 vcc, -1, v6
    s_cbranch_vccnz L_rompt_kernel_d4
    s_branch L_rompt_kernel_d4r
L_rompt_kernel_d8:
    s_add_u32 s91, s80, 1310720
    buffer_load_dwordx4 v[120:123], v244, s[48:51], s91 offen sc1
    s_add_u32 s91, s81, 1310720
    buffer_load_dwordx4 v[124:127], v244, s[48:51], s91 offen sc1
    s_add_u32 s91, s82, 1310720
    buffer_load_dwordx4 v[128:131], v244, s[48:51], s91 offen sc1
    s_add_u32 s91, s83, 1310720
    buffer_load_dwordx4 v[132:135], v244, s[48:51], s91 offen sc1
    s_sub_u32 s87, s87, 1
    s_cmp_lt_i32 s87, 0
    s_waitcnt vmcnt(0)
    s_cbranch_scc1 L_rompt_kernel_d8r
    v_max3_u32 v6, v123, v127, v131
    v_max_u32 v6, v6, v135
    v_cmp_eq_u32 vcc, -1, v6
    s_cbranch_vccnz L_rompt_kernel_d8
    s_branch L_rompt_kernel_d8r
L_rompt_kernel_d12:
    s_add_u32 s91, s80, 1966080
    buffer_load_dwordx4 v[136:139], v244, s[48:51], s91 offen sc1
    s_add_u32 s91, s81, 1966080
    buffer_load_dwordx4 v[140:143], v244, s[48:51], s91 offen sc1
    s_add_u32 s91, s82, 1966080
    buffer_load_dwordx4 v[144:147], v244, s[48:51], s91 offen sc1
    s_add_u32 s91, s83, 1966080
    buffer_load_dwordx4 v[88:91], v244, s[48:51], s91 offen sc1
    s_sub_u32 s87, s87, 1
    s_cmp_lt_i32 s87, 0
    s_waitcnt vmcnt(0)
    s_cbranch_scc1 L_rompt_kernel_d12r
    v_max3_u32 v6, v139, v143, v147
    v_max_u32 v6, v6, v91
    v_cmp_eq_u32 vcc, -1, v6
    s_cbranch_vccnz L_rompt_kernel_d12
    s_branch L_rompt_kernel_d12r
L_rompt_kernel_d16:
    buffer_load_dwordx4 v[92:95], v245, s[48:51], s80 offen sc1
    buffer_load_dwordx4 v[96:99], v245, s[48:51], s81 offen sc1
    buffer_load_dwordx4 v[100:103], v245, s[48:51], s82 offen sc1
    buffer_load_dwordx4 v[104:107], v245, s[48:51], s83 offen sc1
    s_sub_u32 s87, s87, 1
    s_cmp_lt_i32 s87, 0
    s_waitcnt vmcnt(0)
    s_cbranch_scc1 L_rompt_kernel_d16r
    v_max3_u32 v6, v95, v99, v103
    v_max_u32 v6, v6, v107
    v_cmp_eq_u32 vcc, -1, v6
    s_cbranch_vccnz L_rompt_kernel_d16
    s_branch L_rompt_kernel_d16r
L_rompt_kernel_d20:
    s_add_u32 s91, s80, 655360
    buffer_load_dwordx4 v[108:111], v245, s[48:51], s91 offen sc1
    s_add_u32 s91, s81, 655360
    buffer_load_dwordx4 v[112:115], v245, s[48:51], s91 offen sc1
    s_add_u32 s91, s82, 655360
    buffer_load_dwordx4 v[116:119], v245, s[48:51], s91 offen sc1
    s_add_u32 s91, s83, 655360
    buffer_load_dwordx4 v[120:123], v245, s[48:51], s91 offen sc1
    s_sub_u32 s87, s87, 1
    s_cmp_lt_i32 s87, 0
    s_waitcnt vmcnt(0)
    s_cbranch_scc1 L_rompt_kernel_d20r
    v_max3_u32 v6, v111, v115, v119
    v_max_u32 v6, v6, v123
    v_cmp_eq_u32 vcc, -1, v6
    s_cbranch_vccnz L_rompt_kernel_d20
    s_branch L_rompt_kernel_d20r
L_rompt_kernel_d24:
    s_add_u32 s91, s80, 1310720
    buffer_load_dwordx4 v[124:127], v245, s[48:51], s91 offen sc1
    s_add_u32 s91, s81, 1310720
    buffer_load_dwordx4 v[128:131], v245, s[48:51], s91 offen sc1
    s_add_u32 s91, s82, 1310720
    buffer_load_dwordx4 v[132:135], v245, s[48:51], s91 offen sc1
    s_add_u32 s91, s83, 1310720
    buffer_load_dwordx4 v[136:139], v245, s[48:51], s91 offen sc1
    s_sub_u32 s87, s87, 1
    s_cmp_lt_i32 s87, 0
    s_waitcnt vmcnt(0)
    s_cbranch_scc1 L_rompt_kernel_d24r
    v_max3_u32 v6, v127, v131, v135
    v_max_u32 v6, v6, v139
    v_cmp_eq_u32 vcc, -1, v6
    s_cbranch_vccnz L_rompt_kernel_d24
    s_branch L_rompt_kernel_d24r
L_rompt_kernel_d28:
    s_add_u32 s91, s80, 1966080
    buffer_load_dwordx4 v[140:143], v245, s[48:51], s91 offen sc1
    s_add_u32 s91, s81, 1966080
    buffer_load_dwordx4 v[144:147], v245, s[48:51], s91 offen sc1
    s_add_u32 s91, s82, 1966080
    buffer_load_dwordx4 v[88:91], v245, s[48:51], s91 offen sc1
    s_add_u32 s91, s83, 1966080
    buffer_load_dwordx4 v[92:95], v245, s[48:51], s91 offen sc1
    s_sub_u32 s87, s87, 1
    s_cmp_lt_i32 s87, 0
    s_waitcnt vmcnt(0)
    s_cbranch_scc1 L_rompt_kernel_d28r
    v_max3_u32 v6, v143, v147, v91
    v_max_u32 v6, v6, v95
    v_cmp_eq_u32 vcc, -1, v6
    s_cbranch_vccnz L_rompt_kernel_d28
    s_branch L_rompt_kernel_d28r
L_rompt_kernel_d32:
    buffer_load_dwordx4 v[96:99], v246, s[48:51], s80 offen sc1
    buffer_load_dwordx4 v[100:103], v246, s[48:51], s81 offen sc1
    buffer_load_dwordx4 v[104:107], v246, s[48:51], s82 offen sc1
    buffer_load_dwordx4 v[108:111], v246, s[48:51], s83 offen sc1
    s_sub_u32 s87, s87, 1
    s_cmp_lt_i32 s87, 0
    s_waitcnt vmcnt(0)
    s_cbranch_scc1 L_rompt_kernel_d32r
    v_max3_u32 v6, v99, v103, v107
    v_max_u32 v6, v6, v111
    v_cmp_eq_u32 vcc, -1, v6
    s_cbranch_vccnz L_rompt_kernel_d32
    s_branch L_rompt_kernel_d32r
L_rompt_kernel_d36:
    s_add_u32 s91, s80, 655360
    buffer_load_dwordx4 v[112:115], v246, s[48:51], s91 offen sc1
    s_add_u32 s91, s81, 655360
    buffer_load_dwordx4 v[116:119], v246, s[48:51], s91 offen sc1
    s_add_u32 s91, s82, 655360
    buffer_load_dwordx4 v[120:123], v246, s[48:51], s91 offen sc1
    s_add_u32 s91, s83, 655360
    buffer_load_dwordx4 v[124:127], v246, s[48:51], s91 offen sc1
    s_sub_u32 s87, s87, 1
    s_cmp_lt_i32 s87, 0
    s_waitcnt vmcnt(0)
    s_cbranch_scc1 L_rompt_kernel_d36r
    v_max3_u32 v6, v115, v119, v123
    v_max_u32 v6, v6, v127
    v_cmp_eq_u32 vcc, -1, v6
    s_cbranch_vccnz L_rompt_kernel_d36
    s_branch L_rompt_kernel_d36r
L_rompt_kernel_d40:
    s_add_u32 s91, s80, 1310720
    buffer_load_dwordx4 v[128:131], v246, s[48:51], s91 offen sc1
    s_add_u32 s91, s81, 1310720
    buffer_load_dwordx4 v[132:135], v246, s[48:51], s91 offen sc1
    s_add_u32 s91, s82, 1310720
    buffer_load_dwordx4 v[136:139], v246, s[48:51], s91 offen sc1
    s_add_u32 s91, s83, 1310720
    buffer_load_dwordx4 v[140:143], v246, s[48:51], s91 offen sc1
    s_sub_u32 s87, s87, 1
    s_cmp_lt_i32 s87, 0
    s_waitcnt vmcnt(0)
    s_cbranch_scc1 L_rompt_kernel_d40r
    v_max3_u32 v6, v131, v135, v139
    v_max_u32 v6, v6, v143
    v_cmp_eq_u32 vcc, -1, v6
    s_cbranch_vccnz L_rompt_kernel_d40
    s_branch L_rompt_kernel_d40r
L_rompt_kernel_d44:
    s_add_u32 s91, s80, 1966080
    buffer_load_dwordx4 v[144:147], v246, s[48:51], s91 offen sc1
    s_add_u32 s91, s81, 1966080
    buffer_load_dwordx4 v[88:91], v246, s[48:51], s91 offen sc1
    s_add_u32 s91, s82, 1966080
    buffer_load_dwordx4 v[92:95], v246, s[48:51], s91 offen sc1
    s_add_u32 s91, s83, 1966080
    buffer_load_dwordx4 v[96:99], v246, s[48:51], s91 offen sc1
    s_sub_u32 s87, s87, 1
    s_cmp_lt_i32 s87, 0
    s_waitcnt vmcnt(0)
    s_cbranch_scc1 L_rompt_kernel_d44r
    v_max3_u32 v6, v147, v91, v95
    v_max_u32 v6, v6, v99
    v_cmp_eq_u32 vcc, -1, v6
    s_cbranch_vccnz L_rompt_kernel_d44
    s_branch L_rompt_kernel_d44r
L_rompt_kernel_d48:
    buffer_load_dwordx4 v[100:103], v243, s[48:51], s80 offen sc1
    buffer_load_dwordx4 v[104:107], v243, s[48:51], s81 offen sc1
    buffer_load_dwordx4 v[108:111], v243, s[48:51], s82 offen sc1
    buffer_load_dwordx4 v[112:115], v243, s[48:51], s83 offen sc1
    s_sub_u32 s87, s87, 1
    s_cmp_lt_i32 s87, 0
    s_waitcnt vmcnt(0)
    s_cbranch_scc1 L_rompt_kernel_d48r
    v_max3_u32 v6, v103, v107, v111
    v_max_u32 v6, v6, v115
    v_cmp_eq_u32 vcc, -1, v6
    s_cbranch_vccnz L_rompt_kernel_d48
    s_branch L_rompt_kernel_d48r
L_rompt_kernel_d52:
    s_add_u32 s91, s80, 655360
    buffer_load_dwordx4 v[116:119], v243, s[48:51], s91 offen sc1
    s_add_u32 s91, s81, 655360
    buffer_load_dwordx4 v[120:123], v243, s[48:51], s91 offen sc1
    s_add_u32 s91, s82, 655360
    buffer_load_dwordx4 v[124:127], v243, s[48:51], s91 offen sc1
    s_add_u32 s91, s83, 655360
    buffer_load_dwordx4 v[128:131], v243, s[48:51], s91 offen sc1
    s_sub_u32 s87, s87, 1
    s_cmp_lt_i32 s87, 0
    s_waitcnt vmcnt(0)
    s_cbranch_scc1 L_rompt_kernel_d52r
    v_max3_u32 v6, v119, v123, v127
    v_max_u32 v6, v6, v131
    v_cmp_eq_u32 vcc, -1, v6
    s_cbranch_vccnz L_rompt_kernel_d52
    s_branch L_rompt_kernel_d52r
L_rompt_kernel_d56:
    s_add_u32 s91, s80, 1310720
    buffer_load_dwordx4 v[132:135], v243, s[48:51], s91 offen sc1
    s_add_u32 s91, s81, 1310720
    buffer_load_dwordx4 v[136:139], v243, s[48:51], s91 offen sc1
    s_add_u32 s91, s82, 1310720
    buffer_load_dwordx4 v[140:143], v243, s[48:51], s91 offen sc1
    s_add_u32 s91, s83, 1310720
    buffer_load_dwordx4 v[144:147], v243, s[48:51], s91 offen sc1
    s_sub_u32 s87, s87, 1
    s_cmp_lt_i32 s87, 0
    s_waitcnt vmcnt(0)
    s_cbranch_scc1 L_rompt_kernel_d56r
    v_max3_u32 v6, v135, v139, v143
    v_max_u32 v6, v6, v147
    v_cmp_eq_u32 vcc, -1, v6
    s_cbranch_vccnz L_rompt_kernel_d56
    s_branch L_rompt_kernel_d56r
L_rompt_kernel_d60:
    s_add_u32 s91, s80, 1966080
    buffer_load_dwordx4 v[88:91], v243, s[48:51], s91 offen sc1
    s_add_u32 s91, s81, 1966080
    buffer_load_dwordx4 v[92:95], v243, s[48:51], s91 offen sc1
    s_add_u32 s91, s82, 1966080
    buffer_load_dwordx4 v[96:99], v243, s[48:51], s91 offen sc1
    s_add_u32 s91, s83, 1966080
    buffer_load_dwordx4 v[100:103], v243, s[48:51], s91 offen sc1
    s_sub_u32 s87, s87, 1
    s_cmp_lt_i32 s87, 0
    s_waitcnt vmcnt(0)
    s_cbranch_scc1 L_rompt_kernel_d60r
    v_max3_u32 v6, v91, v95, v99
    v_max_u32 v6, v6, v103
    v_cmp_eq_u32 vcc, -1, v6
    s_cbranch_vccnz L_rompt_kernel_d60
    s_branch L_rompt_kernel_d60r
L_rompt_kernel_e0:
    buffer_load_dwordx4 v[88:91], v235, s[8:11], s80 offen offset:0 sc1
    s_sub_u32 s87, s87, 1
    s_cmp_lt_i32 s87, 0
    s_waitcnt vmcnt(0)
    s_cbranch_scc1 L_rompt_kernel_e0r
    v_cmp_eq_u32 vcc, -1, v91
    s_cbranch_vccnz L_rompt_kernel_e0
    s_branch L_rompt_kernel_e0r
L_rompt_kernel_e1:
    buffer_load_dwordx4 v[92:95], v235, s[8:11], s81 offen offset:0 sc1
    s_sub_u32 s87, s87, 1
    s_cmp_lt_i32 s87, 0
    s_waitcnt vmcnt(0)
    s_cbranch_scc1 L_rompt_kernel_e1r
    v_cmp_eq_u32 vcc, -1, v95
    s_cbranch_vccnz L_rompt_kernel_e1
    s_branch L_rompt_kernel_e1r
L_rompt_kernel_e2:
    buffer_load_dwordx4 v[96:99], v235, s[8:11], s82 offen offset:0 sc1
    s_sub_u32 s87, s87, 1
    s_cmp_lt_i32 s87, 0
    s_waitcnt vmcnt(0)
    s_cbranch_scc1 L_rompt_kernel_e2r
    v_cmp_eq_u32 vcc, -1, v99
    s_cbranch_vccnz L_rompt_kernel_e2
    s_branch L_rompt_kernel_e2r
L_rompt_kernel_e3:
    buffer_load_dwordx4 v[100:103], v235, s[8:11], s83 offen offset:0 sc1
    s_sub_u32 s87, s87, 1
    s_cmp_lt_i32 s87, 0
    s_waitcnt vmcnt(0)
    s_cbranch_scc1 L_rompt_kernel_e3r
    v_cmp_eq_u32 vcc, -1, v103
    s_cbranch_vccnz L_rompt_kernel_e3
    s_branch L_rompt_kernel_e3r
L_rompt_kernel_e4:
    s_add_u32 s91, s80, 655360
    buffer_load_dwordx4 v[104:107], v235, s[8:11], s91 offen offset:0 sc1
    s_add_u32 s91, s81, 655360
    buffer_load_dwordx4 v[108:111], v235, s[8:11], s91 offen offset:0 sc1
    s_add_u32 s91, s82, 655360
    buffer_load_dwordx4 v[112:115], v235, s[8:11], s91 offen offset:0 sc1
    s_add_u32 s91, s83, 655360
    buffer_load_dwordx4 v[116:119], v235, s[8:11], s91 offen offset:0 sc1
    s_sub_u32 s87, s87, 1
    s_cmp_lt_i32 s87, 0
    s_waitcnt vmcnt(0)
    s_cbranch_scc1 L_rompt_kernel_e4r
    v_max3_u32 v6, v107, v111, v115
    v_max_u32 v6, v6, v119
    v_cmp_eq_u32 vcc, -1, v6
    s_cbranch_vccnz L_rompt_kernel_e4
    s_branch L_rompt_kernel_e4r
L_rompt_kernel_e8:
    s_add_u32 s91, s80, 1310720
    buffer_load_dwordx4 v[120:123], v235, s[8:11], s91 offen offset:0 sc1
    s_add_u32 s91, s81, 1310720
    buffer_load_dwordx4 v[124:127], v235, s[8:11], s91 offen offset:0 sc1
    s_add_u32 s91, s82, 1310720
    buffer_load_dwordx4 v[128:131], v235, s[8:11], s91 offen offset:0 sc1
    s_add_u32 s91, s83, 1310720
    buffer_load_dwordx4 v[132:135], v235, s[8:11], s91 offen offset:0 sc1
    s_sub_u32 s87, s87, 1
    s_cmp_lt_i32 s87, 0
    s_waitcnt vmcnt(0)
    s_cbranch_scc1 L_rompt_kernel_e8r
    v_max3_u32 v6, v123, v127, v131
    v_max_u32 v6, v6, v135
    v_cmp_eq_u32 vcc, -1, v6
    s_cbranch_vccnz L_rompt_kernel_e8
    s_branch L_rompt_kernel_e8r
L_rompt_kernel_e12:
    buffer_load_dwordx4 v[136:139], v235, s[8:11], s80 offen offset:256 sc1
    buffer_load_dwordx4 v[140:143], v235, s[8:11], s81 offen offset:256 sc1
    buffer_load_dwordx4 v[144:147], v235, s[8:11], s82 offen offset:256 sc1
    buffer_load_dwordx4 v[88:91], v235, s[8:11], s83 offen offset:256 sc1
    s_sub_u32 s87, s87, 1
    s_cmp_lt_i32 s87, 0
    s_waitcnt vmcnt(0)
    s_cbranch_scc1 L_rompt_kernel_e12r
    v_max3_u32 v6, v139, v143, v147
    v_max_u32 v6, v6, v91
    v_cmp_eq_u32 vcc, -1, v6
    s_cbranch_vccnz L_rompt_kernel_e12
    s_branch L_rompt_kernel_e12r
L_rompt_kernel_e16:
    s_add_u32 s91, s80, 655360
    buffer_load_dwordx4 v[92:95], v235, s[8:11], s91 offen offset:256 sc1
    s_add_u32 s91, s81, 655360
    buffer_load_dwordx4 v[96:99], v235, s[8:11], s91 offen offset:256 sc1
    s_add_u32 s91, s82, 655360
    buffer_load_dwordx4 v[100:103], v235, s[8:11], s91 offen offset:256 sc1
    s_add_u32 s91, s83, 655360
    buffer_load_dwordx4 v[104:107], v235, s[8:11], s91 offen offset:256 sc1
    s_sub_u32 s87, s87, 1
    s_cmp_lt_i32 s87, 0
    s_waitcnt vmcnt(0)
    s_cbranch_scc1 L_rompt_kernel_e16r
    v_max3_u32 v6, v95, v99, v103
    v_max_u32 v6, v6, v107
    v_cmp_eq_u32 vcc, -1, v6
    s_cbranch_vccnz L_rompt_kernel_e16
    s_branch L_rompt_kernel_e16r
L_rompt_kernel_e20:
    s_add_u32 s91, s80, 1310720
    buffer_load_dwordx4 v[108:111], v235, s[8:11], s91 offen offset:256 sc1
    s_add_u32 s91, s81, 1310720
    buffer_load_dwordx4 v[112:115], v235, s[8:11], s91 offen offset:256 sc1
    s_add_u32 s91, s82, 1310720
    buffer_load_dwordx4 v[116:119], v235, s[8:11], s91 offen offset:256 sc1
    s_add_u32 s91, s83, 1310720
    buffer_load_dwordx4 v[120:123], v235, s[8:11], s91 offen offset:256 sc1
    s_sub_u32 s87, s87, 1
    s_cmp_lt_i32 s87, 0
    s_waitcnt vmcnt(0)
    s_cbranch_scc1 L_rompt_kernel_e20r
    v_max3_u32 v6, v111, v115, v119
    v_max_u32 v6, v6, v123
    v_cmp_eq_u32 vcc, -1, v6
    s_cbranch_vccnz L_rompt_kernel_e20
    s_branch L_rompt_kernel_e20r
L_rompt_kernel_e24:
    buffer_load_dwordx4 v[124:127], v235, s[8:11], s80 offen offset:512 sc1
    buffer_load_dwordx4 v[128:131], v235, s[8:11], s81 offen offset:512 sc1
    buffer_load_dwordx4 v[132:135], v235, s[8:11], s82 offen offset:512 sc1
    buffer_load_dwordx4 v[136:139], v235, s[8:11], s83 offen offset:512 sc1
    s_sub_u32 s87, s87, 1
    s_cmp_lt_i32 s87, 0
    s_waitcnt vmcnt(0)
    s_cbranch_scc1 L_rompt_kernel_e24r
    v_max3_u32 v6, v127, v131, v135
    v_max_u32 v6, v6, v139
    v_cmp_eq_u32 vcc, -1, v6
    s_cbranch_vccnz L_rompt_kernel_e24
    s_branch L_rompt_kernel_e24r
L_rompt_kernel_e28:
    s_add_u32 s91, s80, 655360
    buffer_load_dwordx4 v[140:143], v235, s[8:11], s91 offen offset:512 sc1
    s_add_u32 s91, s81, 655360
    buffer_load_dwordx4 v[144:147], v235, s[8:11], s91 offen offset:512 sc1
    s_add_u32 s91, s82, 655360
    buffer_load_dwordx4 v[88:91], v235, s[8:11], s91 offen offset:512 sc1
    s_add_u32 s91, s83, 655360
    buffer_load_dwordx4 v[92:95], v235, s[8:11], s91 offen offset:512 sc1
    s_sub_u32 s87, s87, 1
    s_cmp_lt_i32 s87, 0
    s_waitcnt vmcnt(0)
    s_cbranch_scc1 L_rompt_kernel_e28r
    v_max3_u32 v6, v143, v147, v91
    v_max_u32 v6, v6, v95
    v_cmp_eq_u32 vcc, -1, v6
    s_cbranch_vccnz L_rompt_kernel_e28
    s_branch L_rompt_kernel_e28r
L_rompt_kernel_e32:
    s_add_u32 s91, s80, 1310720
    buffer_load_dwordx4 v[96:99], v235, s[8:11], s91 offen offset:512 sc1
    s_add_u32 s91, s81, 1310720
    buffer_load_dwordx4 v[100:103], v235, s[8:11], s91 offen offset:512 sc1
    s_add_u32 s91, s82, 1310720
    buffer_load_dwordx4 v[104:107], v235, s[8:11], s91 offen offset:512 sc1
    s_add_u32 s91, s83, 1310720
    buffer_load_dwordx4 v[108:111], v235, s[8:11], s91 offen offset:512 sc1
    s_sub_u32 s87, s87, 1
    s_cmp_lt_i32 s87, 0
    s_waitcnt vmcnt(0)
    s_cbranch_scc1 L_rompt_kernel_e32r
    v_max3_u32 v6, v99, v103, v107
    v_max_u32 v6, v6, v111
    v_cmp_eq_u32 vcc, -1, v6
    s_cbranch_vccnz L_rompt_kernel_e32
    s_branch L_rompt_kernel_e32r
L_rompt_kernel_e36:
    buffer_load_dwordx4 v[112:115], v235, s[8:11], s80 offen offset:768 sc1
    buffer_load_dwordx4 v[116:119], v235, s[8:11], s81 offen offset:768 sc1
    buffer_load_dwordx4 v[120:123], v235, s[8:11], s82 offen offset:768 sc1
    buffer_load_dwordx4 v[124:127], v235, s[8:11], s83 offen offset:768 sc1
    s_sub_u32 s87, s87, 1
    s_cmp_lt_i32 s87, 0
    s_waitcnt vmcnt(0)
    s_cbranch_scc1 L_rompt_kernel_e36r
    v_max3_u32 v6, v115, v119, v123
    v_max_u32 v6, v6, v127
    v_cmp_eq_u32 vcc, -1, v6
    s_cbranch_vccnz L_rompt_kernel_e36
    s_branch L_rompt_kernel_e36r
L_rompt_kernel_e40:
    s_add_u32 s91, s80, 655360
    buffer_load_dwordx4 v[128:131], v235, s[8:11], s91 offen offset:768 sc1
    s_add_u32 s91, s81, 655360
    buffer_load_dwordx4 v[132:135], v235, s[8:11], s91 offen offset:768 sc1
    s_add_u32 s91, s82, 655360
    buffer_load_dwordx4 v[136:139], v235, s[8:11], s91 offen offset:768 sc1
    s_add_u32 s91, s83, 655360
    buffer_load_dwordx4 v[140:143], v235, s[8:11], s91 offen offset:768 sc1
    s_sub_u32 s87, s87, 1
    s_cmp_lt_i32 s87, 0
    s_waitcnt vmcnt(0)
    s_cbranch_scc1 L_rompt_kernel_e40r
    v_max3_u32 v6, v131, v135, v139
    v_max_u32 v6, v6, v143
    v_cmp_eq_u32 vcc, -1, v6
    s_cbranch_vccnz L_rompt_kernel_e40
    s_branch L_rompt_kernel_e40r
L_rompt_kernel_e44:
    s_add_u32 s91, s80, 1310720
    buffer_load_dwordx4 v[144:147], v235, s[8:11], s91 offen offset:768 sc1
    s_add_u32 s91, s81, 1310720
    buffer_load_dwordx4 v[88:91], v235, s[8:11], s91 offen offset:768 sc1
    s_add_u32 s91, s82, 1310720
    buffer_load_dwordx4 v[92:95], v235, s[8:11], s91 offen offset:768 sc1
    s_add_u32 s91, s83, 1310720
    buffer_load_dwordx4 v[96:99], v235, s[8:11], s91 offen offset:768 sc1
    s_sub_u32 s87, s87, 1
    s_cmp_lt_i32 s87, 0
    s_waitcnt vmcnt(0)
    s_cbranch_scc1 L_rompt_kernel_e44r
    v_max3_u32 v6, v147, v91, v95
    v_max_u32 v6, v6, v99
    v_cmp_eq_u32 vcc, -1, v6
    s_cbranch_vccnz L_rompt_kernel_e44
    s_branch L_rompt_kernel_e44r
L_rompt_kernel_e48:
    buffer_load_dwordx4 v[100:103], v235, s[8:11], s80 offen offset:1024 sc1
    buffer_load_dwordx4 v[104:107], v235, s[8:11], s81 offen offset:1024 sc1
    buffer_load_dwordx4 v[108:111], v235, s[8:11], s82 offen offset:1024 sc1
    buffer_load_dwordx4 v[112:115], v235, s[8:11], s83 offen offset:1024 sc1
    s_sub_u32 s87, s87, 1
    s_cmp_lt_i32 s87, 0
    s_waitcnt vmcnt(0)
    s_cbranch_scc1 L_rompt_kernel_e48r
    v_max3_u32 v6, v103, v107, v111
    v_max_u32 v6, v6, v115
    v_cmp_eq_u32 vcc, -1, v6
    s_cbranch_vccnz L_rompt_kernel_e48
    s_branch L_rompt_kernel_e48r
L_rompt_kernel_e52:
    s_add_u32 s91, s80, 655360
    buffer_load_dwordx4 v[116:119], v235, s[8:11], s91 offen offset:1024 sc1
    s_add_u32 s91, s81, 655360
    buffer_load_dwordx4 v[120:123], v235, s[8:11], s91 offen offset:1024 sc1
    s_add_u32 s91, s82, 655360
    buffer_load_dwordx4 v[124:127], v235, s[8:11], s91 offen offset:1024 sc1
    s_add_u32 s91, s83, 655360
    buffer_load_dwordx4 v[128:131], v235, s[8:11], s91 offen offset:1024 sc1
    s_sub_u32 s87, s87, 1
    s_cmp_lt_i32 s87, 0
    s_waitcnt vmcnt(0)
    s_cbranch_scc1 L_rompt_kernel_e52r
    v_max3_u32 v6, v119, v123, v127
    v_max_u32 v6, v6, v131
    v_cmp_eq_u32 vcc, -1, v6
    s_cbranch_vccnz L_rompt_kernel_e52
    s_branch L_rompt_kernel_e52r
L_rompt_kernel_e56:
    s_add_u32 s91, s80, 1310720
    buffer_load_dwordx4 v[132:135], v235, s[8:11], s91 offen offset:1024 sc1
    s_add_u32 s91, s81, 1310720
    buffer_load_dwordx4 v[136:139], v235, s[8:11], s91 offen offset:1024 sc1
    s_add_u32 s91, s82, 1310720
    buffer_load_dwordx4 v[140:143], v235, s[8:11], s91 offen offset:1024 sc1
    s_add_u32 s91, s83, 1310720
    buffer_load_dwordx4 v[144:147], v235, s[8:11], s91 offen offset:1024 sc1
    s_sub_u32 s87, s87, 1
    s_cmp_lt_i32 s87, 0
    s_waitcnt vmcnt(0)
    s_cbranch_scc1 L_rompt_kernel_e56r
    v_max3_u32 v6, v135, v139, v143
    v_max_u32 v6, v6, v147
    v_cmp_eq_u32 vcc, -1, v6
    s_cbranch_vccnz L_rompt_kernel_e56
    s_branch L_rompt_kernel_e56r
.section .rodata,"a"
.p2align 6
.amdhsa_kernel sequential_preLN__mha_block__mixer_token_mlp__prompt_kernel
  .amdhsa_next_free_vgpr 512
  .amdhsa_next_free_sgpr 96
  .amdhsa_accum_offset 256
  .amdhsa_group_segment_fixed_size 0
  .amdhsa_kernarg_size 88
  .amdhsa_user_sgpr_count 2
  .amdhsa_user_sgpr_kernarg_segment_ptr 1
  .amdhsa_system_sgpr_workgroup_id_x 1
.end_amdhsa_kernel
```
